```python
import torch

def _softmax(x, axis=-1):
    return torch.softmax(x, dim=axis)

def _gelu(x):
    return torch.nn.functional.gelu(x, approximate='tanh')

def _silu(x):
    return torch.nn.functional.silu(x)

def _sigmoid(x):
    return torch.sigmoid(x)

def _layernorm(x, axis=-1, eps=1e-05):
    m = x.mean(dim=axis, keepdim=True)
    v = x.var(dim=axis, keepdim=True, unbiased=False)
    return (x - m) / torch.sqrt(v + eps)

def _scatter_add(tgt, idx, src, axis=0):
    return tgt.clone().index_add_(axis, idx, src)

def _segment_sum(src, seg, n):
    out = torch.zeros((n,) + src.shape[1:], dtype=src.dtype)
    return out.index_add_(0, seg, src)

def _pad(x, pw):
    flat = tuple((v for pair in reversed(pw) for v in pair))
    return torch.nn.functional.pad(x, flat)
kernel_name = 'adaLN_cond__softmax_full_mha__glu_gated_geglu__prompt'

def setup_inputs():

    _w = lambda a: (lambda t: t.to(torch.bfloat16) if t.is_floating_point() else t)(torch.as_tensor(a))

    def _A_setup():
        B, S, D = (1, 2048, 640)
        return {'x': _w((lambda *s: torch.randn(*s, dtype=torch.bfloat16) * 0.05)(B, S, D)), 'wqkv': _w((lambda *s: torch.randn(*s, dtype=torch.bfloat16) * 0.05)(D, 3 * D)), 'wo': _w((lambda *s: torch.randn(*s, dtype=torch.bfloat16) * 0.05)(D, D))}
    _A_in = _A_setup()

    def _B_setup():
        B, S, Dm, Df = (1, 2048, 640, 1536)
        return {'x': _w((lambda *s: torch.randn(*s, dtype=torch.bfloat16) * 0.05)(B, S, Dm)), 'w_gate': _w((lambda *s: torch.randn(*s, dtype=torch.bfloat16) * 0.8)(Dm, Df) * Dm ** (-0.5)), 'w_up': _w((lambda *s: torch.randn(*s, dtype=torch.bfloat16) * 0.8)(Dm, Df) * Dm ** (-0.5)), 'w_down': _w((lambda *s: torch.randn(*s, dtype=torch.bfloat16) * 0.8)(Df, Dm) * Df ** (-0.5))}
    _B_in = _B_setup()
    return {'A_x': _A_in['x'], 'A_wqkv': _A_in['wqkv'], 'A_wo': _A_in['wo'], 'B_x': _B_in['x'], 'B_w_gate': _B_in['w_gate'], 'B_w_up': _B_in['w_up'], 'B_w_down': _B_in['w_down'], 'c': _w((lambda *s: torch.randn(*s, dtype=torch.bfloat16) * 0.1)(1, 640) * 8.0), 'w_mod': _w((lambda *s: torch.randn(*s, dtype=torch.bfloat16) * 0.1)(640, 6 * 640) * 640 ** (-0.5) * 8.0)}

def reference(A_x, A_wqkv, A_wo, B_x, B_w_gate, B_w_up, B_w_down, c, w_mod):

    def _A_ref(x, wqkv, wo):
        B, S, D = x.shape
        H = 32
        Dh = D // H
        qkv = (lambda x, *d: x.permute(*d))((x @ wqkv).reshape(B, S, 3, H, Dh), 2, 0, 3, 1, 4)
        q, k, v = (qkv[0], qkv[1], qkv[2])
        scale = Dh ** (-0.5)
        scores = torch.einsum('bhqd,bhkd->bhqk', q, k) * scale
        p = _softmax(scores, axis=-1)
        o = torch.einsum('bhqk,bhkd->bhqd', p, v)
        return (lambda x, *d: x.permute(*d))(o, 0, 2, 1, 3).reshape(B, S, D) @ wo

    def _B_ref(x, w_gate, w_up, w_down):
        g = torch.einsum('bsd,df->bsf', x, w_gate)
        u = torch.einsum('bsd,df->bsf', x, w_up)
        h = _gelu(g) * u
        return torch.einsum('bsf,fd->bsd', h, w_down)
    x = A_x
    mod = (_silu(c) @ w_mod).reshape(c.shape[0], 6, 1, -1)
    sa, ca, ga, sb, cb, gb = (mod[:, 0].clone(), mod[:, 1].clone(), mod[:, 2].clone(), mod[:, 3].clone(), mod[:, 4].clone(), mod[:, 5].clone())
    h = _layernorm(x, axis=-1) * (1 + ca) + sa
    x = x + ga * _A_ref(h, A_wqkv, A_wo)
    h = _layernorm(x, axis=-1) * (1 + cb) + sb
    x = x + gb * _B_ref(h, B_w_gate, B_w_up, B_w_down)
    return x
```

```asm
; @launch grid=(256,1,1) block=(256,1,1) lds=163840
.amdgcn_target "amdgcn-amd-amdhsa--gfx950"
.text
.globl adaLN_cond__softmax_full_mha__glu_gated_geglu__prompt_kernel
.p2align 12
.p2align 8
.type adaLN_cond__softmax_full_mha__glu_gated_geglu__prompt_kernel,@function
adaLN_cond__softmax_full_mha__glu_gated_geglu__prompt_kernel:
L_top:
    s_cmp_ge_u32 s2, 256
    s_cbranch_scc1 L_end
    s_load_dwordx16 s[64:79], s[0:1], 0
    s_load_dwordx8 s[80:87], s[0:1], 64
    s_getpc_b64 s[60:61]
L_pc:
    v_lshrrev_b32 v8, 6, v0
    s_and_b32 s50, s2, 7
    s_lshr_b32 s51, s2, 3
    v_readfirstlane_b32 s3, v8
    s_cmp_lt_u32 s51, 16
    s_cbranch_scc1 L_nopf
    v_lshrrev_b32 v9, 3, v0
    s_and_b32 s52, s51, 15
    s_lshl_b32 s52, s52, 12
    v_lshl_add_u32 v9, v9, 7, s52
    v_min_u32 v9, L_bot-L_pc, v9
    global_load_dword v63, v9, s[60:61]
L_nopf:
    s_and_b32 s52, s51, 3
    s_lshr_b32 s54, s51, 2
    s_lshl_b32 s53, s54, 3
    s_add_u32 s53, s53, s50
    s_lshl_b32 s37, s53, 2
    s_add_u32 s37, s37, s52
    s_cmp_lt_u32 s53, 20
    s_cselect_b32 s88, 1, 0
    s_cmp_lt_u32 s53, 60
    s_cselect_b32 s36, 0, 0x80000000
    s_cselect_b32 s37, s37, 0
    s_lshr_b32 s38, s37, 1
    s_lshl_b32 s38, s38, 6
    s_and_b32 s92, s37, 1
    s_mul_i32 s93, s92, 2457600
    s_add_u32 s93, s93, s38
    s_mul_i32 s92, s92, 640
    v_lshrrev_b32 v12, 2, v0
    v_and_b32 v13, 3, v0
    v_lshlrev_b32 v16, 3, v12
    v_lshlrev_b32 v17, 1, v12
    v_mul_u32_u24 v12, 7680, v12
    v_lshl_add_u32 v13, v13, 4, s36
    v_lshl_add_u32 v14, v12, 2, v13
    v_add_u32 v15, v12, v13
    s_mov_b32 s22, 4915200
    s_mov_b32 s23, 0x20000
    s_mov_b32 s30, 1280
    s_mov_b32 s31, 0x20000
    v_mov_b32 v6, 0
    v_and_b32 v5, 63, v0
    v_lshlrev_b32 v1, 4, v5
    s_waitcnt lgkmcnt(0)
    s_mov_b64 s[28:29], s[78:79]
    s_mov_b64 s[20:21], s[80:81]
    buffer_load_dwordx2 v[128:129], v16, s[28:31], s92 offen
    buffer_load_ushort v130, v17, s[28:31], s92 offen offset:512
    s_cmp_eq_u32 s88, 0
    s_cbranch_scc1 wa_1
    s_add_u32 s63, s93, 0
    buffer_load_dwordx4 v[144:147], v14, s[20:23], s63 offen
    s_add_u32 s63, s93, 7680
    buffer_load_dwordx4 v[148:151], v14, s[20:23], s63 offen
    s_add_u32 s63, s93, 15360
    buffer_load_dwordx4 v[152:155], v14, s[20:23], s63 offen
    s_add_u32 s63, s93, 23040
    buffer_load_dwordx4 v[156:159], v14, s[20:23], s63 offen
    s_add_u32 s63, s93, 1966080
    buffer_load_dwordx4 v[160:163], v15, s[20:23], s63 offen
wa_1:
    s_add_u32 s8, s86, 0
    s_addc_u32 s9, s87, 0
    s_load_dword s6, s[8:9], 0
    s_lshr_b32 s4, s50, 2
    s_lshl_b32 s4, s4, 3
    s_and_b32 s5, s51, 7
    s_add_u32 s4, s4, s5
    s_and_b32 s5, s50, 3
    s_lshl_b32 s5, s5, 2
    s_lshr_b32 s53, s51, 3
    s_add_u32 s5, s5, s53
    s_mul_hi_u32 s50, s37, 715827883
    s_mul_i32 s51, s50, 6
    s_sub_u32 s51, s37, s51
    s_mul_i32 s32, s50, 61440
    s_mul_i32 s53, s51, 640
    s_add_u32 s32, s32, s53
    s_mul_i32 s53, s3, 160
    s_add_u32 s32, s32, s53
    s_lshl_b32 s49, s4, 4
    s_add_u32 s49, s49, s5
    s_mul_i32 s49, s49, 10240
    s_lshl_b32 s53, s53, 1
    s_add_u32 s49, s49, s53
    s_mul_i32 s53, s3, 3072
    v_cmp_gt_u32 vcc, 32, v5
    v_mov_b32 v11, 0x80000000
    v_add_u32 v29, 0, v5
    v_mul_u32_u24 v29, 6554, v29
    v_lshrrev_b32 v28, 16, v29
    v_lshrrev_b32 v29, 17, v29
    v_mul_u32_u24 v28, 3680, v28
    v_mul_u32_u24 v29, 960, v29
    v_add3_u32 v30, v28, v1, s36
    v_add_u32 v33, v29, v1
    v_add_u32 v29, 64, v5
    v_mul_u32_u24 v29, 6554, v29
    v_lshrrev_b32 v28, 16, v29
    v_lshrrev_b32 v29, 17, v29
    v_mul_u32_u24 v28, 3680, v28
    v_mul_u32_u24 v29, 960, v29
    v_add3_u32 v31, v28, v1, s36
    v_add_u32 v34, v29, v1
    v_add_u32 v29, 128, v5
    v_mul_u32_u24 v29, 6554, v29
    v_lshrrev_b32 v28, 16, v29
    v_lshrrev_b32 v29, 17, v29
    v_mul_u32_u24 v28, 3680, v28
    v_mul_u32_u24 v29, 960, v29
    v_add3_u32 v32, v28, v1, s36
    v_add_u32 v35, v29, v1
    v_cndmask_b32 v32, v11, v32, vcc
    v_cndmask_b32 v35, v11, v35, vcc
    s_mov_b32 s10, 33554432
    s_mov_b32 s11, 0x20000
    s_mov_b32 s14, 2621440
    s_mov_b32 s15, 0x20000
    s_mov_b32 s26, 2457600
    s_mov_b32 s27, 0x20000
    s_add_u32 m0, s53, 16384
    s_mov_b64 s[12:13], s[64:65]
    s_mov_b64 s[24:25], s[66:67]
    s_cmp_lg_u32 s88, 0
    s_cbranch_scc1 wb_2
    buffer_load_dwordx4 v33, s[12:15], s49 offen offset:0 lds
    buffer_load_dwordx4 v34, s[12:15], s49 offen offset:1024 lds
    buffer_load_dwordx4 v35, s[12:15], s49 offen offset:2048 lds
    s_add_u32 m0, s53, 0
    s_nop 0
    buffer_load_dwordx4 v30, s[24:27], s32 offen offset:0 lds
    buffer_load_dwordx4 v31, s[24:27], s32 offen offset:1024 lds
    buffer_load_dwordx4 v32, s[24:27], s32 offen offset:2048 lds
    s_add_u32 s63, s93, 0
    buffer_load_dwordx4 v[144:147], v14, s[20:23], s63 offen
    s_add_u32 s63, s93, 7680
    buffer_load_dwordx4 v[148:151], v14, s[20:23], s63 offen
    s_add_u32 s63, s93, 15360
    buffer_load_dwordx4 v[152:155], v14, s[20:23], s63 offen
    s_add_u32 s63, s93, 23040
    buffer_load_dwordx4 v[156:159], v14, s[20:23], s63 offen
    s_add_u32 s63, s93, 1966080
    buffer_load_dwordx4 v[160:163], v15, s[20:23], s63 offen
wb_2:
    v_cmp_eq_u32 vcc, 0, v5
    v_mov_b32 v7, 0x80000000
    v_lshlrev_b32 v252, 2, v5
    v_cndmask_b32 v7, v7, v5, vcc
    v_add_u32 v2, 0x10000, v1
    v_add_u32 v3, 0x20000, v1
    s_lshl_b32 s7, s4, 2
    s_add_u32 s7, s7, s3
    s_lshl_b32 s39, s3, 12
    s_and_b32 s41, s5, 7
    s_lshr_b32 s63, s5, 3
    s_lshl_b32 s63, s63, 2
    s_lshl_b32 s40, s4, 3
    s_add_u32 s40, s40, s63
    s_add_u32 s40, s40, s3
    s_mov_b64 s[16:17], s[82:83]
    s_mov_b32 s18, 2621440
    s_mov_b32 s19, 0x20000
    s_mov_b32 s35, 0x20000
    s_lshr_b32 s54, s51, 1
    s_and_b32 s55, s51, 1
    s_mul_i32 s59, s50, 3072
    s_lshl_b32 s63, s50, 10
    s_add_u32 s56, s63, 122880
    s_add_u32 s58, s56, 4294967168
    s_add_u32 s57, s59, 2048
    s_add_u32 s63, s59, 768
    s_add_u32 s62, s59, 4294967168
    s_cmp_eq_u32 s54, 1
    s_cselect_b32 s56, s59, s56
    s_cselect_b32 s57, s63, s57
    s_cselect_b32 s58, s62, s58
    s_add_u32 s63, s59, 1152
    s_add_u32 s62, s59, 1664
    s_cmp_eq_u32 s54, 2
    s_cselect_b32 s56, s63, s56
    s_cselect_b32 s57, s63, s57
    s_cselect_b32 s58, s62, s58
    v_mov_b32 v40, s56
    v_mov_b32 v41, s57
    v_mov_b32 v42, s58
    v_and_b32 v43, 31, v5
    v_lshrrev_b32 v44, 5, v5
    v_lshl_add_u32 v39, v44, 9, s36
    s_mov_b32 s59, 163840
    v_add_u32 v45, 0, v43
    v_mul_u32_u24 v46, 1639, v45
    v_lshrrev_b32 v46, 16, v46
    v_mul_u32_u24 v47, 40, v46
    v_sub_u32 v45, v45, v47
    v_cmp_gt_u32 vcc, 24, v45
    v_mad_u32_u24 v46, v46, s59, v39
    v_lshl_add_u32 v46, v45, 4, v46
    v_cndmask_b32 v47, v42, v41, vcc
    v_cmp_gt_u32 vcc, 16, v45
    s_nop 1
    v_cndmask_b32 v47, v47, v40, vcc
    v_add_u32 v36, v46, v47
    v_add_u32 v45, 32, v43
    v_mul_u32_u24 v46, 1639, v45
    v_lshrrev_b32 v46, 16, v46
    v_mul_u32_u24 v47, 40, v46
    v_sub_u32 v45, v45, v47
    v_cmp_gt_u32 vcc, 24, v45
    v_mad_u32_u24 v46, v46, s59, v39
    v_lshl_add_u32 v46, v45, 4, v46
    v_cndmask_b32 v47, v42, v41, vcc
    v_cmp_gt_u32 vcc, 16, v45
    s_nop 1
    v_cndmask_b32 v47, v47, v40, vcc
    v_add_u32 v37, v46, v47
    v_add_u32 v45, 64, v43
    v_mul_u32_u24 v46, 1639, v45
    v_lshrrev_b32 v46, 16, v46
    v_mul_u32_u24 v47, 40, v46
    v_sub_u32 v45, v45, v47
    v_cmp_gt_u32 vcc, 24, v45
    v_mad_u32_u24 v46, v46, s59, v39
    v_lshl_add_u32 v46, v45, 4, v46
    v_cndmask_b32 v47, v42, v41, vcc
    v_cmp_gt_u32 vcc, 16, v45
    s_nop 1
    v_cndmask_b32 v47, v47, v40, vcc
    v_add_u32 v38, v46, v47
    v_cmp_gt_u32 vcc, 16, v43
    v_bfe_u32 v46, v5, 2, 2
    v_lshl_add_u32 v45, v44, 3, v46
    v_cndmask_b32 v38, v11, v38, vcc
    v_mul_u32_u24 v45, 160, v45
    v_bfe_u32 v46, v5, 4, 1
    v_lshl_add_u32 v45, v46, 5, v45
    v_and_b32 v46, 3, v5
    v_lshl_add_u32 v45, v46, 3, v45
    v_add_u32 v45, s53, v45
    s_lshl_b32 s55, s55, 2
    s_add_u32 s55, s55, s3
    s_mul_i32 s84, s55, 327680
    s_add_u32 s84, s84, 1048576
    s_mul_i32 s50, s50, 3
    s_add_u32 s50, s50, s54
    s_mul_hi_u32 s54, s50, 143165577
    s_mul_i32 s54, s54, 34
    s_add_u32 s50, s50, s54
    s_lshl_b32 s55, s55, 9
    s_add_u32 s50, s50, s55
    s_lshl_b32 s50, s50, 2
    s_add_u32 s85, s50, 20480
    v_and_b32 v8, 7, v5
    v_lshrrev_b32 v9, 3, v5
    v_mul_u32_u24 v10, 320, v8
    v_lshl_add_u32 v10, v9, 4, v10
    v_add_u32 v10, s53, v10
    s_mul_i32 s50, s3, 20
    v_add_u32 v9, s50, v9
    s_lshl_b32 s47, s7, 8
    s_add_u32 s47, s47, 4096
    s_mov_b32 s89, 0
    s_mul_i32 s50, s3, 80
    v_add_u32 v164, s50, v5
    v_cmp_lt_u32 vcc, 15, v5
    v_mov_b32 v165, 304
    v_and_b32 v166, 31, v5
    s_add_u32 s50, s50, 368
    v_cndmask_b32 v165, 64, v165, vcc
    v_cndmask_b32 v170, 0, 1.0, vcc
    v_add_u32 v166, s50, v166
    v_add_u32 v165, v165, v164
    s_mov_b32 s50, 152576
    v_lshl_add_u32 v167, v164, 3, s50
    v_lshl_add_u32 v168, v165, 3, s50
    v_lshl_add_u32 v169, v166, 3, s50
    v_lshlrev_b32 v164, 4, v164
    v_lshlrev_b32 v165, 4, v165
    v_lshlrev_b32 v166, 4, v166
    s_and_b32 s48, s5, 14
    s_and_b32 s50, s4, 1
    s_add_u32 s48, s48, s50
    s_lshl_b32 s48, s48, 2
    s_add_u32 s48, s48, s3
    s_lshl_b32 s48, s48, 8
    s_add_u32 s48, s48, 20480
    v_lshlrev_b32 v51, 5, v9
    v_add_u32 v51, 152576, v51
    v_lshlrev_b32 v124, 9, v9
    v_lshl_add_u32 v124, v8, 4, v124
    v_cmp_gt_u32 vcc, 32, v5
    s_lshr_b32 s44, s5, 2
    s_lshl_b32 s45, s4, 2
    v_cndmask_b32 v125, v11, v124, vcc
    s_add_u32 s54, s44, s45
    s_mul_i32 s44, s54, 40960
    s_and_b32 s55, s5, 3
    s_lshl_b32 s45, s55, 7
    s_add_u32 s44, s44, s45
    s_add_u32 s44, s44, 11010048
    s_add_u32 s45, s44, 4096
    s_add_u32 s46, s44, 8192
    s_lshl_b32 s90, s54, 8
    s_lshl_b32 s55, s55, 4
    s_add_u32 s90, s90, s55
    s_lshl_b32 s55, s3, 2
    s_add_u32 s90, s90, s55
    s_add_u32 s90, s90, 36864
    s_waitcnt vmcnt(5) lgkmcnt(0)
    s_add_u32 s6, s6, 2654435769
    v_mov_b32 v4, s6
    v_lshlrev_b32 v184, 16, v128
    v_and_b32 v185, 0xffff0000, v128
    v_lshlrev_b32 v186, 16, v129
    v_and_b32 v187, 0xffff0000, v129
    v_lshlrev_b32 v188, 16, v130
    v_mul_f32 v194, 0xbfb8aa3b, v184
    v_mul_f32 v195, 0xbfb8aa3b, v185
    v_mul_f32 v196, 0xbfb8aa3b, v186
    v_mul_f32 v197, 0xbfb8aa3b, v187
    v_mul_f32 v198, 0xbfb8aa3b, v188
    v_exp_f32 v194, v194
    v_exp_f32 v195, v195
    v_exp_f32 v196, v196
    v_exp_f32 v197, v197
    v_exp_f32 v198, v198
    v_add_f32 v194, 1.0, v194
    v_add_f32 v195, 1.0, v195
    v_add_f32 v196, 1.0, v196
    v_add_f32 v197, 1.0, v197
    v_add_f32 v198, 1.0, v198
    v_rcp_f32 v194, v194
    v_rcp_f32 v195, v195
    v_rcp_f32 v196, v196
    v_rcp_f32 v197, v197
    v_rcp_f32 v198, v198
    v_mul_f32 v184, v184, v194
    v_mul_f32 v185, v185, v195
    v_mul_f32 v186, v186, v196
    v_mul_f32 v187, v187, v197
    v_mul_f32 v188, v188, v198
    v_cvt_pk_bf16_f32 v184, v184, v184
    v_cvt_pk_bf16_f32 v185, v185, v185
    v_cvt_pk_bf16_f32 v186, v186, v186
    v_cvt_pk_bf16_f32 v187, v187, v187
    v_cvt_pk_bf16_f32 v188, v188, v188
    v_lshlrev_b32 v184, 16, v184
    v_lshlrev_b32 v185, 16, v185
    v_lshlrev_b32 v186, 16, v186
    v_lshlrev_b32 v187, 16, v187
    v_lshlrev_b32 v188, 16, v188
    s_cmp_eq_u32 s88, 0
    s_cbranch_scc1 wd_3
    s_mov_b32 s54, s37
    s_mul_hi_u32 s55, s54, 429496730
    s_mul_i32 s55, s55, 54
    s_cmp_ge_u32 s54, 40
    s_cselect_b32 s56, 246, 0
    s_add_u32 s54, s54, s55
    s_sub_u32 s54, s54, s56
    s_lshl_b32 s54, s54, 2
    s_add_u32 s54, s54, 4096
    v_cmp_gt_u32 vcc, 16, v0
    v_lshlrev_b32 v12, 10, v5
    s_nop 0
    v_cndmask_b32 v12, v11, v12, vcc
    s_waitcnt vmcnt(4)
    buffer_load_dwordx4 v33, s[12:15], s49 offen offset:0 lds
    buffer_load_dwordx4 v34, s[12:15], s49 offen offset:1024 lds
    buffer_load_dwordx4 v35, s[12:15], s49 offen offset:2048 lds
    s_add_u32 m0, s53, 0
    s_nop 0
    buffer_load_dwordx4 v30, s[24:27], s32 offen offset:0 lds
    buffer_load_dwordx4 v31, s[24:27], s32 offen offset:1024 lds
    buffer_load_dwordx4 v32, s[24:27], s32 offen offset:2048 lds
    v_lshlrev_b32 v202, 16, v144
    v_and_b32 v203, 0xffff0000, v144
    v_lshlrev_b32 v204, 16, v145
    v_and_b32 v205, 0xffff0000, v145
    v_lshlrev_b32 v206, 16, v146
    v_and_b32 v207, 0xffff0000, v146
    v_lshlrev_b32 v208, 16, v147
    v_and_b32 v209, 0xffff0000, v147
    v_pk_mul_f32 v[194:195], v[202:203], v[184:185] op_sel:[0,0] op_sel_hi:[1,0]
    v_pk_mul_f32 v[196:197], v[204:205], v[184:185] op_sel:[0,0] op_sel_hi:[1,0]
    v_pk_mul_f32 v[198:199], v[206:207], v[184:185] op_sel:[0,0] op_sel_hi:[1,0]
    v_pk_mul_f32 v[200:201], v[208:209], v[184:185] op_sel:[0,0] op_sel_hi:[1,0]
    s_waitcnt vmcnt(9)
    v_lshlrev_b32 v202, 16, v148
    v_and_b32 v203, 0xffff0000, v148
    v_lshlrev_b32 v204, 16, v149
    v_and_b32 v205, 0xffff0000, v149
    v_lshlrev_b32 v206, 16, v150
    v_and_b32 v207, 0xffff0000, v150
    v_lshlrev_b32 v208, 16, v151
    v_and_b32 v209, 0xffff0000, v151
    v_pk_fma_f32 v[194:195], v[202:203], v[184:185], v[194:195] op_sel:[0,1,0] op_sel_hi:[1,1,1]
    v_pk_fma_f32 v[196:197], v[204:205], v[184:185], v[196:197] op_sel:[0,1,0] op_sel_hi:[1,1,1]
    v_pk_fma_f32 v[198:199], v[206:207], v[184:185], v[198:199] op_sel:[0,1,0] op_sel_hi:[1,1,1]
    v_pk_fma_f32 v[200:201], v[208:209], v[184:185], v[200:201] op_sel:[0,1,0] op_sel_hi:[1,1,1]
    s_waitcnt vmcnt(8)
    v_lshlrev_b32 v202, 16, v152
    v_and_b32 v203, 0xffff0000, v152
    v_lshlrev_b32 v204, 16, v153
    v_and_b32 v205, 0xffff0000, v153
    v_lshlrev_b32 v206, 16, v154
    v_and_b32 v207, 0xffff0000, v154
    v_lshlrev_b32 v208, 16, v155
    v_and_b32 v209, 0xffff0000, v155
    v_pk_fma_f32 v[194:195], v[202:203], v[186:187], v[194:195] op_sel:[0,0,0] op_sel_hi:[1,0,1]
    v_pk_fma_f32 v[196:197], v[204:205], v[186:187], v[196:197] op_sel:[0,0,0] op_sel_hi:[1,0,1]
    v_pk_fma_f32 v[198:199], v[206:207], v[186:187], v[198:199] op_sel:[0,0,0] op_sel_hi:[1,0,1]
    v_pk_fma_f32 v[200:201], v[208:209], v[186:187], v[200:201] op_sel:[0,0,0] op_sel_hi:[1,0,1]
    s_waitcnt vmcnt(7)
    v_lshlrev_b32 v202, 16, v156
    v_and_b32 v203, 0xffff0000, v156
    v_lshlrev_b32 v204, 16, v157
    v_and_b32 v205, 0xffff0000, v157
    v_lshlrev_b32 v206, 16, v158
    v_and_b32 v207, 0xffff0000, v158
    v_lshlrev_b32 v208, 16, v159
    v_and_b32 v209, 0xffff0000, v159
    v_pk_fma_f32 v[194:195], v[202:203], v[186:187], v[194:195] op_sel:[0,1,0] op_sel_hi:[1,1,1]
    v_pk_fma_f32 v[196:197], v[204:205], v[186:187], v[196:197] op_sel:[0,1,0] op_sel_hi:[1,1,1]
    v_pk_fma_f32 v[198:199], v[206:207], v[186:187], v[198:199] op_sel:[0,1,0] op_sel_hi:[1,1,1]
    v_pk_fma_f32 v[200:201], v[208:209], v[186:187], v[200:201] op_sel:[0,1,0] op_sel_hi:[1,1,1]
    s_waitcnt vmcnt(6)
    buffer_atomic_swap v4, v12, s[8:11], s54 offen offset:0 sc1
    v_lshlrev_b32 v202, 16, v160
    v_and_b32 v203, 0xffff0000, v160
    v_lshlrev_b32 v204, 16, v161
    v_and_b32 v205, 0xffff0000, v161
    v_lshlrev_b32 v206, 16, v162
    v_and_b32 v207, 0xffff0000, v162
    v_lshlrev_b32 v208, 16, v163
    v_and_b32 v209, 0xffff0000, v163
    v_pk_fma_f32 v[194:195], v[202:203], v[188:189], v[194:195] op_sel:[0,0,0] op_sel_hi:[1,0,1]
    v_pk_fma_f32 v[196:197], v[204:205], v[188:189], v[196:197] op_sel:[0,0,0] op_sel_hi:[1,0,1]
    v_pk_fma_f32 v[198:199], v[206:207], v[188:189], v[198:199] op_sel:[0,0,0] op_sel_hi:[1,0,1]
    v_pk_fma_f32 v[200:201], v[208:209], v[188:189], v[200:201] op_sel:[0,0,0] op_sel_hi:[1,0,1]
    v_lshrrev_b32 v202, 4, v5
    v_and_b32 v203, 3, v5
    v_permlane32_swap_b32 v194, v198
    v_permlane32_swap_b32 v195, v199
    v_permlane32_swap_b32 v196, v200
    v_permlane32_swap_b32 v197, v201
    v_add_f32 v194, v194, v198
    v_add_f32 v195, v195, v199
    v_add_f32 v196, v196, v200
    v_add_f32 v197, v197, v201
    v_lshl_add_u32 v202, v203, 2, v202
    s_lshl_b32 s50, s3, 7
    v_permlane16_swap_b32 v194, v196
    v_permlane16_swap_b32 v195, v197
    v_add_f32 v194, v194, v196
    v_add_f32 v195, v195, v197
    s_add_u32 s50, s50, 158720
    s_nop 0
    v_add_f32_dpp v194, v194, v194 row_ror:8 row_mask:0xf bank_mask:0xf
    v_add_f32_dpp v195, v195, v195 row_ror:8 row_mask:0xf bank_mask:0xf
    s_nop 1
    v_add_f32_dpp v194, v194, v194 row_ror:4 row_mask:0xf bank_mask:0xf
    v_add_f32_dpp v195, v195, v195 row_ror:4 row_mask:0xf bank_mask:0xf
    v_lshl_add_u32 v202, v202, 3, s50
    ds_write_b64 v202, v[194:195]
    s_waitcnt lgkmcnt(0)
    s_barrier
    v_add_u32 v202, 158720, v252
    ds_read_b32 v194, v202
    ds_read_b32 v196, v202 offset:128
    ds_read_b32 v197, v202 offset:256
    ds_read_b32 v198, v202 offset:384
    s_lshl_b32 s89, s38, 2
    s_and_b32 s52, s37, 1
    s_mul_i32 s52, s52, 30720
    s_add_u32 s89, s89, s52
    s_add_u32 s89, s89, 524288
    v_cmp_gt_u32 vcc, 32, v0
    v_mov_b32 v203, 0x80000000
    v_lshlrev_b32 v199, 3, v5
    v_mov_b32 v195, v4
    v_cndmask_b32 v203, v203, v199, vcc
    v_or_b32 v203, s36, v203
    s_waitcnt lgkmcnt(0)
    v_add_f32 v194, v194, v196
    v_add_f32 v197, v197, v198
    v_add_f32 v194, v194, v197
    buffer_store_dwordx2 v[194:195], v203, s[8:11], s89 offen sc1
    s_waitcnt vmcnt(2)
wd_3:
    v_mov_b32 v203, 0x80000000
    ds_read_b128 v[16:19], v10 offset:16384
    ds_read_b128 v[20:23], v10 offset:16512
    ds_read_b128 v[24:27], v10 offset:16640
    ds_read_b64_tr_b16 v[88:89], v45 offset:0
    ds_read_b64_tr_b16 v[90:91], v45 offset:640
    ds_read_b64_tr_b16 v[92:93], v45 offset:64
    ds_read_b64_tr_b16 v[94:95], v45 offset:704
    ds_read_b64_tr_b16 v[96:97], v45 offset:128
    ds_read_b64_tr_b16 v[98:99], v45 offset:768
    v_cmp_gt_u32 vcc, 2, v5
    v_lshl_add_u32 v13, v5, 10, s36
    v_lshlrev_b32 v29, 5, v8
    v_cndmask_b32 v13, v11, v13, vcc
    v_cmp_gt_u32 vcc, 32, v5
    v_add_u32 v29, 159232, v29
    s_lshl_b32 s50, s3, 3
    v_add_u32 v28, s50, v29
    s_waitcnt lgkmcnt(6)
    v_cndmask_b32 v24, 0, v24, vcc
    v_cndmask_b32 v25, 0, v25, vcc
    v_cndmask_b32 v26, 0, v26, vcc
    v_cndmask_b32 v27, 0, v27, vcc
    s_waitcnt lgkmcnt(0)
    buffer_store_dwordx4 v[88:91], v36, s[8:11], s84 offen sc1
    buffer_store_dwordx4 v[92:95], v37, s[8:11], s84 offen sc1
    buffer_store_dwordx4 v[96:99], v38, s[8:11], s84 offen sc1
    s_mov_b64 exec, 1048575
    v_mov_b32 v48, 0
    buffer_atomic_or v48, v252, s[8:11], s47 offen sc0 sc1
    s_mov_b64 exec, -1
    s_cmp_lg_u32 s88, 0
    s_cbranch_scc1 wg_4
    v_lshlrev_b32 v64, 16, v16
    v_and_b32 v65, 0xffff0000, v16
    v_lshlrev_b32 v66, 16, v17
    v_and_b32 v67, 0xffff0000, v17
    v_lshlrev_b32 v68, 16, v18
    v_and_b32 v69, 0xffff0000, v18
    v_lshlrev_b32 v70, 16, v19
    v_and_b32 v71, 0xffff0000, v19
    v_lshlrev_b32 v72, 16, v20
    v_and_b32 v73, 0xffff0000, v20
    v_lshlrev_b32 v74, 16, v21
    v_and_b32 v75, 0xffff0000, v21
    v_lshlrev_b32 v76, 16, v22
    v_and_b32 v77, 0xffff0000, v22
    v_lshlrev_b32 v78, 16, v23
    v_and_b32 v79, 0xffff0000, v23
    v_lshlrev_b32 v80, 16, v24
    v_and_b32 v81, 0xffff0000, v24
    v_lshlrev_b32 v82, 16, v25
    v_and_b32 v83, 0xffff0000, v25
    v_lshlrev_b32 v84, 16, v26
    v_and_b32 v85, 0xffff0000, v26
    v_lshlrev_b32 v86, 16, v27
    v_and_b32 v87, 0xffff0000, v27
    v_pk_add_f32 v[30:31], v[64:65], v[66:67]
    v_pk_mul_f32 v[32:33], v[64:65], v[64:65]
    v_pk_fma_f32 v[32:33], v[66:67], v[66:67], v[32:33]
    v_pk_add_f32 v[30:31], v[30:31], v[68:69]
    v_pk_fma_f32 v[32:33], v[68:69], v[68:69], v[32:33]
    v_pk_add_f32 v[30:31], v[30:31], v[70:71]
    v_pk_fma_f32 v[32:33], v[70:71], v[70:71], v[32:33]
    v_pk_add_f32 v[30:31], v[30:31], v[72:73]
    v_pk_fma_f32 v[32:33], v[72:73], v[72:73], v[32:33]
    v_pk_add_f32 v[30:31], v[30:31], v[74:75]
    v_pk_fma_f32 v[32:33], v[74:75], v[74:75], v[32:33]
    v_pk_add_f32 v[30:31], v[30:31], v[76:77]
    v_pk_fma_f32 v[32:33], v[76:77], v[76:77], v[32:33]
    v_pk_add_f32 v[30:31], v[30:31], v[78:79]
    v_pk_fma_f32 v[32:33], v[78:79], v[78:79], v[32:33]
    v_pk_add_f32 v[30:31], v[30:31], v[80:81]
    v_pk_fma_f32 v[32:33], v[80:81], v[80:81], v[32:33]
    v_pk_add_f32 v[30:31], v[30:31], v[82:83]
    v_pk_fma_f32 v[32:33], v[82:83], v[82:83], v[32:33]
    v_pk_add_f32 v[30:31], v[30:31], v[84:85]
    v_pk_fma_f32 v[32:33], v[84:85], v[84:85], v[32:33]
    v_pk_add_f32 v[30:31], v[30:31], v[86:87]
    v_pk_fma_f32 v[32:33], v[86:87], v[86:87], v[32:33]
    v_add_f32 v30, v30, v31
    v_add_f32 v31, v32, v33
    s_nop 0
    v_add_f32_dpp v30, v30, v30 row_ror:8 row_mask:0xf bank_mask:0xf
    v_add_f32_dpp v31, v31, v31 row_ror:8 row_mask:0xf bank_mask:0xf
    v_mov_b32 v32, v30
    v_mov_b32 v33, v31
    s_nop 0
    v_permlane16_swap_b32 v30, v32
    v_permlane16_swap_b32 v31, v33
    v_pk_add_f32 v[30:31], v[30:31], v[32:33]
    v_mov_b32 v32, v30
    v_mov_b32 v33, v31
    s_nop 0
    v_permlane32_swap_b32 v30, v32
    v_permlane32_swap_b32 v31, v33
    v_pk_add_f32 v[30:31], v[30:31], v[32:33]
    ds_write_b64 v28, v[30:31]
    s_waitcnt lgkmcnt(0)
    s_barrier
    ds_read_b128 v[52:55], v29
    ds_read_b128 v[56:59], v29 offset:16
    s_waitcnt lgkmcnt(0)
    v_pk_add_f32 v[52:53], v[52:53], v[54:55]
    v_pk_add_f32 v[56:57], v[56:57], v[58:59]
    v_pk_add_f32 v[52:53], v[52:53], v[56:57]
    v_mul_f32 v52, 0xbacccccd, v52
    v_mul_f32 v53, 0x3acccccd, v53
    v_fma_f32 v53, -v52, v52, v53
    v_max_f32 v53, 0, v53
    v_add_f32 v53, 0x3727c5ac, v53
    v_rsq_f32 v54, v53
    v_pk_add_f32 v[64:65], v[64:65], v[52:53] op_sel_hi:[1,0]
    v_pk_add_f32 v[66:67], v[66:67], v[52:53] op_sel_hi:[1,0]
    v_pk_add_f32 v[68:69], v[68:69], v[52:53] op_sel_hi:[1,0]
    v_pk_add_f32 v[70:71], v[70:71], v[52:53] op_sel_hi:[1,0]
    v_pk_add_f32 v[72:73], v[72:73], v[52:53] op_sel_hi:[1,0]
    v_pk_add_f32 v[74:75], v[74:75], v[52:53] op_sel_hi:[1,0]
    v_pk_add_f32 v[76:77], v[76:77], v[52:53] op_sel_hi:[1,0]
    v_pk_add_f32 v[78:79], v[78:79], v[52:53] op_sel_hi:[1,0]
    v_pk_add_f32 v[80:81], v[80:81], v[52:53] op_sel_hi:[1,0]
    v_pk_add_f32 v[82:83], v[82:83], v[52:53] op_sel_hi:[1,0]
    v_pk_add_f32 v[84:85], v[84:85], v[52:53] op_sel_hi:[1,0]
    v_pk_add_f32 v[86:87], v[86:87], v[52:53] op_sel_hi:[1,0]
    v_pk_mul_f32 v[64:65], v[64:65], v[54:55] op_sel_hi:[1,0]
    v_pk_mul_f32 v[66:67], v[66:67], v[54:55] op_sel_hi:[1,0]
    v_pk_mul_f32 v[68:69], v[68:69], v[54:55] op_sel_hi:[1,0]
    v_pk_mul_f32 v[70:71], v[70:71], v[54:55] op_sel_hi:[1,0]
    v_pk_mul_f32 v[72:73], v[72:73], v[54:55] op_sel_hi:[1,0]
    v_pk_mul_f32 v[74:75], v[74:75], v[54:55] op_sel_hi:[1,0]
    v_pk_mul_f32 v[76:77], v[76:77], v[54:55] op_sel_hi:[1,0]
    v_pk_mul_f32 v[78:79], v[78:79], v[54:55] op_sel_hi:[1,0]
    v_pk_mul_f32 v[80:81], v[80:81], v[54:55] op_sel_hi:[1,0]
    v_pk_mul_f32 v[82:83], v[82:83], v[54:55] op_sel_hi:[1,0]
    v_pk_mul_f32 v[84:85], v[84:85], v[54:55] op_sel_hi:[1,0]
    v_pk_mul_f32 v[86:87], v[86:87], v[54:55] op_sel_hi:[1,0]
wg_4:
    v_and_b32 v39, 31, v5
    v_cmp_gt_u32 s[58:59], 24, v39
    v_mov_b32 v40, 0x80000000
    s_mul_i32 s42, s5, 163840
    s_add_u32 s42, s42, s39
    v_cndmask_b32 v40, v40, v1, s[58:59]
    s_add_u32 s42, s42, 1032192
    s_cmp_eq_u32 s3, 2
    s_cselect_b64 s[58:59], -1, 0
    v_cndmask_b32 v228, v1, v40, s[58:59]
    s_cmp_eq_u32 s3, 1
    s_cselect_b64 s[58:59], -1, 0
    v_cndmask_b32 v229, v1, v40, s[58:59]
    s_cmp_eq_u32 s3, 0
    s_cselect_b64 s[58:59], -1, 0
    s_cmp_eq_u32 s3, 3
    s_cselect_b64 s[58:59], -1, s[58:59]
    v_cndmask_b32 v230, v1, v40, s[58:59]
    s_cmp_lt_u32 s3, 2
    s_cselect_b64 s[58:59], -1, 0
    v_cndmask_b32 v60, v1, v228, s[58:59]
    v_cndmask_b32 v61, v1, v229, s[58:59]
    v_cndmask_b32 v62, v1, v230, s[58:59]
    s_lshl_b32 s91, s7, 8
    s_add_u32 s91, s91, 36864
    s_mul_i32 s43, s7, 40960
    s_add_u32 s43, s43, 11005952
    s_waitcnt vmcnt(1)
    buffer_atomic_swap v4, v13, s[8:11], s85 offen offset:0 sc1
    s_waitcnt vmcnt(1)
    s_mov_b64 exec, 1048575
    v_cmp_ne_u32 vcc, s6, v48
    s_mov_b64 exec, -1
    s_cbranch_vccnz cold_6
coldr_7:
    s_mov_b32 s63, 524288
    buffer_load_dwordx4 v[88:91], v164, s[8:11], s63 offen sc1
    s_mov_b32 s63, 555008
    buffer_load_dwordx4 v[92:95], v164, s[8:11], s63 offen sc1
    s_mov_b32 s63, 524288
    buffer_load_dwordx4 v[96:99], v165, s[8:11], s63 offen sc1
    s_mov_b32 s63, 555008
    buffer_load_dwordx4 v[100:103], v165, s[8:11], s63 offen sc1
    s_mov_b32 s63, 524288
    buffer_load_dwordx4 v[104:107], v166, s[8:11], s63 offen sc1
    s_mov_b32 s63, 555008
    buffer_load_dwordx4 v[108:111], v166, s[8:11], s63 offen sc1
    s_cmp_lg_u32 s88, 0
    s_cbranch_scc1 wh_10
    v_lshlrev_b32 v202, 16, v144
    v_and_b32 v203, 0xffff0000, v144
    v_lshlrev_b32 v204, 16, v145
    v_and_b32 v205, 0xffff0000, v145
    v_lshlrev_b32 v206, 16, v146
    v_and_b32 v207, 0xffff0000, v146
    v_lshlrev_b32 v208, 16, v147
    v_and_b32 v209, 0xffff0000, v147
    v_pk_mul_f32 v[194:195], v[202:203], v[184:185] op_sel:[0,0] op_sel_hi:[1,0]
    v_pk_mul_f32 v[196:197], v[204:205], v[184:185] op_sel:[0,0] op_sel_hi:[1,0]
    v_pk_mul_f32 v[198:199], v[206:207], v[184:185] op_sel:[0,0] op_sel_hi:[1,0]
    v_pk_mul_f32 v[200:201], v[208:209], v[184:185] op_sel:[0,0] op_sel_hi:[1,0]
    v_lshlrev_b32 v202, 16, v148
    v_and_b32 v203, 0xffff0000, v148
    v_lshlrev_b32 v204, 16, v149
    v_and_b32 v205, 0xffff0000, v149
    v_lshlrev_b32 v206, 16, v150
    v_and_b32 v207, 0xffff0000, v150
    v_lshlrev_b32 v208, 16, v151
    v_and_b32 v209, 0xffff0000, v151
    v_pk_fma_f32 v[194:195], v[202:203], v[184:185], v[194:195] op_sel:[0,1,0] op_sel_hi:[1,1,1]
    v_pk_fma_f32 v[196:197], v[204:205], v[184:185], v[196:197] op_sel:[0,1,0] op_sel_hi:[1,1,1]
    v_pk_fma_f32 v[198:199], v[206:207], v[184:185], v[198:199] op_sel:[0,1,0] op_sel_hi:[1,1,1]
    v_pk_fma_f32 v[200:201], v[208:209], v[184:185], v[200:201] op_sel:[0,1,0] op_sel_hi:[1,1,1]
    v_lshlrev_b32 v202, 16, v152
    v_and_b32 v203, 0xffff0000, v152
    v_lshlrev_b32 v204, 16, v153
    v_and_b32 v205, 0xffff0000, v153
    v_lshlrev_b32 v206, 16, v154
    v_and_b32 v207, 0xffff0000, v154
    v_lshlrev_b32 v208, 16, v155
    v_and_b32 v209, 0xffff0000, v155
    v_pk_fma_f32 v[194:195], v[202:203], v[186:187], v[194:195] op_sel:[0,0,0] op_sel_hi:[1,0,1]
    v_pk_fma_f32 v[196:197], v[204:205], v[186:187], v[196:197] op_sel:[0,0,0] op_sel_hi:[1,0,1]
    v_pk_fma_f32 v[198:199], v[206:207], v[186:187], v[198:199] op_sel:[0,0,0] op_sel_hi:[1,0,1]
    v_pk_fma_f32 v[200:201], v[208:209], v[186:187], v[200:201] op_sel:[0,0,0] op_sel_hi:[1,0,1]
    v_lshlrev_b32 v202, 16, v156
    v_and_b32 v203, 0xffff0000, v156
    v_lshlrev_b32 v204, 16, v157
    v_and_b32 v205, 0xffff0000, v157
    v_lshlrev_b32 v206, 16, v158
    v_and_b32 v207, 0xffff0000, v158
    v_lshlrev_b32 v208, 16, v159
    v_and_b32 v209, 0xffff0000, v159
    v_pk_fma_f32 v[194:195], v[202:203], v[186:187], v[194:195] op_sel:[0,1,0] op_sel_hi:[1,1,1]
    v_pk_fma_f32 v[196:197], v[204:205], v[186:187], v[196:197] op_sel:[0,1,0] op_sel_hi:[1,1,1]
    v_pk_fma_f32 v[198:199], v[206:207], v[186:187], v[198:199] op_sel:[0,1,0] op_sel_hi:[1,1,1]
    v_pk_fma_f32 v[200:201], v[208:209], v[186:187], v[200:201] op_sel:[0,1,0] op_sel_hi:[1,1,1]
    v_lshlrev_b32 v202, 16, v160
    v_and_b32 v203, 0xffff0000, v160
    v_lshlrev_b32 v204, 16, v161
    v_and_b32 v205, 0xffff0000, v161
    v_lshlrev_b32 v206, 16, v162
    v_and_b32 v207, 0xffff0000, v162
    v_lshlrev_b32 v208, 16, v163
    v_and_b32 v209, 0xffff0000, v163
    v_pk_fma_f32 v[194:195], v[202:203], v[188:189], v[194:195] op_sel:[0,0,0] op_sel_hi:[1,0,1]
    v_pk_fma_f32 v[196:197], v[204:205], v[188:189], v[196:197] op_sel:[0,0,0] op_sel_hi:[1,0,1]
    v_pk_fma_f32 v[198:199], v[206:207], v[188:189], v[198:199] op_sel:[0,0,0] op_sel_hi:[1,0,1]
    v_pk_fma_f32 v[200:201], v[208:209], v[188:189], v[200:201] op_sel:[0,0,0] op_sel_hi:[1,0,1]
    v_lshrrev_b32 v202, 4, v5
    v_and_b32 v203, 3, v5
    v_permlane32_swap_b32 v194, v198
    v_permlane32_swap_b32 v195, v199
    v_permlane32_swap_b32 v196, v200
    v_permlane32_swap_b32 v197, v201
    v_add_f32 v194, v194, v198
    v_add_f32 v195, v195, v199
    v_add_f32 v196, v196, v200
    v_add_f32 v197, v197, v201
    v_lshl_add_u32 v202, v203, 2, v202
    s_lshl_b32 s50, s3, 7
    v_permlane16_swap_b32 v194, v196
    v_permlane16_swap_b32 v195, v197
    v_add_f32 v194, v194, v196
    v_add_f32 v195, v195, v197
    s_add_u32 s50, s50, 158720
    s_nop 0
    v_add_f32_dpp v194, v194, v194 row_ror:8 row_mask:0xf bank_mask:0xf
    v_add_f32_dpp v195, v195, v195 row_ror:8 row_mask:0xf bank_mask:0xf
    s_nop 1
    v_add_f32_dpp v194, v194, v194 row_ror:4 row_mask:0xf bank_mask:0xf
    v_add_f32_dpp v195, v195, v195 row_ror:4 row_mask:0xf bank_mask:0xf
    v_lshl_add_u32 v202, v202, 3, s50
    ds_write_b64 v202, v[194:195]
    s_waitcnt lgkmcnt(0)
    s_barrier
    v_add_u32 v202, 158720, v252
    ds_read_b32 v194, v202
    ds_read_b32 v196, v202 offset:128
    ds_read_b32 v197, v202 offset:256
    ds_read_b32 v198, v202 offset:384
    s_lshl_b32 s89, s38, 2
    s_and_b32 s52, s37, 1
    s_mul_i32 s52, s52, 30720
    s_add_u32 s89, s89, s52
    s_add_u32 s89, s89, 524288
    v_cmp_gt_u32 vcc, 32, v0
    v_mov_b32 v203, 0x80000000
    v_lshlrev_b32 v199, 3, v5
    v_mov_b32 v195, v4
    v_cndmask_b32 v203, v203, v199, vcc
    v_or_b32 v203, s36, v203
    s_waitcnt lgkmcnt(0)
    v_add_f32 v194, v194, v196
    v_add_f32 v197, v197, v198
    v_add_f32 v194, v194, v197
    s_waitcnt vmcnt(0)
    s_branch wi_11
wh_10:
    v_lshlrev_b32 v64, 16, v16
    v_and_b32 v65, 0xffff0000, v16
    v_lshlrev_b32 v66, 16, v17
    v_and_b32 v67, 0xffff0000, v17
    v_lshlrev_b32 v68, 16, v18
    v_and_b32 v69, 0xffff0000, v18
    v_lshlrev_b32 v70, 16, v19
    v_and_b32 v71, 0xffff0000, v19
    v_lshlrev_b32 v72, 16, v20
    v_and_b32 v73, 0xffff0000, v20
    v_lshlrev_b32 v74, 16, v21
    v_and_b32 v75, 0xffff0000, v21
    v_lshlrev_b32 v76, 16, v22
    v_and_b32 v77, 0xffff0000, v22
    v_lshlrev_b32 v78, 16, v23
    v_and_b32 v79, 0xffff0000, v23
    v_lshlrev_b32 v80, 16, v24
    v_and_b32 v81, 0xffff0000, v24
    v_lshlrev_b32 v82, 16, v25
    v_and_b32 v83, 0xffff0000, v25
    v_lshlrev_b32 v84, 16, v26
    v_and_b32 v85, 0xffff0000, v26
    v_lshlrev_b32 v86, 16, v27
    v_and_b32 v87, 0xffff0000, v27
    v_pk_add_f32 v[30:31], v[64:65], v[66:67]
    v_pk_mul_f32 v[32:33], v[64:65], v[64:65]
    v_pk_fma_f32 v[32:33], v[66:67], v[66:67], v[32:33]
    v_pk_add_f32 v[30:31], v[30:31], v[68:69]
    v_pk_fma_f32 v[32:33], v[68:69], v[68:69], v[32:33]
    v_pk_add_f32 v[30:31], v[30:31], v[70:71]
    v_pk_fma_f32 v[32:33], v[70:71], v[70:71], v[32:33]
    v_pk_add_f32 v[30:31], v[30:31], v[72:73]
    v_pk_fma_f32 v[32:33], v[72:73], v[72:73], v[32:33]
    v_pk_add_f32 v[30:31], v[30:31], v[74:75]
    v_pk_fma_f32 v[32:33], v[74:75], v[74:75], v[32:33]
    v_pk_add_f32 v[30:31], v[30:31], v[76:77]
    v_pk_fma_f32 v[32:33], v[76:77], v[76:77], v[32:33]
    v_pk_add_f32 v[30:31], v[30:31], v[78:79]
    v_pk_fma_f32 v[32:33], v[78:79], v[78:79], v[32:33]
    v_pk_add_f32 v[30:31], v[30:31], v[80:81]
    v_pk_fma_f32 v[32:33], v[80:81], v[80:81], v[32:33]
    v_pk_add_f32 v[30:31], v[30:31], v[82:83]
    v_pk_fma_f32 v[32:33], v[82:83], v[82:83], v[32:33]
    v_pk_add_f32 v[30:31], v[30:31], v[84:85]
    v_pk_fma_f32 v[32:33], v[84:85], v[84:85], v[32:33]
    v_pk_add_f32 v[30:31], v[30:31], v[86:87]
    v_pk_fma_f32 v[32:33], v[86:87], v[86:87], v[32:33]
    v_add_f32 v30, v30, v31
    v_add_f32 v31, v32, v33
    s_nop 0
    v_add_f32_dpp v30, v30, v30 row_ror:8 row_mask:0xf bank_mask:0xf
    v_add_f32_dpp v31, v31, v31 row_ror:8 row_mask:0xf bank_mask:0xf
    v_mov_b32 v32, v30
    v_mov_b32 v33, v31
    s_nop 0
    v_permlane16_swap_b32 v30, v32
    v_permlane16_swap_b32 v31, v33
    v_pk_add_f32 v[30:31], v[30:31], v[32:33]
    v_mov_b32 v32, v30
    v_mov_b32 v33, v31
    s_nop 0
    v_permlane32_swap_b32 v30, v32
    v_permlane32_swap_b32 v31, v33
    v_pk_add_f32 v[30:31], v[30:31], v[32:33]
    ds_write_b64 v28, v[30:31]
    s_waitcnt lgkmcnt(0)
    s_barrier
    ds_read_b128 v[52:55], v29
    ds_read_b128 v[56:59], v29 offset:16
    s_waitcnt lgkmcnt(0)
    v_pk_add_f32 v[52:53], v[52:53], v[54:55]
    v_pk_add_f32 v[56:57], v[56:57], v[58:59]
    v_pk_add_f32 v[52:53], v[52:53], v[56:57]
    v_mul_f32 v52, 0xbacccccd, v52
    v_mul_f32 v53, 0x3acccccd, v53
    v_fma_f32 v53, -v52, v52, v53
    v_max_f32 v53, 0, v53
    v_add_f32 v53, 0x3727c5ac, v53
    v_rsq_f32 v54, v53
    v_pk_add_f32 v[64:65], v[64:65], v[52:53] op_sel_hi:[1,0]
    v_pk_add_f32 v[66:67], v[66:67], v[52:53] op_sel_hi:[1,0]
    v_pk_add_f32 v[68:69], v[68:69], v[52:53] op_sel_hi:[1,0]
    v_pk_add_f32 v[70:71], v[70:71], v[52:53] op_sel_hi:[1,0]
    v_pk_add_f32 v[72:73], v[72:73], v[52:53] op_sel_hi:[1,0]
    v_pk_add_f32 v[74:75], v[74:75], v[52:53] op_sel_hi:[1,0]
    v_pk_add_f32 v[76:77], v[76:77], v[52:53] op_sel_hi:[1,0]
    v_pk_add_f32 v[78:79], v[78:79], v[52:53] op_sel_hi:[1,0]
    v_pk_add_f32 v[80:81], v[80:81], v[52:53] op_sel_hi:[1,0]
    v_pk_add_f32 v[82:83], v[82:83], v[52:53] op_sel_hi:[1,0]
    v_pk_add_f32 v[84:85], v[84:85], v[52:53] op_sel_hi:[1,0]
    v_pk_add_f32 v[86:87], v[86:87], v[52:53] op_sel_hi:[1,0]
    v_pk_mul_f32 v[64:65], v[64:65], v[54:55] op_sel_hi:[1,0]
    v_pk_mul_f32 v[66:67], v[66:67], v[54:55] op_sel_hi:[1,0]
    v_pk_mul_f32 v[68:69], v[68:69], v[54:55] op_sel_hi:[1,0]
    v_pk_mul_f32 v[70:71], v[70:71], v[54:55] op_sel_hi:[1,0]
    v_pk_mul_f32 v[72:73], v[72:73], v[54:55] op_sel_hi:[1,0]
    v_pk_mul_f32 v[74:75], v[74:75], v[54:55] op_sel_hi:[1,0]
    v_pk_mul_f32 v[76:77], v[76:77], v[54:55] op_sel_hi:[1,0]
    v_pk_mul_f32 v[78:79], v[78:79], v[54:55] op_sel_hi:[1,0]
    v_pk_mul_f32 v[80:81], v[80:81], v[54:55] op_sel_hi:[1,0]
    v_pk_mul_f32 v[82:83], v[82:83], v[54:55] op_sel_hi:[1,0]
    v_pk_mul_f32 v[84:85], v[84:85], v[54:55] op_sel_hi:[1,0]
    v_pk_mul_f32 v[86:87], v[86:87], v[54:55] op_sel_hi:[1,0]
wi_11:
    s_waitcnt vmcnt(0)
    v_max_u32 v112, v89, v91
    v_min_u32 v89, v89, v91
    v_max3_u32 v112, v112, v93, v95
    v_min3_u32 v89, v89, v93, v95
    v_max3_u32 v112, v112, v97, v99
    v_min3_u32 v89, v89, v97, v99
    v_max3_u32 v112, v112, v101, v103
    v_min3_u32 v89, v89, v101, v103
    v_max3_u32 v112, v112, v105, v107
    v_min3_u32 v89, v89, v105, v107
    v_max3_u32 v112, v112, v109, v111
    v_min3_u32 v89, v89, v109, v111
    v_cmp_ne_u32 vcc, s6, v112
    v_cmp_ne_u32 s[60:61], s6, v89
    s_or_b64 vcc, vcc, s[60:61]
    s_cbranch_vccnz cold_12
coldr_13:
    v_add_f32 v88, v88, v92
    v_add_f32 v90, v90, v94
    v_cvt_pk_bf16_f32 v90, v88, v90
    v_lshlrev_b32 v88, 16, v90
    v_and_b32 v89, 0xffff0000, v90
    ds_write_b64 v167, v[88:89] offset:0
    v_add_f32 v96, v96, v100
    v_add_f32 v98, v98, v102
    v_cvt_pk_bf16_f32 v98, v96, v98
    v_lshlrev_b32 v96, 16, v98
    v_and_b32 v97, 0xffff0000, v98
    v_add_f32 v96, v170, v96
    v_add_f32 v97, v170, v97
    v_cvt_pk_bf16_f32 v98, v96, v97
    v_lshlrev_b32 v96, 16, v98
    v_and_b32 v97, 0xffff0000, v98
    ds_write_b64 v168, v[96:97] offset:0
    v_add_f32 v104, v104, v108
    v_add_f32 v106, v106, v110
    v_cvt_pk_bf16_f32 v106, v104, v106
    v_lshlrev_b32 v104, 16, v106
    v_and_b32 v105, 0xffff0000, v106
    v_add_f32 v104, 1.0, v104
    v_add_f32 v105, 1.0, v105
    v_cvt_pk_bf16_f32 v106, v104, v105
    v_lshlrev_b32 v104, 16, v106
    v_and_b32 v105, 0xffff0000, v106
    ds_write_b64 v169, v[104:105] offset:0
    s_mov_b64 exec, 1073741823
    v_mov_b32 v50, 0
    buffer_atomic_or v50, v252, s[8:11], s48 offen sc0 sc1
    s_mov_b64 exec, -1
    s_waitcnt lgkmcnt(0)
    ds_read_b128 v[16:19], v51 offset:0
    ds_read_b128 v[20:23], v51 offset:16
    ds_read_b128 v[24:27], v51 offset:2560
    ds_read_b128 v[28:31], v51 offset:2576
    ds_read_b128 v[32:35], v51 offset:256
    ds_read_b128 v[36:39], v51 offset:272
    ds_read_b128 v[40:43], v51 offset:2816
    ds_read_b128 v[44:47], v51 offset:2832
    ds_read_b128 v[88:91], v51 offset:512
    ds_read_b128 v[92:95], v51 offset:528
    ds_read_b128 v[96:99], v51 offset:3072
    ds_read_b128 v[100:103], v51 offset:3088
    s_waitcnt lgkmcnt(8)
    v_pk_fma_f32 v[16:17], v[24:25], v[64:65], v[16:17]
    v_pk_fma_f32 v[18:19], v[26:27], v[66:67], v[18:19]
    v_pk_fma_f32 v[20:21], v[28:29], v[68:69], v[20:21]
    v_pk_fma_f32 v[22:23], v[30:31], v[70:71], v[22:23]
    v_cvt_pk_bf16_f32 v112, v16, v17
    v_cvt_pk_bf16_f32 v113, v18, v19
    v_cvt_pk_bf16_f32 v114, v20, v21
    v_cvt_pk_bf16_f32 v115, v22, v23
    buffer_store_dwordx4 v[112:115], v124, s[8:11], s44 offen sc1
    s_waitcnt lgkmcnt(4)
    v_pk_fma_f32 v[32:33], v[40:41], v[72:73], v[32:33]
    v_pk_fma_f32 v[34:35], v[42:43], v[74:75], v[34:35]
    v_pk_fma_f32 v[36:37], v[44:45], v[76:77], v[36:37]
    v_pk_fma_f32 v[38:39], v[46:47], v[78:79], v[38:39]
    v_cvt_pk_bf16_f32 v116, v32, v33
    v_cvt_pk_bf16_f32 v117, v34, v35
    v_cvt_pk_bf16_f32 v118, v36, v37
    v_cvt_pk_bf16_f32 v119, v38, v39
    buffer_store_dwordx4 v[116:119], v124, s[8:11], s45 offen sc1
    s_waitcnt lgkmcnt(0)
    v_pk_fma_f32 v[88:89], v[96:97], v[80:81], v[88:89]
    v_pk_fma_f32 v[90:91], v[98:99], v[82:83], v[90:91]
    v_pk_fma_f32 v[92:93], v[100:101], v[84:85], v[92:93]
    v_pk_fma_f32 v[94:95], v[102:103], v[86:87], v[94:95]
    v_cvt_pk_bf16_f32 v120, v88, v89
    v_cvt_pk_bf16_f32 v121, v90, v91
    v_cvt_pk_bf16_f32 v122, v92, v93
    v_cvt_pk_bf16_f32 v123, v94, v95
    buffer_store_dwordx4 v[120:123], v125, s[8:11], s46 offen sc1
    buffer_store_dwordx2 v[194:195], v203, s[8:11], s89 offen sc1
    s_waitcnt vmcnt(4)
    s_mov_b64 exec, 1073741823
    v_cmp_ne_u32 vcc, s6, v50
    s_mov_b64 exec, -1
    s_cbranch_vccnz cold_16
coldr_17:
    s_barrier
    s_add_u32 m0, s39, 0
    s_add_u32 s42, s42, 16384
    buffer_load_dwordx4 v228, s[8:11], s42 offen offset:0 sc1 lds
    buffer_load_dwordx4 v229, s[8:11], s42 offen offset:1024 sc1 lds
    buffer_load_dwordx4 v230, s[8:11], s42 offen offset:2048 sc1 lds
    buffer_load_dwordx4 v228, s[8:11], s42 offen offset:3072 sc1 lds
    s_add_u32 m0, s39, 16384
    s_add_u32 s42, s42, 16384
    buffer_load_dwordx4 v229, s[8:11], s42 offen offset:0 sc1 lds
    buffer_load_dwordx4 v230, s[8:11], s42 offen offset:1024 sc1 lds
    buffer_load_dwordx4 v228, s[8:11], s42 offen offset:2048 sc1 lds
    buffer_load_dwordx4 v229, s[8:11], s42 offen offset:3072 sc1 lds
    s_waitcnt vmcnt(9)
    buffer_atomic_swap v4, v7, s[8:11], s90 offen offset:0 sc1
    s_add_u32 m0, s39, 32768
    s_add_u32 s42, s42, 16384
    buffer_load_dwordx4 v230, s[8:11], s42 offen offset:0 sc1 lds
    buffer_load_dwordx4 v228, s[8:11], s42 offen offset:1024 sc1 lds
    buffer_load_dwordx4 v229, s[8:11], s42 offen offset:2048 sc1 lds
    buffer_load_dwordx4 v230, s[8:11], s42 offen offset:3072 sc1 lds
    s_add_u32 m0, s39, 49152
    s_add_u32 s42, s42, 16384
    buffer_load_dwordx4 v228, s[8:11], s42 offen offset:0 sc1 lds
    buffer_load_dwordx4 v229, s[8:11], s42 offen offset:1024 sc1 lds
    buffer_load_dwordx4 v230, s[8:11], s42 offen offset:2048 sc1 lds
    buffer_load_dwordx4 v228, s[8:11], s42 offen offset:3072 sc1 lds
    s_mov_b64 exec, 65535
    v_mov_b32 v16, 0
    buffer_atomic_or v16, v252, s[8:11], s91 offen sc0 sc1
    s_mov_b64 exec, -1
    s_add_u32 m0, s39, 65536
    s_add_u32 s42, s42, 16384
    buffer_load_dwordx4 v229, s[8:11], s42 offen offset:0 sc1 lds
    buffer_load_dwordx4 v230, s[8:11], s42 offen offset:1024 sc1 lds
    buffer_load_dwordx4 v228, s[8:11], s42 offen offset:2048 sc1 lds
    buffer_load_dwordx4 v229, s[8:11], s42 offen offset:3072 sc1 lds
    s_lshl_b32 s65, s3, 13
    s_add_u32 s65, s65, 114688
    v_bfe_u32 v41, v5, 2, 2
    v_and_b32 v42, 3, v5
    v_lshrrev_b32 v43, 2, v5
    v_mov_b32 v227, 0x80000000
    s_cmp_ge_u32 s2, 120
    s_cbranch_scc1 cold_21
    s_mul_hi_u32 s56, s2, 858993460
    s_mul_i32 s55, s56, 5
    s_sub_u32 s55, s2, s55
    s_lshr_b32 s54, s3, 1
    s_and_b32 s62, s3, 1
    s_cmp_eq_u32 s54, 1
    s_cselect_b32 s32, s74, s72
    s_cselect_b32 s33, s75, s73
    s_mov_b32 s34, 1966080
    s_lshl_b32 s57, s56, 1
    s_add_u32 s57, s57, s62
    s_mul_i32 s64, s55, 393216
    s_lshl_b32 s58, s57, 6
    s_add_u32 s64, s64, s58
    s_mov_b32 s66, 49152
    s_mov_b32 s67, 49152
    v_mul_u32_u24 v43, 3072, v43
    v_lshl_add_u32 v224, v42, 4, v43
    v_lshrrev_b32 v43, 5, v5
    v_lshl_add_u32 v41, v43, 3, v41
    v_lshlrev_b32 v41, 6, v41
    v_bfe_u32 v42, v5, 4, 1
    v_lshl_add_u32 v41, v42, 5, v41
    v_bfe_u32 v42, v5, 1, 1
    v_lshl_add_u32 v41, v42, 3, v41
    v_and_b32 v42, 1, v5
    v_lshl_add_u32 v41, v42, 4, v41
    v_add_u32 v225, s65, v41
    v_add_u32 v211, 1024, v225
    v_mov_b32 v212, v225
    v_mul_u32_u24 v42, 1280, v42
    v_lshlrev_b32 v41, 4, v43
    v_sub_u32 v41, v41, v42
    s_lshl_b32 s58, s55, 8
    s_add_u32 s58, s58, 150016
    v_add_u32 v226, s58, v41
    v_cmp_eq_u32 vcc, 0, v43
    v_lshlrev_b32 v41, 3, v5
    s_nop 0
    v_cndmask_b32 v227, v227, v41, vcc
    s_mul_hi_u32 s58, s57, 1431655766
    s_mul_i32 s59, s58, 3
    s_sub_u32 s57, s57, s59
    s_lshl_b32 s59, s57, 1
    s_add_u32 s59, s59, s54
    s_mul_i32 s79, s59, 5
    s_add_u32 s79, s79, s55
    s_lshl_b32 s63, s58, 5
    s_add_u32 s79, s79, s63
    s_lshl_b32 s79, s79, 2
    s_add_u32 s79, s79, 154624
    s_mul_i32 s78, s58, 6
    s_add_u32 s78, s78, s59
    s_lshl_b32 s78, s78, 11
    s_lshl_b32 s63, s55, 8
    s_add_u32 s78, s78, s63
    s_add_u32 s78, s78, 196608
    s_mul_i32 s58, s58, 245760
    s_cmp_ge_u32 s59, 3
    s_cselect_b32 s57, 117, 0
    s_cselect_b32 s71, 1, 3
    s_cmp_ge_u32 s59, 4
    s_cselect_b32 s57, 156, s57
    s_cselect_b32 s71, 2, s71
    s_add_u32 s59, s59, s57
    s_lshl_b32 s57, s55, 3
    s_mul_i32 s57, s57, s71
    s_add_u32 s59, s59, s57
    s_lshl_b32 s59, s59, 10
    s_lshl_b32 s71, s71, 10
    s_add_u32 s58, s58, s59
    s_add_u32 s70, s58, 6815744
    v_mov_b32 v210, v1
ssJ_20:
    s_mov_b64 exec, 0
    s_cmp_eq_u32 s3, 0
    s_cbranch_scc1 L_pg0_0
    s_cmp_eq_u32 s3, 1
    s_cbranch_scc1 L_pg0_1
    s_cmp_eq_u32 s3, 2
    s_cbranch_scc1 L_pg0_2
    s_cmp_eq_u32 s3, 3
    s_cbranch_scc1 L_pg0_3
L_wr0:
    s_mov_b64 exec, -1
    s_waitcnt vmcnt(4)
    s_mov_b64 exec, 65535
    v_cmp_ne_u32 vcc, s6, v16
    s_mov_b64 exec, -1
    s_cbranch_vccnz cold_22
coldr_23:
    s_add_u32 s43, s43, 4096
    buffer_load_dwordx4 a[0:3], v1, s[8:11], s43 offen offset:0 sc1
    buffer_load_dwordx4 a[4:7], v1, s[8:11], s43 offen offset:1024 sc1
    buffer_load_dwordx4 a[8:11], v1, s[8:11], s43 offen offset:2048 sc1
    buffer_load_dwordx4 a[12:15], v1, s[8:11], s43 offen offset:3072 sc1
    s_add_u32 s43, s43, 4096
    buffer_load_dwordx4 a[16:19], v1, s[8:11], s43 offen offset:0 sc1
    buffer_load_dwordx4 a[20:23], v1, s[8:11], s43 offen offset:1024 sc1
    buffer_load_dwordx4 a[24:27], v1, s[8:11], s43 offen offset:2048 sc1
    buffer_load_dwordx4 a[28:31], v1, s[8:11], s43 offen offset:3072 sc1
    s_add_u32 s43, s43, 4096
    buffer_load_dwordx4 a[32:35], v1, s[8:11], s43 offen offset:0 sc1
    buffer_load_dwordx4 a[36:39], v1, s[8:11], s43 offen offset:1024 sc1
    s_barrier
    ds_read_b128 a[160:163], v1 offset:0
    ds_read_b128 a[164:167], v1 offset:1024
    ds_read_b128 a[168:171], v1 offset:2048
    ds_read_b128 a[172:175], v1 offset:3072
    ds_read_b128 a[176:179], v1 offset:4096
    ds_read_b128 a[180:183], v1 offset:5120
    s_waitcnt vmcnt(9) lgkmcnt(5)
    v_mfma_f32_32x32x16_bf16 v[64:79], a[160:163], a[0:3], 0
    ds_read_b128 a[160:163], v1 offset:6144
    buffer_load_dwordx4 a[40:43], v1, s[8:11], s43 offen offset:2048 sc1
    s_waitcnt lgkmcnt(4)
    v_mfma_f32_32x32x16_bf16 v[80:95], a[164:167], a[0:3], 0
    ds_read_b128 a[164:167], v1 offset:7168
    v_min_u32 v241, 119, v0
    v_cmp_lt_u32 vcc, 39, v241
    s_mov_b32 s56, 79
    v_cmp_lt_u32 s[58:59], s56, v241
    v_mov_b32 v242, 600
    v_mfma_f32_32x32x16_bf16 v[96:111], a[168:171], a[0:3], 0
    ds_read_b128 a[168:171], v1 offset:8192
    buffer_load_dwordx4 a[44:47], v1, s[8:11], s43 offen offset:3072 sc1
    s_waitcnt vmcnt(10) lgkmcnt(5)
    v_mfma_f32_32x32x16_bf16 v[64:79], a[172:175], a[4:7], v[64:79]
    ds_read_b128 a[172:175], v1 offset:9216
    v_mov_b32 v243, 880
    v_cndmask_b32 v242, 0, v242, vcc
    v_cndmask_b32 v245, 0, 1.0, vcc
    v_cndmask_b32 v242, v242, v243, s[58:59]
    s_waitcnt lgkmcnt(4)
    v_mfma_f32_32x32x16_bf16 v[80:95], a[176:179], a[4:7], v[80:95]
    ds_read_b128 a[176:179], v1 offset:10240
    s_add_u32 s43, s43, 4096
    buffer_load_dwordx4 a[48:51], v1, s[8:11], s43 offen offset:0 sc1
    v_cndmask_b32 v245, v245, 0, s[58:59]
    v_mfma_f32_32x32x16_bf16 v[96:111], a[180:183], a[4:7], v[96:111]
    ds_read_b128 a[180:183], v1 offset:11264
    s_mul_i32 s56, s41, 40
    v_add3_u32 v241, v241, v242, s56
    s_mul_hi_u32 s56, s2, 858993460
    s_mul_i32 s56, s56, 5
    s_waitcnt vmcnt(10) lgkmcnt(5)
    v_mfma_f32_32x32x16_bf16 v[64:79], a[160:163], a[8:11], v[64:79]
    ds_read_b128 a[160:163], v1 offset:12288
    buffer_load_dwordx4 a[52:55], v1, s[8:11], s43 offen offset:1024 sc1
    s_waitcnt lgkmcnt(4)
    v_mfma_f32_32x32x16_bf16 v[80:95], a[164:167], a[8:11], v[80:95]
    ds_read_b128 a[164:167], v1 offset:13312
    s_sub_u32 s56, s2, s56
    s_lshl_b32 s56, s56, 6
    s_cmp_eq_u32 s3, 3
    s_cselect_b32 s57, 320, 0
    s_cselect_b32 s55, 1.0, 0
    v_mfma_f32_32x32x16_bf16 v[96:111], a[168:171], a[8:11], v[96:111]
    ds_read_b128 a[168:171], v1 offset:14336
    buffer_load_dwordx4 a[56:59], v1, s[8:11], s43 offen offset:2048 sc1
    s_waitcnt vmcnt(11) lgkmcnt(5)
    v_mfma_f32_32x32x16_bf16 v[64:79], a[172:175], a[12:15], v[64:79]
    ds_read_b128 a[172:175], v1 offset:15360
    s_add_u32 s56, s56, s57
    s_add_u32 s56, s56, 320
    v_add_u32 v242, s56, v5
    v_mov_b32 v246, s55
    s_waitcnt lgkmcnt(4)
    v_mfma_f32_32x32x16_bf16 v[80:95], a[176:179], a[12:15], v[80:95]
    ds_read_b128 a[176:179], v1 offset:16384
    buffer_load_dwordx4 a[60:63], v1, s[8:11], s43 offen offset:3072 sc1
    v_mfma_f32_32x32x16_bf16 v[96:111], a[180:183], a[12:15], v[96:111]
    ds_read_b128 a[180:183], v1 offset:17408
    s_cmp_ge_u32 s3, 2
    s_cselect_b64 s[58:59], -1, 0
    v_cndmask_b32 v241, v241, v242, s[58:59]
    v_cndmask_b32 v245, v245, v246, s[58:59]
    s_waitcnt vmcnt(11) lgkmcnt(5)
    v_mfma_f32_32x32x16_bf16 v[64:79], a[160:163], a[16:19], v[64:79]
    ds_read_b128 a[160:163], v1 offset:18432
    s_add_u32 s43, s43, 4096
    buffer_load_dwordx4 a[64:67], v1, s[8:11], s43 offen offset:0 sc1
L_pg0_0:
    s_cbranch_execz L_wr0
    s_waitcnt lgkmcnt(4)
    v_mfma_f32_32x32x16_bf16 v[80:95], a[164:167], a[16:19], v[80:95]
    ds_read_b128 a[164:167], v1 offset:19456
    s_mov_b32 s56, 147456
    v_lshl_add_u32 v243, v241, 2, s56
    v_lshlrev_b32 v241, 4, v241
    s_and_b32 s51, s3, 1
    s_lshr_b32 s52, s3, 1
    v_mfma_f32_32x32x16_bf16 v[96:111], a[168:171], a[16:19], v[96:111]
    ds_read_b128 a[168:171], v1 offset:20480
    s_lshl_b32 s54, s51, 12
    s_lshl_b32 s55, s52, 11
    s_add_u32 s54, s54, s55
    v_add_u32 v11, s54, v1
    s_waitcnt vmcnt(11) lgkmcnt(5)
    v_mfma_f32_32x32x16_bf16 v[64:79], a[172:175], a[20:23], v[64:79]
    ds_read_b128 a[172:175], v1 offset:21504
    buffer_load_dwordx4 a[68:71], v1, s[8:11], s43 offen offset:1024 sc1
    s_waitcnt lgkmcnt(4)
    v_mfma_f32_32x32x16_bf16 v[80:95], a[176:179], a[20:23], v[80:95]
    ds_read_b128 a[176:179], v1 offset:22528
    v_xor_b32 v10, 0x800, v11
    s_lshr_b32 s54, s54, 2
    v_lshlrev_b32 v13, 3, v5
    v_add_u32 v13, s54, v13
    v_xor_b32 v12, 0x200, v13
    v_mfma_f32_32x32x16_bf16 v[96:111], a[180:183], a[20:23], v[96:111]
    ds_read_b128 a[180:183], v1 offset:23552
    buffer_load_dwordx4 a[72:75], v1, s[8:11], s43 offen offset:2048 sc1
    s_waitcnt vmcnt(12) lgkmcnt(5)
    v_mfma_f32_32x32x16_bf16 v[64:79], a[160:163], a[24:27], v[64:79]
    ds_read_b128 a[160:163], v1 offset:24576
    v_add_u32 v12, 67584, v12
    v_add_u32 v13, 67584, v13
    v_lshrrev_b32 v18, 5, v5
    s_mul_i32 s54, s51, 3072
    s_waitcnt lgkmcnt(4)
    v_mfma_f32_32x32x16_bf16 v[80:95], a[164:167], a[24:27], v[80:95]
    ds_read_b128 a[164:167], v1 offset:25600
    buffer_load_dwordx4 a[76:79], v1, s[8:11], s43 offen offset:3072 sc1
    s_add_u32 s54, s54, 69632
    v_mfma_f32_32x32x16_bf16 v[96:111], a[168:171], a[24:27], v[96:111]
    ds_read_b128 a[168:171], v1 offset:26624
    v_lshl_add_u32 v14, v18, 9, s54
    s_mul_i32 s55, s52, 12288
    s_add_u32 s54, s54, s55
    v_add_u32 v58, s54, v1
    s_waitcnt vmcnt(12) lgkmcnt(5)
    v_mfma_f32_32x32x16_bf16 v[64:79], a[172:175], a[28:31], v[64:79]
    ds_read_b128 a[172:175], v1 offset:27648
    s_add_u32 s43, s43, 4096
    buffer_load_dwordx4 a[80:83], v1, s[8:11], s43 offen offset:0 sc1
    s_waitcnt lgkmcnt(4)
    v_mfma_f32_32x32x16_bf16 v[80:95], a[176:179], a[28:31], v[80:95]
    ds_read_b128 a[176:179], v1 offset:28672
    s_lshl_b32 s54, s51, 8
    s_add_u32 s54, s54, 94208
    v_mov_b32 v15, s54
    v_and_b32 v19, 31, v5
    s_mov_b32 s50, 2688
    v_mfma_f32_32x32x16_bf16 v[96:111], a[180:183], a[28:31], v[96:111]
    ds_read_b128 a[180:183], v1 offset:29696
    s_lshl_b32 s63, s2, 2
    s_add_u32 s63, s63, s3
    s_lshl_b32 s63, s63, 7
    s_add_u32 s63, s63, 53248
    v_lshlrev_b32 v49, 6, v5
    v_mov_b32 v48, 0
    s_mov_b64 exec, 3
    buffer_atomic_or v48, v49, s[8:11], s63 offen sc1
    s_mov_b64 exec, -1
    s_waitcnt vmcnt(13) lgkmcnt(5)
    v_mfma_f32_32x32x16_bf16 v[64:79], a[160:163], a[32:35], v[64:79]
    ds_read_b128 a[160:163], v1 offset:30720
    v_lshlrev_b32 v20, 3, v19
    s_lshl_b32 s55, s52, 10
    s_add_u32 s54, s54, s55
    v_lshl_add_u32 v59, v18, 9, v20
    s_waitcnt lgkmcnt(4)
    v_mfma_f32_32x32x16_bf16 v[80:95], a[164:167], a[32:35], v[80:95]
    ds_read_b128 a[164:167], v1 offset:31744
    buffer_load_dwordx4 a[84:87], v1, s[8:11], s43 offen offset:1024 sc1
    v_add_u32 v59, s54, v59
    v_mfma_f32_32x32x16_bf16 v[96:111], a[168:171], a[32:35], v[96:111]
    s_barrier
    ds_read_b128 a[168:171], v1 offset:32768
    v_mad_u32_u24 v8, v18, s50, v20
    v_mul_u32_u24 v21, 320, v18
    v_lshl_add_u32 v21, v19, 4, v21
    v_and_b32 v22, 27, v19
    s_waitcnt vmcnt(13) lgkmcnt(5)
    v_mfma_f32_32x32x16_bf16 v[64:79], a[172:175], a[36:39], v[64:79]
    ds_read_b128 a[172:175], v1 offset:33792
    buffer_load_dwordx4 a[88:91], v1, s[8:11], s43 offen offset:2048 sc1
    s_waitcnt lgkmcnt(4)
    v_mfma_f32_32x32x16_bf16 v[80:95], a[176:179], a[36:39], v[80:95]
    ds_read_b128 a[176:179], v1 offset:34816
    v_cmp_eq_u32 vcc, 24, v22
    v_mov_b32 v22, 0x80000000
    v_mov_b32 v23, 640
    v_cndmask_b32 v22, v22, v23, vcc
    v_cmp_gt_u32 vcc, 20, v19
    v_mfma_f32_32x32x16_bf16 v[96:111], a[180:183], a[36:39], v[96:111]
    ds_read_b128 a[180:183], v1 offset:35840
    s_lshl_b32 s53, s5, 1
    s_add_u32 s53, s53, s51
    v_cndmask_b32 v9, v22, v21, vcc
    s_mul_i32 s53, s53, 172032
    s_waitcnt vmcnt(13) lgkmcnt(5)
    v_mfma_f32_32x32x16_bf16 v[64:79], a[160:163], a[40:43], v[64:79]
    ds_read_b128 a[160:163], v1 offset:36864
    s_add_u32 m0, s39, 81920
    s_add_u32 s42, s42, 16384
    buffer_load_dwordx4 v230, s[8:11], s42 offen offset:0 sc1 lds
    s_waitcnt lgkmcnt(4)
    v_mfma_f32_32x32x16_bf16 v[80:95], a[164:167], a[40:43], v[80:95]
    ds_read_b128 a[164:167], v1 offset:37888
    s_add_u32 s53, s53, 13631488
    s_mul_i32 s54, s52, 5376
    s_add_u32 s46, s53, s54
    s_mov_b32 s47, 0
    v_add_u32 v8, s46, v8
    v_mfma_f32_32x32x16_bf16 v[96:111], a[168:171], a[40:43], v[96:111]
    ds_read_b128 a[168:171], v1 offset:38912
    buffer_load_dwordx4 a[92:95], v1, s[8:11], s43 offen offset:3072 sc1
    s_waitcnt vmcnt(14) lgkmcnt(5)
    v_mfma_f32_32x32x16_bf16 v[64:79], a[172:175], a[44:47], v[64:79]
    ds_read_b128 a[172:175], v1 offset:39936
    v_add_u32 v9, s46, v9
    v_add_u32 v0, s46, v1
    s_lshl_b32 s52, s52, 9
    s_lshl_b32 s86, s5, 10
    s_waitcnt lgkmcnt(4)
    v_mfma_f32_32x32x16_bf16 v[80:95], a[176:179], a[44:47], v[80:95]
    ds_read_b128 a[176:179], v1 offset:40960
    buffer_load_dwordx4 v228, s[8:11], s42 offen offset:1024 sc1 lds
    s_add_u32 s86, s86, s52
    v_mfma_f32_32x32x16_bf16 v[96:111], a[180:183], a[44:47], v[96:111]
    ds_read_b128 a[180:183], v1 offset:41984
    s_and_b32 s52, s4, 1
    s_lshl_b32 s52, s52, 8
    s_add_u32 s86, s86, s52
    v_cmp_gt_u32 vcc, 2, v5
    s_waitcnt vmcnt(14) lgkmcnt(5)
    v_mfma_f32_32x32x16_bf16 v[64:79], a[160:163], a[48:51], v[64:79]
    ds_read_b128 a[160:163], v1 offset:43008
    s_add_u32 s43, s43, 4096
    buffer_load_dwordx4 a[96:99], v1, s[8:11], s43 offen offset:0 sc1
    s_waitcnt lgkmcnt(4)
    v_mfma_f32_32x32x16_bf16 v[80:95], a[164:167], a[48:51], v[80:95]
    ds_read_b128 a[164:167], v1 offset:44032
    v_lshlrev_b32 v20, 8, v5
    v_mov_b32 v21, 0x80000000
    v_cndmask_b32 v253, v21, v20, vcc
    v_add_u32 v254, 2688, v0
    v_add_u32 v255, 2688, v9
    v_mfma_f32_32x32x16_bf16 v[96:111], a[168:171], a[48:51], v[96:111]
    ds_read_b128 a[168:171], v1 offset:45056
    buffer_load_dwordx4 v229, s[8:11], s42 offen offset:2048 sc1 lds
    s_waitcnt vmcnt(15) lgkmcnt(5)
    v_mfma_f32_32x32x16_bf16 v[64:79], a[172:175], a[52:55], v[64:79]
    ds_read_b128 a[172:175], v1 offset:46080
    s_add_u32 s86, s86, 53248
    v_and_b32 v220, 15, v5
    v_lshrrev_b32 v221, 4, v5
    v_mul_u32_u24 v216, 1280, v220
    s_waitcnt lgkmcnt(4)
    v_mfma_f32_32x32x16_bf16 v[80:95], a[176:179], a[52:55], v[80:95]
    ds_read_b128 a[176:179], v1 offset:47104
    buffer_load_dwordx4 v230, s[8:11], s42 offen offset:3072 sc1 lds
    v_lshl_add_u32 v217, v221, 3, v216
    v_mfma_f32_32x32x16_bf16 v[96:111], a[180:183], a[52:55], v[96:111]
    ds_read_b128 a[180:183], v1 offset:48128
    v_lshl_add_u32 v216, v221, 4, v216
    s_mul_i32 s83, s41, 160
    s_mul_i32 s82, s40, 20480
    s_add_u32 s82, s82, s83
    s_waitcnt vmcnt(15) lgkmcnt(5)
    v_mfma_f32_32x32x16_bf16 v[64:79], a[160:163], a[56:59], v[64:79]
    ds_read_b128 a[160:163], v1 offset:49152
    buffer_load_dwordx4 a[100:103], v1, s[8:11], s43 offen offset:1024 sc1
    s_waitcnt lgkmcnt(4)
    v_mfma_f32_32x32x16_bf16 v[80:95], a[164:167], a[56:59], v[80:95]
    ds_read_b128 a[164:167], v1 offset:50176
    s_add_u32 s83, s83, 147456
    v_lshl_add_u32 v218, v221, 4, s83
    v_lshl_add_u32 v219, v221, 3, s83
    v_cmp_gt_u32 vcc, 32, v5
    v_lshrrev_b32 v18, 5, v5
    v_mfma_f32_32x32x16_bf16 v[96:111], a[168:171], a[56:59], v[96:111]
    ds_read_b128 a[168:171], v1 offset:51200
    v_lshlrev_b32 v222, 6, v19
    v_lshl_add_u32 v222, v18, 5, v222
    v_mov_b32 v18, 0x80000000
    v_lshlrev_b32 v247, 3, v5
    s_waitcnt vmcnt(15) lgkmcnt(5)
    v_mfma_f32_32x32x16_bf16 v[64:79], a[172:175], a[60:63], v[64:79]
    ds_read_b128 a[172:175], v1 offset:52224
    buffer_load_dwordx4 a[104:107], v1, s[8:11], s43 offen offset:2048 sc1
    s_waitcnt lgkmcnt(4)
    v_mfma_f32_32x32x16_bf16 v[80:95], a[176:179], a[60:63], v[80:95]
    ds_read_b128 a[176:179], v1 offset:53248
    v_cndmask_b32 v223, v18, v247, vcc
    s_lshl_b32 s51, s41, 7
    s_add_u32 s51, s51, 151552
    s_lshl_b32 s52, s5, 7
    s_add_u32 s52, s52, 154624
    v_mfma_f32_32x32x16_bf16 v[96:111], a[180:183], a[60:63], v[96:111]
    ds_read_b128 a[180:183], v1 offset:54272
    buffer_load_dwordx4 a[108:111], v1, s[8:11], s43 offen offset:3072 sc1
    s_waitcnt vmcnt(16) lgkmcnt(5)
    v_mfma_f32_32x32x16_bf16 v[64:79], a[160:163], a[64:67], v[64:79]
    ds_read_b128 a[160:163], v1 offset:55296
    v_min_u32 v213, 19, v19
    v_min_u32 v214, 29, v19
    v_lshl_add_u32 v213, v213, 2, s51
    v_lshl_add_u32 v214, v214, 2, s52
    s_waitcnt lgkmcnt(4)
    v_mfma_f32_32x32x16_bf16 v[80:95], a[164:167], a[64:67], v[80:95]
    ds_read_b128 a[164:167], v1 offset:56320
    s_add_u32 s43, s43, 4096
    buffer_load_dwordx4 a[112:115], v1, s[8:11], s43 offen offset:0 sc1
    s_lshl_b32 s51, s41, 8
    v_mfma_f32_32x32x16_bf16 v[96:111], a[168:171], a[64:67], v[96:111]
    ds_read_b128 a[168:171], v1 offset:57344
    s_add_u32 s51, s51, 152576
    v_cndmask_b32 v213, v214, v213, vcc
    v_min_u32 v214, 47, v5
    v_lshl_add_u32 v214, v214, 2, s51
    s_waitcnt vmcnt(16) lgkmcnt(5)
    v_mfma_f32_32x32x16_bf16 v[64:79], a[172:175], a[68:71], v[64:79]
    ds_read_b128 a[172:175], v1 offset:58368
    s_add_u32 m0, s39, 98304
    s_add_u32 s42, s42, 16384
    buffer_load_dwordx4 v228, s[8:11], s42 offen offset:0 sc1 lds
    s_waitcnt lgkmcnt(4)
    v_mfma_f32_32x32x16_bf16 v[80:95], a[176:179], a[68:71], v[80:95]
    ds_read_b128 a[176:179], v1 offset:59392
    v_mov_b32 v231, 0x80000000
    s_mul_i32 s84, s5, 6
    s_add_u32 s84, s84, s3
    s_lshl_b32 s84, s84, 11
    s_add_u32 s84, s84, 196608
    v_mfma_f32_32x32x16_bf16 v[96:111], a[180:183], a[68:71], v[96:111]
    ds_read_b128 a[180:183], v1 offset:60416
    buffer_load_dwordx4 v229, s[8:11], s42 offen offset:1024 sc1 lds
    s_waitcnt vmcnt(17) lgkmcnt(5)
    v_mfma_f32_32x32x16_bf16 v[64:79], a[160:163], a[72:75], v[64:79]
    ds_read_b128 a[160:163], v1 offset:61440
    s_and_b32 s85, s3, 1
    s_sub_u32 s85, s85, s3
    s_add_u32 s85, s85, 4
    s_lshl_b32 s85, s85, 11
    s_waitcnt lgkmcnt(4)
    v_mfma_f32_32x32x16_bf16 v[80:95], a[164:167], a[72:75], v[80:95]
    ds_read_b128 a[164:167], v1 offset:62464
    buffer_load_dwordx4 a[116:119], v1, s[8:11], s43 offen offset:1024 sc1
    s_add_u32 s85, s85, s84
    v_mfma_f32_32x32x16_bf16 v[96:111], a[168:171], a[72:75], v[96:111]
    ds_read_b128 a[168:171], v1 offset:63488
    v_mul_u32_u24 v20, 6554, v5
    v_lshrrev_b32 v20, 16, v20
    v_mul_u32_u24 v20, 1120, v20
    v_add_u32 v20, v20, v1
    s_waitcnt vmcnt(17) lgkmcnt(5)
    v_mfma_f32_32x32x16_bf16 v[64:79], a[172:175], a[76:79], v[64:79]
    ds_read_b128 a[172:175], v1 offset:64512
    buffer_load_dwordx4 v230, s[8:11], s42 offen offset:2048 sc1 lds
    s_waitcnt lgkmcnt(4)
    v_mfma_f32_32x32x16_bf16 v[80:95], a[176:179], a[76:79], v[80:95]
    s_waitcnt vmcnt(38)
    s_barrier
    ds_read_b128 a[176:179], v2 offset:0
    v_cmp_gt_u32 vcc, 60, v5
    v_mul_u32_u24 v21, 43, v220
    v_lshrrev_b32 v21, 8, v21
    v_cndmask_b32 v248, v18, v20, vcc
    v_cmp_gt_u32 vcc, 40, v5
    v_mfma_f32_32x32x16_bf16 v[96:111], a[180:183], a[76:79], v[96:111]
    ds_read_b128 a[180:183], v2 offset:1024
    v_mul_u32_u24 v22, 160, v220
    v_lshl_add_u32 v22, v21, 6, v22
    v_cndmask_b32 v249, v18, v20, vcc
    v_add_u32 v22, s65, v22
    s_waitcnt vmcnt(17) lgkmcnt(5)
    v_mfma_f32_32x32x16_bf16 v[64:79], a[160:163], a[80:83], v[64:79]
    ds_read_b128 a[160:163], v2 offset:2048
    buffer_load_dwordx4 a[120:123], v1, s[8:11], s43 offen offset:2048 sc1
    s_waitcnt lgkmcnt(4)
    v_mfma_f32_32x32x16_bf16 v[80:95], a[164:167], a[80:83], v[80:95]
    ds_read_b128 a[164:167], v2 offset:3072
    v_lshl_add_u32 v250, v221, 4, v22
    v_lshl_add_u32 v251, v221, 3, v22
    v_add_u32 v202, s65, v1
    s_xor_b32 s51, s3, 2
    s_lshl_b32 s51, s51, 13
    v_mfma_f32_32x32x16_bf16 v[96:111], a[168:171], a[80:83], v[96:111]
    ds_read_b128 a[168:171], v2 offset:4096
    buffer_load_dwordx4 v228, s[8:11], s42 offen offset:3072 sc1 lds
    s_waitcnt vmcnt(17) lgkmcnt(5)
    v_mfma_f32_32x32x16_bf16 v[64:79], a[172:175], a[84:87], v[64:79]
    ds_read_b128 a[172:175], v2 offset:5120
    s_add_u32 s51, s51, 114688
    v_add_u32 v203, s51, v1
    s_lshr_b32 s52, s3, 1
    s_lshl_b32 s50, s4, 1
    s_waitcnt lgkmcnt(4)
    v_mfma_f32_32x32x16_bf16 v[80:95], a[176:179], a[84:87], v[80:95]
    ds_read_b128 a[176:179], v2 offset:6144
    buffer_load_dwordx4 a[124:127], v1, s[8:11], s43 offen offset:3072 sc1
    s_add_u32 s55, s50, s52
    v_mfma_f32_32x32x16_bf16 v[96:111], a[180:183], a[84:87], v[96:111]
    ds_read_b128 a[180:183], v2 offset:7168
    s_mul_i32 s50, s55, 81920
    s_mul_i32 s51, s5, 1280
    s_add_u32 s50, s50, s51
    s_add_u32 s50, s50, 19398656
    s_waitcnt vmcnt(17) lgkmcnt(5)
    v_mfma_f32_32x32x16_bf16 v[64:79], a[160:163], a[88:91], v[64:79]
    ds_read_b128 a[160:163], v2 offset:8192
    s_add_u32 s43, s43, 4096
    buffer_load_dwordx4 a[128:131], v1, s[8:11], s43 offen offset:0 sc1
    s_waitcnt lgkmcnt(4)
    v_mfma_f32_32x32x16_bf16 v[80:95], a[164:167], a[88:91], v[80:95]
    ds_read_b128 a[164:167], v2 offset:9216
    s_and_b32 s56, s3, 1
    s_lshl_b32 s51, s56, 3
    s_add_u32 s89, s51, s50
    s_mul_i32 s52, s56, 768
    s_add_u32 s88, s50, s52
    v_mfma_f32_32x32x16_bf16 v[96:111], a[168:171], a[88:91], v[96:111]
    ds_read_b128 a[168:171], v2 offset:10240
    buffer_load_dwordx4 a[132:135], v1, s[8:11], s43 offen offset:1024 sc1
    s_waitcnt vmcnt(17) lgkmcnt(5)
    v_mfma_f32_32x32x16_bf16 v[64:79], a[172:175], a[92:95], v[64:79]
    ds_read_b128 a[172:175], v2 offset:11264
    s_add_u32 s90, s88, 40960
    s_add_u32 s91, s89, 40960
    s_lshl_b32 s50, s55, 9
    s_lshl_b32 s51, s5, 1
    s_waitcnt lgkmcnt(4)
    v_mfma_f32_32x32x16_bf16 v[80:95], a[176:179], a[92:95], v[80:95]
    ds_read_b128 a[176:179], v2 offset:12288
    s_add_u32 m0, s39, 114688
    s_add_u32 s42, s42, 16384
    buffer_load_dwordx4 v61, s[8:11], s42 offen offset:0 sc1 lds
    s_add_u32 s51, s51, s56
    v_mfma_f32_32x32x16_bf16 v[96:111], a[180:183], a[92:95], v[96:111]
    ds_read_b128 a[180:183], v2 offset:13312
    s_lshl_b32 s51, s51, 2
    s_add_u32 s50, s50, s51
    s_add_u32 s92, s50, 69632
    s_lshl_b32 s50, s55, 5
    s_waitcnt vmcnt(16) lgkmcnt(5)
    v_mfma_f32_32x32x16_bf16 v[64:79], a[160:163], a[96:99], v[64:79]
    ds_read_b128 a[160:163], v2 offset:14336
    buffer_load_dwordx4 a[136:139], v1, s[8:11], s43 offen offset:2048 sc1
    s_waitcnt lgkmcnt(4)
    v_mfma_f32_32x32x16_bf16 v[80:95], a[164:167], a[96:99], v[80:95]
    ds_read_b128 a[164:167], v2 offset:15360
    s_lshr_b32 s51, s51, 2
    s_add_u32 s50, s50, s51
    s_mul_i32 s36, s50, 2560
    s_add_u32 s36, s36, 22020096
    s_lshl_b32 s37, s50, 7
    v_mfma_f32_32x32x16_bf16 v[96:111], a[168:171], a[96:99], v[96:111]
    s_waitcnt vmcnt(15)
    s_barrier
    ds_read_b128 a[168:171], v2 offset:16384
    s_add_u32 s37, s37, 393216
    s_mul_i32 s38, s50, 6144
    s_add_u32 s38, s38, 24641536
    s_lshr_b32 s77, s40, 1
    s_waitcnt vmcnt(14) lgkmcnt(5)
    v_mfma_f32_32x32x16_bf16 v[64:79], a[172:175], a[100:103], v[64:79]
    ds_read_b128 a[172:175], v2 offset:17408
    buffer_load_dwordx4 v62, s[8:11], s42 offen offset:1024 sc1 lds
    s_waitcnt lgkmcnt(4)
    v_mfma_f32_32x32x16_bf16 v[80:95], a[176:179], a[100:103], v[80:95]
    ds_read_b128 a[176:179], v2 offset:18432
    s_lshl_b32 s77, s77, 8
    s_add_u32 s77, s77, 69632
    s_mov_b64 s[68:69], 0
    s_mov_b64 s[72:73], -1
    s_mov_b64 s[74:75], -1
    v_mfma_f32_32x32x16_bf16 v[96:111], a[180:183], a[100:103], v[96:111]
    ds_read_b128 a[180:183], v2 offset:19456
    buffer_load_dwordx4 v60, s[8:11], s42 offen offset:2048 sc1 lds
    s_waitcnt vmcnt(15) lgkmcnt(5)
    v_mfma_f32_32x32x16_bf16 v[64:79], a[160:163], a[104:107], v[64:79]
    ds_read_b128 a[160:163], v2 offset:20480
    s_mov_b32 s76, 0x5d800000
    v_lshrrev_b32 v16, 5, v5
    v_and_b32 v17, 31, v5
    s_lshl_b32 s50, s5, 7
    s_waitcnt lgkmcnt(4)
    v_mfma_f32_32x32x16_bf16 v[80:95], a[164:167], a[104:107], v[80:95]
    ds_read_b128 a[164:167], v2 offset:21504
    buffer_load_dwordx4 a[140:143], v1, s[8:11], s43 offen offset:3072 sc1
    s_add_u32 s50, s50, s7
    v_mfma_f32_32x32x16_bf16 v[96:111], a[168:171], a[104:107], v[96:111]
    ds_read_b128 a[168:171], v2 offset:22528
    s_mul_i32 s50, s50, 2688
    s_add_u32 s50, s50, 13631488
    s_add_u32 s51, s50, 172032
    s_mov_b32 s52, 172032
    s_waitcnt vmcnt(15) lgkmcnt(5)
    v_mfma_f32_32x32x16_bf16 v[64:79], a[172:175], a[108:111], v[64:79]
    ds_read_b128 a[172:175], v2 offset:23552
    buffer_load_dwordx4 v61, s[8:11], s42 offen offset:3072 sc1 lds
    s_waitcnt lgkmcnt(4)
    v_mfma_f32_32x32x16_bf16 v[80:95], a[176:179], a[108:111], v[80:95]
    ds_read_b128 a[176:179], v2 offset:24576
    s_mov_b32 s53, 0x3ea52b5c
    v_lshlrev_b32 v18, 3, v17
    v_mad_u32_u24 v20, v16, s52, v18
    s_lshl_b32 s54, s3, 8
    s_add_u32 s54, s54, 67584
    v_mfma_f32_32x32x16_bf16 v[96:111], a[180:183], a[108:111], v[96:111]
    ds_read_b128 a[180:183], v2 offset:25600
    s_add_u32 s43, s43, 4096
    buffer_load_dwordx4 a[144:147], v1, s[8:11], s43 offen offset:0 sc1
    s_waitcnt vmcnt(16) lgkmcnt(5)
    v_mfma_f32_32x32x16_bf16 v[64:79], a[160:163], a[112:115], v[64:79]
    ds_read_b128 a[160:163], v2 offset:26624
    v_lshl_add_u32 v21, v16, 10, v18
    v_add_u32 v21, s54, v21
    s_lshl_b32 s54, s3, 10
    s_add_u32 s54, s54, 59392
    s_waitcnt lgkmcnt(4)
    v_mfma_f32_32x32x16_bf16 v[80:95], a[164:167], a[112:115], v[80:95]
    ds_read_b128 a[164:167], v2 offset:27648
    buffer_load_dwordx4 a[148:151], v1, s[8:11], s43 offen offset:1024 sc1
    v_add_u32 v55, s54, v1
    v_mfma_f32_32x32x16_bf16 v[96:111], a[168:171], a[112:115], v[96:111]
    ds_read_b128 a[168:171], v2 offset:28672
    s_mul_i32 s54, s3, 6144
    s_add_u32 s54, s54, 69632
    v_add_u32 v19, s54, v1
    s_lshl_b32 s54, s3, 9
    s_waitcnt vmcnt(14) lgkmcnt(5)
    v_mfma_f32_32x32x16_bf16 v[64:79], a[172:175], a[116:119], v[64:79]
    ds_read_b128 a[172:175], v2 offset:29696
    buffer_load_dwordx4 a[152:155], v1, s[8:11], s43 offen offset:2048 sc1
    s_waitcnt lgkmcnt(4)
    v_mfma_f32_32x32x16_bf16 v[80:95], a[176:179], a[116:119], v[80:95]
    ds_read_b128 a[176:179], v2 offset:30720
    s_add_u32 s54, s54, 94208
    v_lshl_add_u32 v57, v5, 3, s54
    s_mul_i32 s54, s3, 2560
    s_add_u32 s54, s54, 49152
    v_mul_u32_u24 v23, 80, v17
    v_mfma_f32_32x32x16_bf16 v[96:111], a[180:183], a[116:119], v[96:111]
    ds_read_b128 a[180:183], v2 offset:31744
    v_lshl_add_u32 v23, v16, 3, v23
    v_add_u32 v23, s54, v23
    v_bfe_u32 v24, v5, 2, 2
    v_lshl_add_u32 v24, v16, 3, v24
    s_waitcnt vmcnt(13) lgkmcnt(5)
    v_mfma_f32_32x32x16_bf16 v[64:79], a[160:163], a[120:123], v[64:79]
    s_waitcnt vmcnt(12)
    s_barrier
    ds_read_b128 a[160:163], v2 offset:32768
    s_add_u32 m0, s39, 131072
    s_add_u32 s42, s42, 16384
    buffer_load_dwordx4 v1, s[8:11], s42 offen offset:0 sc1 lds
    s_waitcnt lgkmcnt(4)
    v_mfma_f32_32x32x16_bf16 v[80:95], a[164:167], a[120:123], v[80:95]
    ds_read_b128 a[164:167], v2 offset:33792
    v_mul_u32_u24 v24, 80, v24
    v_add_u32 v24, s54, v24
    v_and_b32 v25, 1, v5
    v_lshlrev_b32 v25, 4, v25
    v_bfe_u32 v26, v5, 1, 1
    v_mfma_f32_32x32x16_bf16 v[96:111], a[168:171], a[120:123], v[96:111]
    ds_read_b128 a[168:171], v2 offset:34816
    buffer_load_dwordx4 a[156:159], v1, s[8:11], s43 offen offset:3072 sc1
    s_waitcnt vmcnt(13) lgkmcnt(5)
    v_mfma_f32_32x32x16_bf16 v[64:79], a[172:175], a[124:127], v[64:79]
    ds_read_b128 a[172:175], v2 offset:35840
    v_lshl_add_u32 v25, v26, 3, v25
    v_cmp_gt_u32 vcc, 16, v17
    v_add_u32 v26, 48, v25
    v_mul_u32_u24 v27, 320, v16
    s_waitcnt lgkmcnt(4)
    v_mfma_f32_32x32x16_bf16 v[80:95], a[176:179], a[124:127], v[80:95]
    ds_read_b128 a[176:179], v2 offset:36864
    buffer_load_dwordx4 v1, s[8:11], s42 offen offset:1024 sc1 lds
    v_cndmask_b32 v25, 32, v25, vcc
    v_mfma_f32_32x32x16_bf16 v[96:111], a[180:183], a[124:127], v[96:111]
    ds_read_b128 a[180:183], v2 offset:37888
    v_cndmask_b32 v26, 40, v26, vcc
    v_add_u32 v25, v25, v24
    v_add_u32 v26, v26, v24
    v_lshl_add_u32 v27, v17, 4, v27
    s_waitcnt vmcnt(13) lgkmcnt(5)
    v_mfma_f32_32x32x16_bf16 v[64:79], a[160:163], a[128:131], v[64:79]
    ds_read_b128 a[160:163], v2 offset:38912
    buffer_load_dwordx4 v1, s[8:11], s42 offen offset:2048 sc1 lds
    s_waitcnt lgkmcnt(4)
    v_mfma_f32_32x32x16_bf16 v[80:95], a[164:167], a[128:131], v[80:95]
    ds_read_b128 a[164:167], v2 offset:39936
    v_lshl_add_u32 v28, v16, 2, 20
    v_cmp_lt_u32 vcc, v17, v28
    v_mov_b32 v28, 0x80000000
    v_mov_b32 v29, 0x3f803f80
    v_cndmask_b32 v27, v28, v27, vcc
    v_mfma_f32_32x32x16_bf16 v[96:111], a[168:171], a[128:131], v[96:111]
    ds_read_b128 a[168:171], v2 offset:40960
    buffer_load_dwordx4 v1, s[8:11], s42 offen offset:3072 sc1 lds
    s_waitcnt vmcnt(14) lgkmcnt(5)
    v_mfma_f32_32x32x16_bf16 v[64:79], a[172:175], a[132:135], v[64:79]
    ds_read_b128 a[172:175], v2 offset:41984
    v_cmp_gt_u32 vcc, 20, v17
    s_lshl_b32 s55, s5, 8
    s_lshr_b32 s56, s3, 1
    s_mul_i32 s56, s56, 126
    s_waitcnt lgkmcnt(4)
    v_mfma_f32_32x32x16_bf16 v[80:95], a[176:179], a[132:135], v[80:95]
    ds_read_b128 a[176:179], v2 offset:43008
    s_add_u32 m0, s39, 0
    s_add_u32 s42, s42, 16384
    buffer_load_dwordx4 v1, s[8:11], s42 offen offset:0 sc1 lds
    s_add_u32 s55, s55, s56
    v_mfma_f32_32x32x16_bf16 v[96:111], a[180:183], a[132:135], v[96:111]
    ds_read_b128 a[180:183], v2 offset:44032
    s_add_u32 s55, s55, s3
    s_lshl_b32 s56, s4, 1
    s_add_u32 s55, s55, s56
    s_lshl_b32 s55, s55, 2
    s_waitcnt vmcnt(13) lgkmcnt(5)
    v_mfma_f32_32x32x16_bf16 v[64:79], a[160:163], a[136:139], v[64:79]
    ds_read_b128 a[160:163], v2 offset:45056
    buffer_load_dwordx4 v1, s[8:11], s42 offen offset:1024 sc1 lds
    s_waitcnt lgkmcnt(4)
    v_mfma_f32_32x32x16_bf16 v[80:95], a[164:167], a[136:139], v[80:95]
    ds_read_b128 a[164:167], v2 offset:46080
    s_add_u32 s55, s55, 53248
    s_cmp_eq_u32 s4, 1
    s_cselect_b32 s20, 0, 10752
    s_cmp_eq_u32 s4, 2
    s_cselect_b32 s21, 0, 21504
    v_mfma_f32_32x32x16_bf16 v[96:111], a[168:171], a[136:139], v[96:111]
    ds_read_b128 a[168:171], v2 offset:47104
    s_cmp_eq_u32 s4, 3
    s_cselect_b32 s22, 0, 32256
    s_cmp_eq_u32 s4, 4
    s_cselect_b32 s23, 0, 43008
    s_waitcnt vmcnt(11) lgkmcnt(5)
    v_mfma_f32_32x32x16_bf16 v[64:79], a[172:175], a[140:143], v[64:79]
    ds_read_b128 a[172:175], v2 offset:48128
    buffer_load_dwordx4 v1, s[8:11], s42 offen offset:2048 sc1 lds
    s_waitcnt lgkmcnt(4)
    v_mfma_f32_32x32x16_bf16 v[80:95], a[176:179], a[140:143], v[80:95]
    s_waitcnt vmcnt(11)
    s_barrier
    ds_read_b128 a[176:179], v2 offset:49152
    s_cmp_eq_u32 s4, 5
    s_cselect_b32 s24, 0, 53760
    s_cmp_eq_u32 s4, 6
    s_cselect_b32 s25, 0, 64512
    v_mfma_f32_32x32x16_bf16 v[96:111], a[180:183], a[140:143], v[96:111]
    ds_read_b128 a[180:183], v2 offset:50176
    buffer_load_dwordx4 v1, s[8:11], s42 offen offset:3072 sc1 lds
    s_waitcnt vmcnt(11) lgkmcnt(5)
    v_mfma_f32_32x32x16_bf16 v[64:79], a[160:163], a[144:147], v[64:79]
    ds_read_b128 a[160:163], v2 offset:51200
    s_cmp_eq_u32 s4, 7
    s_cselect_b32 s26, 0, 75264
    s_cmp_eq_u32 s4, 8
    s_cselect_b32 s27, 0, 86016
    s_waitcnt lgkmcnt(4)
    v_mfma_f32_32x32x16_bf16 v[80:95], a[164:167], a[144:147], v[80:95]
    ds_read_b128 a[164:167], v2 offset:52224
    s_mov_b32 s63, 534528
    buffer_load_dwordx4 v[232:235], v241, s[8:11], s63 offen sc1
    v_mfma_f32_32x32x16_bf16 v[96:111], a[168:171], a[144:147], v[96:111]
    ds_read_b128 a[168:171], v2 offset:53248
    s_cmp_eq_u32 s4, 9
    s_cselect_b32 s28, 0, 96768
    s_cmp_eq_u32 s4, 10
    s_cselect_b32 s29, 0, 107520
    s_waitcnt vmcnt(11) lgkmcnt(5)
    v_mfma_f32_32x32x16_bf16 v[64:79], a[172:175], a[148:151], v[64:79]
    ds_read_b128 a[172:175], v2 offset:54272
    s_mov_b32 s63, 565248
    buffer_load_dwordx4 v[236:239], v241, s[8:11], s63 offen sc1
    s_waitcnt lgkmcnt(4)
    v_mfma_f32_32x32x16_bf16 v[80:95], a[176:179], a[148:151], v[80:95]
    ds_read_b128 a[176:179], v2 offset:55296
    s_cmp_eq_u32 s4, 11
    s_cselect_b32 s30, 0, 118272
    s_cmp_eq_u32 s4, 12
    s_cselect_b32 s31, 0, 129024
    v_mfma_f32_32x32x16_bf16 v[96:111], a[180:183], a[148:151], v[96:111]
    ds_read_b128 a[180:183], v2 offset:56320
    s_cmp_eq_u32 s4, 13
    s_cselect_b32 s80, 0, 139776
    s_cmp_eq_u32 s4, 14
    s_cselect_b32 s81, 0, 150528
    s_waitcnt vmcnt(11) lgkmcnt(5)
    v_mfma_f32_32x32x16_bf16 v[64:79], a[160:163], a[152:155], v[64:79]
    ds_read_b128 a[160:163], v2 offset:57344
    s_cmp_eq_u32 s4, 15
    s_cselect_b32 s100, 0, 161280
    v_bfe_u32 v228, v5, 4, 1
    v_mul_u32_u24 v228, 20480, v228
    s_waitcnt lgkmcnt(4)
    v_mfma_f32_32x32x16_bf16 v[80:95], a[164:167], a[152:155], v[80:95]
    ds_read_b128 a[164:167], v2 offset:58368
    v_lshl_add_u32 v228, v220, 4, v228
    v_lshrrev_b32 v230, 5, v5
    v_lshl_add_u32 v229, v230, 8, v228
    v_lshl_or_b32 v228, v230, 31, v228
    v_mfma_f32_32x32x16_bf16 v[96:111], a[168:171], a[152:155], v[96:111]
    ds_read_b128 a[168:171], v2 offset:59392
    s_waitcnt vmcnt(9) lgkmcnt(5)
    v_mfma_f32_32x32x16_bf16 v[64:79], a[172:175], a[156:159], v[64:79]
    ds_read_b128 a[172:175], v2 offset:60416
    s_waitcnt lgkmcnt(4)
    v_mfma_f32_32x32x16_bf16 v[80:95], a[176:179], a[156:159], v[80:95]
    ds_read_b128 a[176:179], v2 offset:61440
    v_mfma_f32_32x32x16_bf16 v[96:111], a[180:183], a[156:159], v[96:111]
    ds_read_b128 a[180:183], v2 offset:62464
    s_waitcnt lgkmcnt(4)
    v_mfma_f32_32x32x16_bf16 v[112:127], a[160:163], a[0:3], 0
    ds_read_b128 a[160:163], v2 offset:63488
    v_mfma_f32_32x32x16_bf16 v[112:127], a[164:167], a[4:7], v[112:127]
    ds_read_b128 a[164:167], v2 offset:64512
L_pg0_1:
    s_cbranch_execz L_wr0
    s_waitcnt lgkmcnt(4)
    v_mfma_f32_32x32x16_bf16 v[112:127], a[168:171], a[8:11], v[112:127]
    s_waitcnt vmcnt(6)
    s_barrier
    ds_read_b128 a[168:171], v3 offset:0
    v_cvt_pk_bf16_f32 v128, v64, v65
    v_cvt_pk_bf16_f32 v129, v66, v67
    v_cvt_pk_bf16_f32 v130, v68, v69
    v_cvt_pk_bf16_f32 v131, v70, v71
    v_mfma_f32_32x32x16_bf16 v[112:127], a[172:175], a[12:15], v[112:127]
    ds_read_b128 a[172:175], v3 offset:1024
    buffer_store_dwordx4 v[128:131], v1, s[8:11], s50 offen sc1
    s_waitcnt lgkmcnt(4)
    v_mfma_f32_32x32x16_bf16 v[112:127], a[176:179], a[16:19], v[112:127]
    ds_read_b128 a[176:179], v3 offset:2048
    v_cvt_pk_bf16_f32 v138, v84, v85
    v_cvt_pk_bf16_f32 v139, v86, v87
    ds_write_b64 v23, v[138:139] offset:0
    v_mfma_f32_32x32x16_bf16 v[112:127], a[180:183], a[20:23], v[112:127]
    ds_read_b128 a[180:183], v3 offset:3072
    v_cvt_pk_bf16_f32 v140, v88, v89
    v_cvt_pk_bf16_f32 v141, v90, v91
    ds_write_b64 v23, v[140:141] offset:16
    s_waitcnt lgkmcnt(6)
    v_mfma_f32_32x32x16_bf16 v[112:127], a[160:163], a[24:27], v[112:127]
    ds_read_b128 a[160:163], v3 offset:4096
    v_cvt_pk_bf16_f32 v132, v72, v73
    v_cvt_pk_bf16_f32 v133, v74, v75
    v_cvt_pk_bf16_f32 v134, v76, v77
    v_cvt_pk_bf16_f32 v135, v78, v79
    v_mfma_f32_32x32x16_bf16 v[112:127], a[164:167], a[28:31], v[112:127]
    ds_read_b128 a[164:167], v3 offset:5120
    buffer_store_dwordx4 v[132:135], v1, s[8:11], s51 offen sc1
    s_waitcnt lgkmcnt(6)
    v_mfma_f32_32x32x16_bf16 v[112:127], a[168:171], a[32:35], v[112:127]
    ds_read_b128 a[168:171], v3 offset:6144
    v_cvt_pk_bf16_f32 v142, v92, v93
    v_cvt_pk_bf16_f32 v143, v94, v95
    ds_write_b64 v23, v[142:143] offset:32
    v_mfma_f32_32x32x16_bf16 v[112:127], a[172:175], a[36:39], v[112:127]
    ds_read_b128 a[172:175], v3 offset:7168
    v_cvt_pk_bf16_f32 v144, v96, v97
    v_cvt_pk_bf16_f32 v145, v98, v99
    ds_write_b64 v23, v[144:145] offset:48
    s_waitcnt lgkmcnt(7)
    v_mfma_f32_32x32x16_bf16 v[112:127], a[176:179], a[40:43], v[112:127]
    ds_read_b128 a[176:179], v3 offset:8192
    v_cvt_pk_bf16_f32 v146, v100, v101
    v_cvt_pk_bf16_f32 v147, v102, v103
    ds_write_b64 v23, v[146:147] offset:64
    v_mfma_f32_32x32x16_bf16 v[112:127], a[180:183], a[44:47], v[112:127]
    ds_read_b128 a[180:183], v3 offset:9216
    v_cvt_pk_bf16_f32 v136, v80, v81
    v_cvt_pk_bf16_f32 v137, v82, v83
    s_waitcnt lgkmcnt(7)
    v_mfma_f32_32x32x16_bf16 v[112:127], a[160:163], a[48:51], v[112:127]
    ds_read_b128 a[160:163], v3 offset:10240
    buffer_store_dwordx2 v[136:137], v20, s[8:11], s50 offen offset:1024 sc1
    v_mfma_f32_32x32x16_bf16 v[112:127], a[164:167], a[52:55], v[112:127]
    ds_read_b128 a[164:167], v3 offset:11264
    s_waitcnt lgkmcnt(3)
    ds_read_b64_tr_b16 v[148:149], v25 offset:0
    ds_read_b64_tr_b16 v[150:151], v25 offset:320
    ds_read_b64_tr_b16 v[152:153], v25 offset:1280
    s_waitcnt lgkmcnt(9)
    v_mfma_f32_32x32x16_bf16 v[112:127], a[168:171], a[56:59], v[112:127]
    ds_read_b128 a[168:171], v3 offset:12288
    ds_read_b64_tr_b16 v[154:155], v25 offset:1600
    ds_read_b64_tr_b16 v[156:157], v26 offset:0
    ds_read_b64_tr_b16 v[158:159], v26 offset:320
    ds_read_b64_tr_b16 v[160:161], v26 offset:1280
    v_mfma_f32_32x32x16_bf16 v[112:127], a[172:175], a[60:63], v[112:127]
    ds_read_b128 a[172:175], v3 offset:13312
    ds_read_b64_tr_b16 v[162:163], v26 offset:1600
    v_mul_f32 v104, s53, v104
    v_mul_f32 v105, s53, v105
    v_mul_f32 v106, s53, v106
    s_waitcnt lgkmcnt(12)
    v_mfma_f32_32x32x16_bf16 v[112:127], a[176:179], a[64:67], v[112:127]
    ds_read_b128 a[176:179], v3 offset:14336
    v_mul_f32 v107, s53, v107
    v_cvt_pk_bf16_f32 v30, v104, v105
    v_cvt_pk_bf16_f32 v31, v106, v107
    s_waitcnt lgkmcnt(9)
    v_mfma_f32_32x32x16_bf16 v[112:127], a[180:183], a[68:71], v[112:127]
    ds_read_b128 a[180:183], v3 offset:15360
    v_cndmask_b32 v148, v29, v148, vcc
    v_cndmask_b32 v149, v29, v149, vcc
    v_cndmask_b32 v150, v29, v150, vcc
    v_cndmask_b32 v151, v29, v151, vcc
    s_waitcnt lgkmcnt(12)
    v_mfma_f32_32x32x16_bf16 v[112:127], a[160:163], a[72:75], v[112:127]
    s_waitcnt vmcnt(5)
    s_barrier
    ds_read_b128 a[160:163], v1 offset:0
    buffer_store_dwordx4 v[148:151], v27, s[8:11], s50 offen offset:1280 sc1
    v_mfma_f32_32x32x16_bf16 v[112:127], a[164:167], a[76:79], v[112:127]
    ds_read_b128 a[164:167], v1 offset:1024
    ds_write_b128 v19, v[148:151] offset:1024
    s_waitcnt lgkmcnt(10)
    v_cndmask_b32 v152, v29, v152, vcc
    s_waitcnt lgkmcnt(6)
    v_mfma_f32_32x32x16_bf16 v[112:127], a[168:171], a[80:83], v[112:127]
    ds_read_b128 a[168:171], v1 offset:2048
    v_cndmask_b32 v153, v29, v153, vcc
    v_cndmask_b32 v154, v29, v154, vcc
    v_cndmask_b32 v155, v29, v155, vcc
    v_mfma_f32_32x32x16_bf16 v[112:127], a[172:175], a[84:87], v[112:127]
    ds_read_b128 a[172:175], v1 offset:3072
    buffer_store_dwordx4 v[152:155], v27, s[8:11], s50 offen offset:1984 sc1
    s_waitcnt lgkmcnt(5)
    v_mfma_f32_32x32x16_bf16 v[112:127], a[176:179], a[88:91], v[112:127]
    ds_read_b128 a[176:179], v1 offset:4096
    ds_write_b128 v19, v[152:155] offset:2048
    s_waitcnt lgkmcnt(12)
    v_cndmask_b32 v156, v29, v156, vcc
    v_mfma_f32_32x32x16_bf16 v[112:127], a[180:183], a[92:95], v[112:127]
    ds_read_b128 a[180:183], v1 offset:5120
    v_cndmask_b32 v157, v29, v157, vcc
    v_cndmask_b32 v158, v29, v158, vcc
    v_cndmask_b32 v159, v29, v159, vcc
    s_waitcnt lgkmcnt(6)
    v_mfma_f32_32x32x16_bf16 v[112:127], a[160:163], a[96:99], v[112:127]
    ds_read_b128 a[160:163], v1 offset:6144
    buffer_store_dwordx4 v[156:159], v27, s[8:11], s51 offen offset:1280 sc1
    v_mfma_f32_32x32x16_bf16 v[112:127], a[164:167], a[100:103], v[112:127]
    ds_read_b128 a[164:167], v1 offset:7168
    ds_write_b128 v19, v[156:159] offset:4096
    s_waitcnt lgkmcnt(13)
    v_cndmask_b32 v160, v29, v160, vcc
    s_waitcnt lgkmcnt(6)
    v_mfma_f32_32x32x16_bf16 v[112:127], a[168:171], a[104:107], v[112:127]
    ds_read_b128 a[168:171], v1 offset:8192
    v_cndmask_b32 v161, v29, v161, vcc
    v_cndmask_b32 v162, v29, v162, vcc
    v_cndmask_b32 v163, v29, v163, vcc
    v_mfma_f32_32x32x16_bf16 v[112:127], a[172:175], a[108:111], v[112:127]
    ds_read_b128 a[172:175], v1 offset:9216
    buffer_store_dwordx4 v[160:163], v27, s[8:11], s51 offen offset:1984 sc1
    s_waitcnt lgkmcnt(5)
    v_mfma_f32_32x32x16_bf16 v[112:127], a[176:179], a[112:115], v[112:127]
    ds_read_b128 a[176:179], v1 offset:10240
    ds_write_b128 v19, v[160:163] offset:5120
    ds_write_b64 v21, v[30:31]
    v_mfma_f32_32x32x16_bf16 v[112:127], a[180:183], a[116:119], v[112:127]
    ds_read_b128 a[180:183], v1 offset:11264
    ds_write_b64 v57, v[136:137]
    s_waitcnt lgkmcnt(8)
    v_mfma_f32_32x32x16_bf16 v[112:127], a[160:163], a[120:123], v[112:127]
    ds_read_b128 a[160:163], v1 offset:12288
    ds_write_b128 v19, v[128:131] offset:0
    v_mfma_f32_32x32x16_bf16 v[112:127], a[164:167], a[124:127], v[112:127]
    ds_read_b128 a[164:167], v1 offset:13312
    s_waitcnt lgkmcnt(8)
    v_mfma_f32_32x32x16_bf16 v[112:127], a[168:171], a[128:131], v[112:127]
    ds_read_b128 a[168:171], v1 offset:14336
    ds_write_b128 v19, v[132:135] offset:3072
    v_mfma_f32_32x32x16_bf16 v[112:127], a[172:175], a[132:135], v[112:127]
    ds_read_b128 a[172:175], v1 offset:15360
    s_waitcnt lgkmcnt(7)
    v_mfma_f32_32x32x16_bf16 v[112:127], a[176:179], a[136:139], v[112:127]
    v_mfma_f32_32x32x16_bf16 v[112:127], a[180:183], a[140:143], v[112:127]
    s_waitcnt lgkmcnt(3)
    v_mfma_f32_32x32x16_bf16 v[112:127], a[160:163], a[144:147], v[112:127]
    v_mfma_f32_32x32x16_bf16 v[112:127], a[164:167], a[148:151], v[112:127]
    s_waitcnt lgkmcnt(0)
    v_mfma_f32_32x32x16_bf16 v[112:127], a[168:171], a[152:155], v[112:127]
    v_mfma_f32_32x32x16_bf16 v[112:127], a[172:175], a[156:159], v[112:127]
    s_waitcnt lgkmcnt(0)
    v_mov_b32 v60, 0
    v_mov_b32 v61, 0
    v_mov_b32 v54, 0xdddddddd
    v_accvgpr_write_b32 a48, -1
    v_accvgpr_write_b32 a49, -1
    v_accvgpr_write_b32 a50, -1
    v_accvgpr_write_b32 a51, -1
    s_nop 3
    v_pk_mul_f32 v[112:113], v[112:113], s[52:53] op_sel:[0,1] op_sel_hi:[1,1]
    v_pk_mul_f32 v[114:115], v[114:115], s[52:53] op_sel:[0,1] op_sel_hi:[1,1]
    v_pk_mul_f32 v[116:117], v[116:117], s[52:53] op_sel:[0,1] op_sel_hi:[1,1]
    v_pk_mul_f32 v[118:119], v[118:119], s[52:53] op_sel:[0,1] op_sel_hi:[1,1]
    v_pk_mul_f32 v[120:121], v[120:121], s[52:53] op_sel:[0,1] op_sel_hi:[1,1]
    v_pk_mul_f32 v[122:123], v[122:123], s[52:53] op_sel:[0,1] op_sel_hi:[1,1]
    v_pk_mul_f32 v[124:125], v[124:125], s[52:53] op_sel:[0,1] op_sel_hi:[1,1]
    v_pk_mul_f32 v[126:127], v[126:127], s[52:53] op_sel:[0,1] op_sel_hi:[1,1]
    v_cvt_pk_bf16_f32 v64, v112, v113
    v_cvt_pk_bf16_f32 v65, v114, v115
    v_cvt_pk_bf16_f32 v66, v116, v117
    v_cvt_pk_bf16_f32 v67, v118, v119
    ds_write_b128 v55, v[64:67] offset:0
    v_cvt_pk_bf16_f32 v68, v120, v121
    v_cvt_pk_bf16_f32 v69, v122, v123
    v_cvt_pk_bf16_f32 v70, v124, v125
    v_cvt_pk_bf16_f32 v71, v126, v127
    ds_write_b128 v55, v[68:71] offset:4096
    v_mfma_f32_32x32x8bf16_1k a[0:15], v[60:61], v[60:61], 0
    v_mfma_f32_32x32x8bf16_1k a[16:31], v[60:61], v[60:61], 0
    v_mfma_f32_32x32x8bf16_1k v[16:31], v[60:61], v[60:61], 0
    v_mfma_f32_32x32x8bf16_1k v[32:47], v[60:61], v[60:61], 0
    s_waitcnt vmcnt(0)
    buffer_atomic_swap v4, v253, s[8:11], s55 offen offset:0 sc1
    s_waitcnt lgkmcnt(0)
    s_barrier
    ds_read_b64 v[52:53], v15
    ds_read_b64 a[80:81], v12
    ds_read_b64 a[82:83], v13
    ds_read_b128 v[48:51], v14
    ds_read_b128 a[64:67], v10 offset:59392
    ds_read_b128 a[68:71], v10 offset:60416
    ds_read_b128 a[72:75], v11 offset:59392
    ds_read_b128 a[76:79], v11 offset:60416
    ds_read_b64 a[92:93], v59
    ds_read_b128 a[84:87], v58 offset:0
    ds_read_b128 a[94:97], v58 offset:1024
    ds_read_b128 a[98:101], v58 offset:2048
    ds_read_b128 a[88:91], v58 offset:6144
    ds_read_b128 a[102:105], v58 offset:7168
    ds_read_b128 a[106:109], v58 offset:8192
    s_waitcnt lgkmcnt(11)
    v_xor_b32 v52, 0x80008000, v52
    v_xor_b32 v53, 0x80008000, v53
    v_xor_b32 v48, 0x80008000, v48
    v_xor_b32 v49, 0x80008000, v49
    v_xor_b32 v50, 0x80008000, v50
    v_xor_b32 v51, 0x80008000, v51
    s_waitcnt lgkmcnt(7)
    s_nop 0
    v_mfma_f32_32x32x16_bf16 v[128:143], v[48:51], a[64:67], 0
    v_mfma_f32_32x32x16_bf16 v[144:159], v[48:51], a[68:71], 0
    s_waitcnt vmcnt(8)
    v_max_u32 v240, v233, v235
    v_min_u32 v233, v233, v235
    v_max3_u32 v240, v240, v237, v239
    v_min3_u32 v233, v233, v237, v239
    v_cmp_ne_u32 vcc, s6, v240
    v_cmp_ne_u32 s[60:61], s6, v233
    s_or_b64 vcc, vcc, s[60:61]
    s_cbranch_vccnz cold_28
coldr_29:
    v_add_f32 v232, v232, v236
    v_add_f32 v234, v234, v238
    v_cvt_pk_bf16_f32 v234, v232, v234
    v_lshlrev_b32 v232, 16, v234
    v_and_b32 v233, 0xffff0000, v234
    v_add_f32 v232, v245, v232
    v_add_f32 v233, v245, v233
    v_cvt_pk_bf16_f32 v234, v232, v233
    ds_write_b32 v243, v234 offset:0
    v_mfma_f32_32x32x4bf16_1k v[128:159], v[52:53], a[80:81], v[128:159]
    s_waitcnt lgkmcnt(7)
    v_mfma_f32_32x32x4bf16_1k v[64:95], a[92:93], a[80:81], v[128:159] cbsz:1 abid:0
    s_mov_b64 exec, 0
    s_cmp_eq_u32 s3, 0
    s_cbranch_scc1 L_pg1_0
    s_cmp_eq_u32 s3, 1
    s_cbranch_scc1 L_pg1_1
    s_cmp_eq_u32 s3, 2
    s_cbranch_scc1 L_pg1_2
    s_cmp_eq_u32 s3, 3
    s_cbranch_scc1 L_pg1_3
L_wr1:
    s_mov_b64 exec, -1
    s_mul_i32 s42, s41, 102400
    s_mul_i32 s101, s3, 25600
    s_add_u32 s42, s42, s101
    s_add_u32 s42, s42, 3665920
    s_mul_i32 s43, s5, 245760
    s_add_u32 s43, s43, s39
    s_add_u32 s43, s43, 6799360
    s_mul_i32 s49, s41, 245760
    s_add_u32 s49, s49, s39
    s_add_u32 s49, s49, 4702208
    s_waitcnt lgkmcnt(0)
    s_barrier
    s_mov_b32 exec_hi, 0
    v_mov_b32 v215, 0
    buffer_atomic_or v215, v252, s[8:11], s86 offen sc0 sc1
    s_mov_b64 exec, -1
    v_mfma_f32_32x32x16_bf16 v[160:175], v[48:51], a[72:75], 0
    v_mfma_f32_32x32x16_bf16 v[176:191], v[48:51], a[76:79], 0
    v_mfma_f32_32x32x16_bf16 v[64:79], a[84:87], a[64:67], v[64:79]
    v_mfma_f32_32x32x16_bf16 v[80:95], a[84:87], a[68:71], v[80:95]
    s_nop 7
    v_mfma_f32_32x32x4bf16_1k v[160:191], v[52:53], a[82:83], v[160:191]
    s_nop 1
    v_exp_f32 v64, v64
    v_exp_f32 v65, v65
    v_exp_f32 v66, v66
    v_exp_f32 v67, v67
    v_exp_f32 v68, v68
    v_mfma_f32_32x32x4bf16_1k v[96:127], a[92:93], a[82:83], v[160:191] cbsz:1 abid:0
    v_exp_f32 v69, v69
    v_exp_f32 v70, v70
    v_exp_f32 v71, v71
    v_exp_f32 v72, v72
    v_exp_f32 v73, v73
    v_exp_f32 v74, v74
    v_exp_f32 v75, v75
    v_exp_f32 v76, v76
    v_smfmac_f32_32x32x32_bf16 a[0:15], a[94:97], v[64:71], v54
    v_exp_f32 v77, v77
    v_exp_f32 v78, v78
    v_exp_f32 v79, v79
    v_exp_f32 v80, v80
    v_exp_f32 v81, v81
    v_smfmac_f32_32x32x32_bf16 a[0:15], a[98:101], v[72:79], v54
    v_exp_f32 v82, v82
    v_exp_f32 v83, v83
    v_exp_f32 v84, v84
    v_mfma_f32_32x32x16_bf16 v[96:111], a[84:87], a[72:75], v[96:111]
    v_exp_f32 v85, v85
    v_exp_f32 v86, v86
    v_exp_f32 v87, v87
    v_mfma_f32_32x32x16_bf16 v[112:127], a[84:87], a[76:79], v[112:127]
    v_exp_f32 v88, v88
    v_exp_f32 v89, v89
    v_exp_f32 v90, v90
    v_smfmac_f32_32x32x32_bf16 a[16:31], a[94:97], v[80:87], v54
    v_exp_f32 v91, v91
    v_exp_f32 v92, v92
    v_exp_f32 v93, v93
    v_exp_f32 v94, v94
    v_exp_f32 v95, v95
    v_exp_f32 v96, v96
    v_exp_f32 v97, v97
    v_smfmac_f32_32x32x32_bf16 a[16:31], a[98:101], v[88:95], v54
    v_exp_f32 v98, v98
    v_exp_f32 v99, v99
    v_exp_f32 v100, v100
    v_mfma_f32_32x32x4bf16_1k v[64:95], a[92:93], a[80:81], v[128:159] cbsz:1 abid:1
    v_exp_f32 v101, v101
    v_exp_f32 v102, v102
    v_exp_f32 v103, v103
    v_exp_f32 v104, v104
    v_exp_f32 v105, v105
    v_exp_f32 v106, v106
    v_exp_f32 v107, v107
    v_exp_f32 v108, v108
    v_smfmac_f32_32x32x32_bf16 v[16:31], a[94:97], v[96:103], v54
    s_waitcnt vmcnt(0)
    s_mov_b32 exec_hi, 0
    v_cmp_ne_u32 vcc, s6, v215
    s_mov_b64 exec, -1
    s_cbranch_vccnz cold_32
coldr_33:
    buffer_load_dwordx2 a[118:119], v8, s[8:11], s20 offen offset:1024 sc1
    buffer_load_dwordx4 a[110:113], v0, s[8:11], s20 offen sc1
    v_exp_f32 v109, v109
    v_exp_f32 v110, v110
    v_exp_f32 v111, v111
    v_exp_f32 v112, v112
    v_exp_f32 v113, v113
    v_smfmac_f32_32x32x32_bf16 v[16:31], a[98:101], v[104:111], v54
    buffer_load_dwordx4 a[120:123], v9, s[8:11], s20 offen offset:1280 sc1
    buffer_load_dwordx4 a[124:127], v9, s[8:11], s20 offen offset:1984 sc1
    v_exp_f32 v114, v114
    v_exp_f32 v115, v115
    v_exp_f32 v116, v116
    v_mfma_f32_32x32x16_bf16 v[64:79], a[88:91], a[64:67], v[64:79]
    v_exp_f32 v117, v117
    v_exp_f32 v118, v118
    v_exp_f32 v119, v119
    v_mfma_f32_32x32x16_bf16 v[80:95], a[88:91], a[68:71], v[80:95]
    v_exp_f32 v120, v120
    v_exp_f32 v121, v121
    v_exp_f32 v122, v122
    v_smfmac_f32_32x32x32_bf16 v[32:47], a[94:97], v[112:119], v54
    buffer_load_dwordx4 a[114:117], v254, s[8:11], s20 offen sc1
    buffer_load_dwordx4 a[128:131], v255, s[8:11], s20 offen offset:1280 sc1
    buffer_load_dwordx4 a[132:135], v255, s[8:11], s20 offen offset:1984 sc1
    v_exp_f32 v123, v123
    v_exp_f32 v124, v124
    v_exp_f32 v125, v125
    v_exp_f32 v126, v126
    v_exp_f32 v127, v127
    v_exp_f32 v64, v64
    v_exp_f32 v65, v65
    v_smfmac_f32_32x32x32_bf16 v[32:47], a[98:101], v[120:127], v54
    v_exp_f32 v66, v66
    v_exp_f32 v67, v67
    v_exp_f32 v68, v68
    v_mfma_f32_32x32x4bf16_1k v[96:127], a[92:93], a[82:83], v[160:191] cbsz:1 abid:1
    v_exp_f32 v69, v69
    v_exp_f32 v70, v70
    v_exp_f32 v71, v71
    v_exp_f32 v72, v72
    v_exp_f32 v73, v73
    v_exp_f32 v74, v74
    v_exp_f32 v75, v75
    v_exp_f32 v76, v76
    v_smfmac_f32_32x32x32_bf16 a[0:15], a[102:105], v[64:71], v54
    v_exp_f32 v77, v77
    v_exp_f32 v78, v78
    v_exp_f32 v79, v79
    v_exp_f32 v80, v80
    v_exp_f32 v81, v81
    v_smfmac_f32_32x32x32_bf16 a[0:15], a[106:109], v[72:79], v54
    v_exp_f32 v82, v82
    v_exp_f32 v83, v83
    v_exp_f32 v84, v84
    v_mfma_f32_32x32x16_bf16 v[96:111], a[88:91], a[72:75], v[96:111]
    v_exp_f32 v85, v85
    v_exp_f32 v86, v86
    v_exp_f32 v87, v87
    v_mfma_f32_32x32x16_bf16 v[112:127], a[88:91], a[76:79], v[112:127]
    v_exp_f32 v88, v88
    v_exp_f32 v89, v89
    v_exp_f32 v90, v90
    v_smfmac_f32_32x32x32_bf16 a[16:31], a[102:105], v[80:87], v54
    v_exp_f32 v91, v91
    v_exp_f32 v92, v92
    v_exp_f32 v93, v93
    v_exp_f32 v94, v94
    v_exp_f32 v95, v95
    v_exp_f32 v96, v96
    v_exp_f32 v97, v97
    v_smfmac_f32_32x32x32_bf16 a[16:31], a[106:109], v[88:95], v54
    buffer_load_dwordx2 a[144:145], v8, s[8:11], s21 offen offset:1024 sc1
    buffer_load_dwordx4 a[136:139], v0, s[8:11], s21 offen sc1
    s_waitcnt vmcnt(7)
    v_exp_f32 v98, v98
    v_exp_f32 v99, v99
    v_exp_f32 v100, v100
    v_mfma_f32_32x32x4bf16_1k v[64:95], a[118:119], a[80:81], v[128:159] cbsz:1 abid:0
    v_exp_f32 v101, v101
    v_exp_f32 v102, v102
    v_exp_f32 v103, v103
    v_exp_f32 v104, v104
    v_exp_f32 v105, v105
    v_exp_f32 v106, v106
    v_exp_f32 v107, v107
    v_exp_f32 v108, v108
    v_smfmac_f32_32x32x32_bf16 v[16:31], a[102:105], v[96:103], v54
    buffer_load_dwordx4 a[146:149], v9, s[8:11], s21 offen offset:1280 sc1
    buffer_load_dwordx4 a[150:153], v9, s[8:11], s21 offen offset:1984 sc1
    v_exp_f32 v109, v109
    v_exp_f32 v110, v110
    v_exp_f32 v111, v111
    v_exp_f32 v112, v112
    v_exp_f32 v113, v113
    v_smfmac_f32_32x32x32_bf16 v[16:31], a[106:109], v[104:111], v54
    buffer_load_dwordx4 a[140:143], v254, s[8:11], s21 offen sc1
    buffer_load_dwordx4 a[154:157], v255, s[8:11], s21 offen offset:1280 sc1
    buffer_load_dwordx4 a[158:161], v255, s[8:11], s21 offen offset:1984 sc1
    v_exp_f32 v114, v114
    v_exp_f32 v115, v115
    v_exp_f32 v116, v116
    v_mfma_f32_32x32x16_bf16 v[64:79], a[110:113], a[64:67], v[64:79]
    v_exp_f32 v117, v117
    v_exp_f32 v118, v118
    v_exp_f32 v119, v119
    v_mfma_f32_32x32x16_bf16 v[80:95], a[110:113], a[68:71], v[80:95]
    v_exp_f32 v120, v120
    v_exp_f32 v121, v121
    v_exp_f32 v122, v122
    v_smfmac_f32_32x32x32_bf16 v[32:47], a[102:105], v[112:119], v54
    v_exp_f32 v123, v123
    v_exp_f32 v124, v124
    v_exp_f32 v125, v125
    v_exp_f32 v126, v126
    v_exp_f32 v127, v127
    v_exp_f32 v64, v64
    v_exp_f32 v65, v65
    v_smfmac_f32_32x32x32_bf16 v[32:47], a[106:109], v[120:127], v54
    buffer_load_dwordx2 a[92:93], v8, s[8:11], s22 offen offset:1024 sc1
    buffer_load_dwordx4 a[84:87], v0, s[8:11], s22 offen sc1
    s_waitcnt vmcnt(9)
    v_exp_f32 v66, v66
    v_exp_f32 v67, v67
    v_exp_f32 v68, v68
    v_mfma_f32_32x32x4bf16_1k v[96:127], a[118:119], a[82:83], v[160:191] cbsz:1 abid:0
    v_exp_f32 v69, v69
    v_exp_f32 v70, v70
    v_exp_f32 v71, v71
    v_exp_f32 v72, v72
    v_exp_f32 v73, v73
    v_exp_f32 v74, v74
    v_exp_f32 v75, v75
    v_exp_f32 v76, v76
    v_smfmac_f32_32x32x32_bf16 a[0:15], a[120:123], v[64:71], v54
    buffer_load_dwordx4 a[94:97], v9, s[8:11], s22 offen offset:1280 sc1
    buffer_load_dwordx4 a[98:101], v9, s[8:11], s22 offen offset:1984 sc1
    v_exp_f32 v77, v77
    v_exp_f32 v78, v78
    v_exp_f32 v79, v79
    v_exp_f32 v80, v80
    v_exp_f32 v81, v81
    v_smfmac_f32_32x32x32_bf16 a[0:15], a[124:127], v[72:79], v54
    buffer_load_dwordx4 a[88:91], v254, s[8:11], s22 offen sc1
    buffer_load_dwordx4 a[102:105], v255, s[8:11], s22 offen offset:1280 sc1
    buffer_load_dwordx4 a[106:109], v255, s[8:11], s22 offen offset:1984 sc1
    v_exp_f32 v82, v82
    v_exp_f32 v83, v83
    v_exp_f32 v84, v84
    v_mfma_f32_32x32x16_bf16 v[96:111], a[110:113], a[72:75], v[96:111]
    v_exp_f32 v85, v85
    v_exp_f32 v86, v86
    v_exp_f32 v87, v87
    v_mfma_f32_32x32x16_bf16 v[112:127], a[110:113], a[76:79], v[112:127]
    v_exp_f32 v88, v88
    v_exp_f32 v89, v89
    v_exp_f32 v90, v90
    v_smfmac_f32_32x32x32_bf16 a[16:31], a[120:123], v[80:87], v54
    v_exp_f32 v91, v91
    v_exp_f32 v92, v92
    v_exp_f32 v93, v93
    v_exp_f32 v94, v94
    v_exp_f32 v95, v95
    v_exp_f32 v96, v96
    v_exp_f32 v97, v97
    v_smfmac_f32_32x32x32_bf16 a[16:31], a[124:127], v[88:95], v54
    s_add_u32 m0, s65, 0
    s_nop 0
    buffer_load_dwordx4 v224, s[32:35], s64 offen lds
    v_exp_f32 v98, v98
    v_exp_f32 v99, v99
    v_exp_f32 v100, v100
    v_mfma_f32_32x32x4bf16_1k v[64:95], a[118:119], a[80:81], v[128:159] cbsz:1 abid:1
    v_exp_f32 v101, v101
    v_exp_f32 v102, v102
    v_exp_f32 v103, v103
    v_exp_f32 v104, v104
    v_exp_f32 v105, v105
    v_exp_f32 v106, v106
    v_exp_f32 v107, v107
    v_exp_f32 v108, v108
    v_smfmac_f32_32x32x32_bf16 v[16:31], a[120:123], v[96:103], v54
    v_exp_f32 v109, v109
    v_exp_f32 v110, v110
    v_exp_f32 v111, v111
    v_exp_f32 v112, v112
    v_exp_f32 v113, v113
    v_smfmac_f32_32x32x32_bf16 v[16:31], a[124:127], v[104:111], v54
    v_exp_f32 v114, v114
    v_exp_f32 v115, v115
    v_exp_f32 v116, v116
    v_mfma_f32_32x32x16_bf16 v[64:79], a[114:117], a[64:67], v[64:79]
    v_exp_f32 v117, v117
    v_exp_f32 v118, v118
    v_exp_f32 v119, v119
    v_mfma_f32_32x32x16_bf16 v[80:95], a[114:117], a[68:71], v[80:95]
    v_exp_f32 v120, v120
    v_exp_f32 v121, v121
    v_exp_f32 v122, v122
    v_smfmac_f32_32x32x32_bf16 v[32:47], a[120:123], v[112:119], v54
    v_exp_f32 v123, v123
    v_exp_f32 v124, v124
    v_exp_f32 v125, v125
    v_exp_f32 v126, v126
    v_exp_f32 v127, v127
    v_exp_f32 v64, v64
    v_exp_f32 v65, v65
    v_smfmac_f32_32x32x32_bf16 v[32:47], a[124:127], v[120:127], v54
    v_exp_f32 v66, v66
    v_exp_f32 v67, v67
    v_exp_f32 v68, v68
    v_mfma_f32_32x32x4bf16_1k v[96:127], a[118:119], a[82:83], v[160:191] cbsz:1 abid:1
    v_exp_f32 v69, v69
    v_exp_f32 v70, v70
    v_exp_f32 v71, v71
    v_exp_f32 v72, v72
    v_exp_f32 v73, v73
    v_exp_f32 v74, v74
    v_exp_f32 v75, v75
    v_exp_f32 v76, v76
    v_smfmac_f32_32x32x32_bf16 a[0:15], a[128:131], v[64:71], v54
    v_exp_f32 v77, v77
    v_exp_f32 v78, v78
    v_exp_f32 v79, v79
    v_exp_f32 v80, v80
    v_exp_f32 v81, v81
    v_smfmac_f32_32x32x32_bf16 a[0:15], a[132:135], v[72:79], v54
    v_exp_f32 v82, v82
    v_exp_f32 v83, v83
    v_exp_f32 v84, v84
    v_mfma_f32_32x32x16_bf16 v[96:111], a[114:117], a[72:75], v[96:111]
    v_exp_f32 v85, v85
    v_exp_f32 v86, v86
    v_exp_f32 v87, v87
    v_mfma_f32_32x32x16_bf16 v[112:127], a[114:117], a[76:79], v[112:127]
    v_exp_f32 v88, v88
    v_exp_f32 v89, v89
    v_exp_f32 v90, v90
    v_smfmac_f32_32x32x32_bf16 a[16:31], a[128:131], v[80:87], v54
    v_exp_f32 v91, v91
    v_exp_f32 v92, v92
    v_exp_f32 v93, v93
    v_exp_f32 v94, v94
    v_exp_f32 v95, v95
    v_exp_f32 v96, v96
    v_exp_f32 v97, v97
    v_smfmac_f32_32x32x32_bf16 a[16:31], a[132:135], v[88:95], v54
    s_add_u32 m0, s65, 1024
    s_add_u32 s64, s64, s66
    buffer_load_dwordx4 v224, s[32:35], s64 offen lds
    s_waitcnt vmcnt(9)
    v_exp_f32 v98, v98
    v_exp_f32 v99, v99
    v_exp_f32 v100, v100
    v_mfma_f32_32x32x4bf16_1k v[64:95], a[144:145], a[80:81], v[128:159] cbsz:1 abid:0
    v_exp_f32 v101, v101
    v_exp_f32 v102, v102
    v_exp_f32 v103, v103
    v_exp_f32 v104, v104
    v_exp_f32 v105, v105
    v_exp_f32 v106, v106
    v_exp_f32 v107, v107
    v_exp_f32 v108, v108
    v_smfmac_f32_32x32x32_bf16 v[16:31], a[128:131], v[96:103], v54
    v_exp_f32 v109, v109
    v_exp_f32 v110, v110
    v_exp_f32 v111, v111
    v_exp_f32 v112, v112
    v_exp_f32 v113, v113
    v_smfmac_f32_32x32x32_bf16 v[16:31], a[132:135], v[104:111], v54
    v_exp_f32 v114, v114
    v_exp_f32 v115, v115
    v_exp_f32 v116, v116
    v_mfma_f32_32x32x16_bf16 v[64:79], a[136:139], a[64:67], v[64:79]
    v_exp_f32 v117, v117
    v_exp_f32 v118, v118
    v_exp_f32 v119, v119
    v_mfma_f32_32x32x16_bf16 v[80:95], a[136:139], a[68:71], v[80:95]
    v_exp_f32 v120, v120
    v_exp_f32 v121, v121
    v_exp_f32 v122, v122
    v_smfmac_f32_32x32x32_bf16 v[32:47], a[128:131], v[112:119], v54
    v_exp_f32 v123, v123
    v_exp_f32 v124, v124
    v_exp_f32 v125, v125
    v_exp_f32 v126, v126
    v_exp_f32 v127, v127
    v_exp_f32 v64, v64
    v_exp_f32 v65, v65
    v_smfmac_f32_32x32x32_bf16 v[32:47], a[132:135], v[120:127], v54
    buffer_load_dwordx2 a[118:119], v8, s[8:11], s23 offen offset:1024 sc1
    buffer_load_dwordx4 a[110:113], v0, s[8:11], s23 offen sc1
    v_exp_f32 v66, v66
    v_exp_f32 v67, v67
    v_exp_f32 v68, v68
    v_mfma_f32_32x32x4bf16_1k v[96:127], a[144:145], a[82:83], v[160:191] cbsz:1 abid:0
    v_exp_f32 v69, v69
    v_exp_f32 v70, v70
    v_exp_f32 v71, v71
    v_exp_f32 v72, v72
    v_exp_f32 v73, v73
    v_exp_f32 v74, v74
    v_exp_f32 v75, v75
    v_exp_f32 v76, v76
    v_smfmac_f32_32x32x32_bf16 a[0:15], a[146:149], v[64:71], v54
    buffer_load_dwordx4 a[120:123], v9, s[8:11], s23 offen offset:1280 sc1
    buffer_load_dwordx4 a[124:127], v9, s[8:11], s23 offen offset:1984 sc1
    v_exp_f32 v77, v77
    v_exp_f32 v78, v78
    v_exp_f32 v79, v79
    v_exp_f32 v80, v80
    v_exp_f32 v81, v81
    v_smfmac_f32_32x32x32_bf16 a[0:15], a[150:153], v[72:79], v54
    buffer_load_dwordx4 a[114:117], v254, s[8:11], s23 offen sc1
    buffer_load_dwordx4 a[128:131], v255, s[8:11], s23 offen offset:1280 sc1
    buffer_load_dwordx4 a[132:135], v255, s[8:11], s23 offen offset:1984 sc1
    v_exp_f32 v82, v82
    v_exp_f32 v83, v83
    v_exp_f32 v84, v84
    v_mfma_f32_32x32x16_bf16 v[96:111], a[136:139], a[72:75], v[96:111]
    v_exp_f32 v85, v85
    v_exp_f32 v86, v86
    v_exp_f32 v87, v87
    v_mfma_f32_32x32x16_bf16 v[112:127], a[136:139], a[76:79], v[112:127]
    v_exp_f32 v88, v88
    v_exp_f32 v89, v89
    v_exp_f32 v90, v90
    v_smfmac_f32_32x32x32_bf16 a[16:31], a[146:149], v[80:87], v54
    v_exp_f32 v91, v91
    v_exp_f32 v92, v92
    v_exp_f32 v93, v93
    v_exp_f32 v94, v94
    v_exp_f32 v95, v95
    v_exp_f32 v96, v96
    v_exp_f32 v97, v97
    v_smfmac_f32_32x32x32_bf16 a[16:31], a[150:153], v[88:95], v54
    s_add_u32 m0, s65, 2048
    s_add_u32 s64, s64, s67
    buffer_load_dwordx4 v224, s[32:35], s64 offen lds
    v_exp_f32 v98, v98
    v_exp_f32 v99, v99
    v_exp_f32 v100, v100
    v_mfma_f32_32x32x4bf16_1k v[64:95], a[144:145], a[80:81], v[128:159] cbsz:1 abid:1
    v_exp_f32 v101, v101
    v_exp_f32 v102, v102
    v_exp_f32 v103, v103
    v_exp_f32 v104, v104
    v_exp_f32 v105, v105
    v_exp_f32 v106, v106
    v_exp_f32 v107, v107
    v_exp_f32 v108, v108
    v_smfmac_f32_32x32x32_bf16 v[16:31], a[146:149], v[96:103], v54
    v_exp_f32 v109, v109
    v_exp_f32 v110, v110
    v_exp_f32 v111, v111
    v_exp_f32 v112, v112
    v_exp_f32 v113, v113
    v_smfmac_f32_32x32x32_bf16 v[16:31], a[150:153], v[104:111], v54
    v_exp_f32 v114, v114
    v_exp_f32 v115, v115
    v_exp_f32 v116, v116
    v_mfma_f32_32x32x16_bf16 v[64:79], a[140:143], a[64:67], v[64:79]
    v_exp_f32 v117, v117
    v_exp_f32 v118, v118
    v_exp_f32 v119, v119
    v_mfma_f32_32x32x16_bf16 v[80:95], a[140:143], a[68:71], v[80:95]
    v_exp_f32 v120, v120
    v_exp_f32 v121, v121
    v_exp_f32 v122, v122
    v_smfmac_f32_32x32x32_bf16 v[32:47], a[146:149], v[112:119], v54
    v_exp_f32 v123, v123
    v_exp_f32 v124, v124
    v_exp_f32 v125, v125
    v_exp_f32 v126, v126
    v_exp_f32 v127, v127
    v_exp_f32 v64, v64
    v_exp_f32 v65, v65
    v_smfmac_f32_32x32x32_bf16 v[32:47], a[150:153], v[120:127], v54
    v_exp_f32 v66, v66
    v_exp_f32 v67, v67
    v_exp_f32 v68, v68
    v_mfma_f32_32x32x4bf16_1k v[96:127], a[144:145], a[82:83], v[160:191] cbsz:1 abid:1
    v_exp_f32 v69, v69
    v_exp_f32 v70, v70
L_pg0_2:
    s_cbranch_execz L_wr0
    v_exp_f32 v71, v71
    v_exp_f32 v72, v72
    v_exp_f32 v73, v73
    v_exp_f32 v74, v74
    v_exp_f32 v75, v75
    v_exp_f32 v76, v76
    v_smfmac_f32_32x32x32_bf16 a[0:15], a[154:157], v[64:71], v54
    v_exp_f32 v77, v77
    v_exp_f32 v78, v78
    v_exp_f32 v79, v79
    v_exp_f32 v80, v80
    v_exp_f32 v81, v81
    v_smfmac_f32_32x32x32_bf16 a[0:15], a[158:161], v[72:79], v54
    v_exp_f32 v82, v82
    v_exp_f32 v83, v83
    v_exp_f32 v84, v84
    v_mfma_f32_32x32x16_bf16 v[96:111], a[140:143], a[72:75], v[96:111]
    v_exp_f32 v85, v85
    v_exp_f32 v86, v86
    v_exp_f32 v87, v87
    v_mfma_f32_32x32x16_bf16 v[112:127], a[140:143], a[76:79], v[112:127]
    v_exp_f32 v88, v88
    v_exp_f32 v89, v89
    v_exp_f32 v90, v90
    v_smfmac_f32_32x32x32_bf16 a[16:31], a[154:157], v[80:87], v54
    v_exp_f32 v91, v91
    v_exp_f32 v92, v92
    v_exp_f32 v93, v93
    v_exp_f32 v94, v94
    v_exp_f32 v95, v95
    v_exp_f32 v96, v96
    v_exp_f32 v97, v97
    v_smfmac_f32_32x32x32_bf16 a[16:31], a[158:161], v[88:95], v54
    s_add_u32 m0, s65, 3072
    s_add_u32 s64, s64, s66
    buffer_load_dwordx4 v224, s[32:35], s64 offen lds
    s_waitcnt vmcnt(11)
    v_exp_f32 v98, v98
    v_exp_f32 v99, v99
    v_exp_f32 v100, v100
    v_mfma_f32_32x32x4bf16_1k v[64:95], a[92:93], a[80:81], v[128:159] cbsz:1 abid:0
    v_exp_f32 v101, v101
    v_exp_f32 v102, v102
    v_exp_f32 v103, v103
    v_exp_f32 v104, v104
    v_exp_f32 v105, v105
    v_exp_f32 v106, v106
    v_exp_f32 v107, v107
    v_exp_f32 v108, v108
    v_smfmac_f32_32x32x32_bf16 v[16:31], a[154:157], v[96:103], v54
    v_exp_f32 v109, v109
    v_exp_f32 v110, v110
    v_exp_f32 v111, v111
    v_exp_f32 v112, v112
    v_exp_f32 v113, v113
    v_smfmac_f32_32x32x32_bf16 v[16:31], a[158:161], v[104:111], v54
    v_exp_f32 v114, v114
    v_exp_f32 v115, v115
    v_exp_f32 v116, v116
    v_mfma_f32_32x32x16_bf16 v[64:79], a[84:87], a[64:67], v[64:79]
    v_exp_f32 v117, v117
    v_exp_f32 v118, v118
    v_exp_f32 v119, v119
    v_mfma_f32_32x32x16_bf16 v[80:95], a[84:87], a[68:71], v[80:95]
    v_exp_f32 v120, v120
    v_exp_f32 v121, v121
    v_exp_f32 v122, v122
    v_smfmac_f32_32x32x32_bf16 v[32:47], a[154:157], v[112:119], v54
    v_exp_f32 v123, v123
    v_exp_f32 v124, v124
    v_exp_f32 v125, v125
    v_exp_f32 v126, v126
    v_exp_f32 v127, v127
    v_exp_f32 v64, v64
    v_exp_f32 v65, v65
    v_smfmac_f32_32x32x32_bf16 v[32:47], a[158:161], v[120:127], v54
    buffer_load_dwordx2 a[144:145], v8, s[8:11], s24 offen offset:1024 sc1
    buffer_load_dwordx4 a[136:139], v0, s[8:11], s24 offen sc1
    v_exp_f32 v66, v66
    v_exp_f32 v67, v67
    v_exp_f32 v68, v68
    v_mfma_f32_32x32x4bf16_1k v[96:127], a[92:93], a[82:83], v[160:191] cbsz:1 abid:0
    v_exp_f32 v69, v69
    v_exp_f32 v70, v70
    v_exp_f32 v71, v71
    v_exp_f32 v72, v72
    v_exp_f32 v73, v73
    v_exp_f32 v74, v74
    v_exp_f32 v75, v75
    v_exp_f32 v76, v76
    v_smfmac_f32_32x32x32_bf16 a[0:15], a[94:97], v[64:71], v54
    buffer_load_dwordx4 a[146:149], v9, s[8:11], s24 offen offset:1280 sc1
    buffer_load_dwordx4 a[150:153], v9, s[8:11], s24 offen offset:1984 sc1
    v_exp_f32 v77, v77
    v_exp_f32 v78, v78
    v_exp_f32 v79, v79
    v_exp_f32 v80, v80
    v_exp_f32 v81, v81
    v_smfmac_f32_32x32x32_bf16 a[0:15], a[98:101], v[72:79], v54
    buffer_load_dwordx4 a[140:143], v254, s[8:11], s24 offen sc1
    buffer_load_dwordx4 a[154:157], v255, s[8:11], s24 offen offset:1280 sc1
    buffer_load_dwordx4 a[158:161], v255, s[8:11], s24 offen offset:1984 sc1
    v_exp_f32 v82, v82
    v_exp_f32 v83, v83
    v_exp_f32 v84, v84
    v_mfma_f32_32x32x16_bf16 v[96:111], a[84:87], a[72:75], v[96:111]
    v_exp_f32 v85, v85
    v_exp_f32 v86, v86
    v_exp_f32 v87, v87
    v_mfma_f32_32x32x16_bf16 v[112:127], a[84:87], a[76:79], v[112:127]
    v_exp_f32 v88, v88
    v_exp_f32 v89, v89
    v_exp_f32 v90, v90
    v_smfmac_f32_32x32x32_bf16 a[16:31], a[94:97], v[80:87], v54
    v_exp_f32 v91, v91
    v_exp_f32 v92, v92
    v_exp_f32 v93, v93
    v_exp_f32 v94, v94
    v_exp_f32 v95, v95
    v_exp_f32 v96, v96
    v_exp_f32 v97, v97
    v_smfmac_f32_32x32x32_bf16 a[16:31], a[98:101], v[88:95], v54
    s_add_u32 m0, s65, 4096
    s_add_u32 s64, s64, s67
    buffer_load_dwordx4 v224, s[32:35], s64 offen lds
    v_exp_f32 v98, v98
    v_exp_f32 v99, v99
    v_exp_f32 v100, v100
    v_mfma_f32_32x32x4bf16_1k v[64:95], a[92:93], a[80:81], v[128:159] cbsz:1 abid:1
    v_exp_f32 v101, v101
    v_exp_f32 v102, v102
    v_exp_f32 v103, v103
    v_exp_f32 v104, v104
    v_exp_f32 v105, v105
    v_exp_f32 v106, v106
    v_exp_f32 v107, v107
    v_exp_f32 v108, v108
    v_smfmac_f32_32x32x32_bf16 v[16:31], a[94:97], v[96:103], v54
    v_exp_f32 v109, v109
    v_exp_f32 v110, v110
    v_exp_f32 v111, v111
    v_exp_f32 v112, v112
    v_exp_f32 v113, v113
    v_smfmac_f32_32x32x32_bf16 v[16:31], a[98:101], v[104:111], v54
    v_exp_f32 v114, v114
    v_exp_f32 v115, v115
    v_exp_f32 v116, v116
    v_mfma_f32_32x32x16_bf16 v[64:79], a[88:91], a[64:67], v[64:79]
    v_exp_f32 v117, v117
    v_exp_f32 v118, v118
    v_exp_f32 v119, v119
    v_mfma_f32_32x32x16_bf16 v[80:95], a[88:91], a[68:71], v[80:95]
    v_exp_f32 v120, v120
    v_exp_f32 v121, v121
    v_exp_f32 v122, v122
    v_smfmac_f32_32x32x32_bf16 v[32:47], a[94:97], v[112:119], v54
    v_exp_f32 v123, v123
    v_exp_f32 v124, v124
    v_exp_f32 v125, v125
    v_exp_f32 v126, v126
    v_exp_f32 v127, v127
    v_exp_f32 v64, v64
    v_exp_f32 v65, v65
    v_smfmac_f32_32x32x32_bf16 v[32:47], a[98:101], v[120:127], v54
    v_exp_f32 v66, v66
    v_exp_f32 v67, v67
    v_exp_f32 v68, v68
    v_mfma_f32_32x32x4bf16_1k v[96:127], a[92:93], a[82:83], v[160:191] cbsz:1 abid:1
    v_exp_f32 v69, v69
    v_exp_f32 v70, v70
    v_exp_f32 v71, v71
    v_exp_f32 v72, v72
    v_exp_f32 v73, v73
    v_exp_f32 v74, v74
    v_exp_f32 v75, v75
    v_exp_f32 v76, v76
    v_smfmac_f32_32x32x32_bf16 a[0:15], a[102:105], v[64:71], v54
    v_exp_f32 v77, v77
    v_exp_f32 v78, v78
    v_exp_f32 v79, v79
    v_exp_f32 v80, v80
    v_exp_f32 v81, v81
    v_smfmac_f32_32x32x32_bf16 a[0:15], a[106:109], v[72:79], v54
    v_exp_f32 v82, v82
    v_exp_f32 v83, v83
    v_exp_f32 v84, v84
    v_mfma_f32_32x32x16_bf16 v[96:111], a[88:91], a[72:75], v[96:111]
    v_exp_f32 v85, v85
    v_exp_f32 v86, v86
    v_exp_f32 v87, v87
    v_mfma_f32_32x32x16_bf16 v[112:127], a[88:91], a[76:79], v[112:127]
    v_exp_f32 v88, v88
    v_exp_f32 v89, v89
    v_exp_f32 v90, v90
    v_smfmac_f32_32x32x32_bf16 a[16:31], a[102:105], v[80:87], v54
    v_exp_f32 v91, v91
    v_exp_f32 v92, v92
    v_exp_f32 v93, v93
    v_exp_f32 v94, v94
    v_exp_f32 v95, v95
    v_exp_f32 v96, v96
    v_exp_f32 v97, v97
    v_smfmac_f32_32x32x32_bf16 a[16:31], a[106:109], v[88:95], v54
    s_add_u32 m0, s65, 5120
    s_add_u32 s64, s64, s66
    buffer_load_dwordx4 v224, s[32:35], s64 offen lds
    s_waitcnt vmcnt(11)
    v_exp_f32 v98, v98
    v_exp_f32 v99, v99
    v_exp_f32 v100, v100
    v_mfma_f32_32x32x4bf16_1k v[64:95], a[118:119], a[80:81], v[128:159] cbsz:1 abid:0
    v_exp_f32 v101, v101
    v_exp_f32 v102, v102
    v_exp_f32 v103, v103
    v_exp_f32 v104, v104
    v_exp_f32 v105, v105
    v_exp_f32 v106, v106
    v_exp_f32 v107, v107
    v_exp_f32 v108, v108
    v_smfmac_f32_32x32x32_bf16 v[16:31], a[102:105], v[96:103], v54
    v_exp_f32 v109, v109
    v_exp_f32 v110, v110
    v_exp_f32 v111, v111
    v_exp_f32 v112, v112
    v_exp_f32 v113, v113
    v_smfmac_f32_32x32x32_bf16 v[16:31], a[106:109], v[104:111], v54
    v_exp_f32 v114, v114
    v_exp_f32 v115, v115
    v_exp_f32 v116, v116
    v_mfma_f32_32x32x16_bf16 v[64:79], a[110:113], a[64:67], v[64:79]
    v_exp_f32 v117, v117
    v_exp_f32 v118, v118
    v_exp_f32 v119, v119
    v_mfma_f32_32x32x16_bf16 v[80:95], a[110:113], a[68:71], v[80:95]
    v_exp_f32 v120, v120
    v_exp_f32 v121, v121
    v_exp_f32 v122, v122
    v_smfmac_f32_32x32x32_bf16 v[32:47], a[102:105], v[112:119], v54
    v_exp_f32 v123, v123
    v_exp_f32 v124, v124
    v_exp_f32 v125, v125
    v_exp_f32 v126, v126
    v_exp_f32 v127, v127
    v_exp_f32 v64, v64
    v_exp_f32 v65, v65
    v_smfmac_f32_32x32x32_bf16 v[32:47], a[106:109], v[120:127], v54
    buffer_load_dwordx2 a[92:93], v8, s[8:11], s25 offen offset:1024 sc1
    buffer_load_dwordx4 a[84:87], v0, s[8:11], s25 offen sc1
    v_exp_f32 v66, v66
    v_exp_f32 v67, v67
    v_exp_f32 v68, v68
    v_mfma_f32_32x32x4bf16_1k v[96:127], a[118:119], a[82:83], v[160:191] cbsz:1 abid:0
    v_exp_f32 v69, v69
    v_exp_f32 v70, v70
    v_exp_f32 v71, v71
    v_exp_f32 v72, v72
    v_exp_f32 v73, v73
    v_exp_f32 v74, v74
    v_exp_f32 v75, v75
    v_exp_f32 v76, v76
    v_smfmac_f32_32x32x32_bf16 a[0:15], a[120:123], v[64:71], v54
    buffer_load_dwordx4 a[94:97], v9, s[8:11], s25 offen offset:1280 sc1
    buffer_load_dwordx4 a[98:101], v9, s[8:11], s25 offen offset:1984 sc1
    v_exp_f32 v77, v77
    v_exp_f32 v78, v78
    v_exp_f32 v79, v79
    v_exp_f32 v80, v80
    v_exp_f32 v81, v81
    v_smfmac_f32_32x32x32_bf16 a[0:15], a[124:127], v[72:79], v54
    buffer_load_dwordx4 a[88:91], v254, s[8:11], s25 offen sc1
    buffer_load_dwordx4 a[102:105], v255, s[8:11], s25 offen offset:1280 sc1
    buffer_load_dwordx4 a[106:109], v255, s[8:11], s25 offen offset:1984 sc1
    v_exp_f32 v82, v82
    v_exp_f32 v83, v83
    v_exp_f32 v84, v84
    v_mfma_f32_32x32x16_bf16 v[96:111], a[110:113], a[72:75], v[96:111]
    v_exp_f32 v85, v85
    v_exp_f32 v86, v86
    v_exp_f32 v87, v87
    v_mfma_f32_32x32x16_bf16 v[112:127], a[110:113], a[76:79], v[112:127]
    v_exp_f32 v88, v88
    v_exp_f32 v89, v89
    v_exp_f32 v90, v90
    v_smfmac_f32_32x32x32_bf16 a[16:31], a[120:123], v[80:87], v54
    v_exp_f32 v91, v91
    v_exp_f32 v92, v92
    v_exp_f32 v93, v93
    v_exp_f32 v94, v94
    v_exp_f32 v95, v95
    v_exp_f32 v96, v96
    v_exp_f32 v97, v97
    v_smfmac_f32_32x32x32_bf16 a[16:31], a[124:127], v[88:95], v54
    s_add_u32 m0, s65, 6144
    s_add_u32 s64, s64, s67
    s_mov_b32 s50, 0x80000000
    v_and_or_b32 v224, v210, s50, v224
    buffer_load_dwordx4 v224, s[32:35], s64 offen lds
    v_exp_f32 v98, v98
    v_exp_f32 v99, v99
    v_exp_f32 v100, v100
    v_mfma_f32_32x32x4bf16_1k v[64:95], a[118:119], a[80:81], v[128:159] cbsz:1 abid:1
    v_exp_f32 v101, v101
    v_exp_f32 v102, v102
    v_exp_f32 v103, v103
    v_exp_f32 v104, v104
    v_exp_f32 v105, v105
    v_exp_f32 v106, v106
    v_exp_f32 v107, v107
    v_exp_f32 v108, v108
    v_smfmac_f32_32x32x32_bf16 v[16:31], a[120:123], v[96:103], v54
    v_exp_f32 v109, v109
    v_exp_f32 v110, v110
    v_exp_f32 v111, v111
    v_exp_f32 v112, v112
    v_exp_f32 v113, v113
    v_smfmac_f32_32x32x32_bf16 v[16:31], a[124:127], v[104:111], v54
    v_exp_f32 v114, v114
    v_exp_f32 v115, v115
    v_exp_f32 v116, v116
    v_mfma_f32_32x32x16_bf16 v[64:79], a[114:117], a[64:67], v[64:79]
    v_exp_f32 v117, v117
    v_exp_f32 v118, v118
    v_exp_f32 v119, v119
    v_mfma_f32_32x32x16_bf16 v[80:95], a[114:117], a[68:71], v[80:95]
    v_exp_f32 v120, v120
    v_exp_f32 v121, v121
    v_exp_f32 v122, v122
    v_smfmac_f32_32x32x32_bf16 v[32:47], a[120:123], v[112:119], v54
    v_exp_f32 v123, v123
    v_exp_f32 v124, v124
    v_exp_f32 v125, v125
    v_exp_f32 v126, v126
    v_exp_f32 v127, v127
    v_exp_f32 v64, v64
    v_exp_f32 v65, v65
    v_smfmac_f32_32x32x32_bf16 v[32:47], a[124:127], v[120:127], v54
    s_waitcnt vmcnt(17)
    ds_read_b64_tr_b16 a[224:225], v225 offset:0
    ds_read_b64_tr_b16 a[226:227], v225 offset:256
    ds_read_b128 a[192:195], v226 offset:0
    ds_read_b64_tr_b16 a[228:229], v211 offset:0
    ds_read_b64_tr_b16 a[230:231], v211 offset:256
    ds_read_b128 a[196:199], v226 offset:32
    ds_read_b64_tr_b16 a[232:233], v225 offset:2048
    ds_read_b64_tr_b16 a[234:235], v225 offset:2304
    ds_read_b128 a[200:203], v226 offset:64
    ds_read_b64_tr_b16 a[236:237], v211 offset:2048
    ds_read_b64_tr_b16 a[238:239], v211 offset:2304
    ds_read_b128 a[204:207], v226 offset:96
    v_exp_f32 v66, v66
    v_exp_f32 v67, v67
    v_exp_f32 v68, v68
    v_mfma_f32_32x32x4bf16_1k v[96:127], a[118:119], a[82:83], v[160:191] cbsz:1 abid:1
    v_exp_f32 v69, v69
    v_exp_f32 v70, v70
    v_exp_f32 v71, v71
    v_exp_f32 v72, v72
    v_exp_f32 v73, v73
    v_exp_f32 v74, v74
    v_exp_f32 v75, v75
    v_exp_f32 v76, v76
    v_smfmac_f32_32x32x32_bf16 a[0:15], a[128:131], v[64:71], v54
    v_exp_f32 v77, v77
    v_exp_f32 v78, v78
    v_exp_f32 v79, v79
    v_exp_f32 v80, v80
    v_exp_f32 v81, v81
    v_smfmac_f32_32x32x32_bf16 a[0:15], a[132:135], v[72:79], v54
    v_exp_f32 v82, v82
    v_exp_f32 v83, v83
    v_exp_f32 v84, v84
    v_mfma_f32_32x32x16_bf16 v[96:111], a[114:117], a[72:75], v[96:111]
    v_exp_f32 v85, v85
    v_exp_f32 v86, v86
    v_exp_f32 v87, v87
    v_mfma_f32_32x32x16_bf16 v[112:127], a[114:117], a[76:79], v[112:127]
    v_exp_f32 v88, v88
    v_exp_f32 v89, v89
    v_exp_f32 v90, v90
    v_smfmac_f32_32x32x32_bf16 a[16:31], a[128:131], v[80:87], v54
    v_exp_f32 v91, v91
    v_exp_f32 v92, v92
    v_exp_f32 v93, v93
    v_exp_f32 v94, v94
    v_exp_f32 v95, v95
    v_exp_f32 v96, v96
    v_exp_f32 v97, v97
    v_smfmac_f32_32x32x32_bf16 a[16:31], a[132:135], v[88:95], v54
    s_add_u32 m0, s65, 7168
    s_add_u32 s64, s64, s66
    buffer_load_dwordx4 v224, s[32:35], s64 offen lds
    s_waitcnt lgkmcnt(0)
    buffer_store_dwordx4 a[224:227], v1, s[8:11], s70 offen sc1
    s_add_u32 s70, s70, s71
    buffer_store_dwordx4 a[228:231], v1, s[8:11], s70 offen sc1
    s_waitcnt vmcnt(13)
    v_exp_f32 v98, v98
    v_exp_f32 v99, v99
    v_exp_f32 v100, v100
    v_mfma_f32_32x32x4bf16_1k v[64:95], a[144:145], a[80:81], v[128:159] cbsz:1 abid:0
    v_exp_f32 v101, v101
    v_exp_f32 v102, v102
    v_exp_f32 v103, v103
    v_exp_f32 v104, v104
    v_exp_f32 v105, v105
    v_exp_f32 v106, v106
    v_exp_f32 v107, v107
    v_exp_f32 v108, v108
    v_smfmac_f32_32x32x32_bf16 v[16:31], a[128:131], v[96:103], v54
    v_exp_f32 v109, v109
    v_exp_f32 v110, v110
    v_exp_f32 v111, v111
    v_exp_f32 v112, v112
    v_exp_f32 v113, v113
    v_smfmac_f32_32x32x32_bf16 v[16:31], a[132:135], v[104:111], v54
    v_exp_f32 v114, v114
    v_exp_f32 v115, v115
    v_exp_f32 v116, v116
    v_mfma_f32_32x32x16_bf16 v[64:79], a[136:139], a[64:67], v[64:79]
    v_exp_f32 v117, v117
    v_exp_f32 v118, v118
    v_exp_f32 v119, v119
    v_mfma_f32_32x32x16_bf16 v[80:95], a[136:139], a[68:71], v[80:95]
    v_exp_f32 v120, v120
    v_exp_f32 v121, v121
    v_exp_f32 v122, v122
    v_smfmac_f32_32x32x32_bf16 v[32:47], a[128:131], v[112:119], v54
    v_exp_f32 v123, v123
    v_exp_f32 v124, v124
    v_exp_f32 v125, v125
    v_mfma_f32_32x32x16_bf16 a[32:47], a[192:195], a[224:227], 0
    v_exp_f32 v126, v126
    v_exp_f32 v127, v127
    v_exp_f32 v64, v64
    v_exp_f32 v65, v65
    v_smfmac_f32_32x32x32_bf16 v[32:47], a[132:135], v[120:127], v54
    buffer_load_dwordx2 a[118:119], v8, s[8:11], s26 offen offset:1024 sc1
    buffer_load_dwordx4 a[110:113], v0, s[8:11], s26 offen sc1
    v_exp_f32 v66, v66
    v_exp_f32 v67, v67
    v_exp_f32 v68, v68
    v_mfma_f32_32x32x4bf16_1k v[96:127], a[144:145], a[82:83], v[160:191] cbsz:1 abid:0
    v_exp_f32 v69, v69
    v_exp_f32 v70, v70
    v_exp_f32 v71, v71
    v_exp_f32 v72, v72
    v_exp_f32 v73, v73
    v_exp_f32 v74, v74
    v_exp_f32 v75, v75
    v_exp_f32 v76, v76
    v_smfmac_f32_32x32x32_bf16 a[0:15], a[146:149], v[64:71], v54
    buffer_load_dwordx4 a[120:123], v9, s[8:11], s26 offen offset:1280 sc1
    buffer_load_dwordx4 a[124:127], v9, s[8:11], s26 offen offset:1984 sc1
    v_exp_f32 v77, v77
    v_exp_f32 v78, v78
    v_exp_f32 v79, v79
    v_exp_f32 v80, v80
    v_exp_f32 v81, v81
    v_smfmac_f32_32x32x32_bf16 a[0:15], a[150:153], v[72:79], v54
    buffer_load_dwordx4 a[114:117], v254, s[8:11], s26 offen sc1
    buffer_load_dwordx4 a[128:131], v255, s[8:11], s26 offen offset:1280 sc1
    buffer_load_dwordx4 a[132:135], v255, s[8:11], s26 offen offset:1984 sc1
    v_exp_f32 v82, v82
    v_exp_f32 v83, v83
    v_exp_f32 v84, v84
    v_mfma_f32_32x32x16_bf16 v[96:111], a[136:139], a[72:75], v[96:111]
    v_exp_f32 v85, v85
    v_exp_f32 v86, v86
    v_exp_f32 v87, v87
    v_mfma_f32_32x32x16_bf16 v[112:127], a[136:139], a[76:79], v[112:127]
    v_exp_f32 v88, v88
    v_exp_f32 v89, v89
    v_exp_f32 v90, v90
    v_smfmac_f32_32x32x32_bf16 a[16:31], a[146:149], v[80:87], v54
    v_exp_f32 v91, v91
    v_exp_f32 v92, v92
    v_exp_f32 v93, v93
    v_mfma_f32_32x32x16_bf16 a[32:47], a[196:199], a[228:231], a[32:47]
    v_exp_f32 v94, v94
    v_exp_f32 v95, v95
    v_exp_f32 v96, v96
    v_exp_f32 v97, v97
    v_smfmac_f32_32x32x32_bf16 a[16:31], a[150:153], v[88:95], v54
    s_add_u32 s70, s70, s71
    buffer_store_dwordx4 a[232:235], v1, s[8:11], s70 offen sc1
    s_add_u32 s70, s70, s71
    buffer_store_dwordx4 a[236:239], v1, s[8:11], s70 offen sc1
    v_exp_f32 v98, v98
    v_exp_f32 v99, v99
    v_exp_f32 v100, v100
    v_mfma_f32_32x32x4bf16_1k v[64:95], a[144:145], a[80:81], v[128:159] cbsz:1 abid:1
    v_exp_f32 v101, v101
    v_exp_f32 v102, v102
    v_exp_f32 v103, v103
    v_exp_f32 v104, v104
    v_exp_f32 v105, v105
    v_exp_f32 v106, v106
    v_exp_f32 v107, v107
    v_exp_f32 v108, v108
    v_smfmac_f32_32x32x32_bf16 v[16:31], a[146:149], v[96:103], v54
    v_exp_f32 v109, v109
    v_exp_f32 v110, v110
    v_exp_f32 v111, v111
    v_exp_f32 v112, v112
    v_exp_f32 v113, v113
    v_smfmac_f32_32x32x32_bf16 v[16:31], a[150:153], v[104:111], v54
    v_exp_f32 v114, v114
    v_exp_f32 v115, v115
    v_exp_f32 v116, v116
    v_mfma_f32_32x32x16_bf16 v[64:79], a[140:143], a[64:67], v[64:79]
    v_exp_f32 v117, v117
    v_exp_f32 v118, v118
    v_exp_f32 v119, v119
    v_mfma_f32_32x32x16_bf16 v[80:95], a[140:143], a[68:71], v[80:95]
    v_exp_f32 v120, v120
    v_exp_f32 v121, v121
    v_exp_f32 v122, v122
    v_smfmac_f32_32x32x32_bf16 v[32:47], a[146:149], v[112:119], v54
    v_exp_f32 v123, v123
    v_exp_f32 v124, v124
    v_exp_f32 v125, v125
    v_mfma_f32_32x32x16_bf16 a[32:47], a[200:203], a[232:235], a[32:47]
    v_exp_f32 v126, v126
    v_exp_f32 v127, v127
    v_exp_f32 v64, v64
    v_exp_f32 v65, v65
    v_smfmac_f32_32x32x32_bf16 v[32:47], a[150:153], v[120:127], v54
    v_exp_f32 v66, v66
    v_exp_f32 v67, v67
    v_exp_f32 v68, v68
    v_mfma_f32_32x32x4bf16_1k v[96:127], a[144:145], a[82:83], v[160:191] cbsz:1 abid:1
    v_exp_f32 v69, v69
    v_exp_f32 v70, v70
    v_exp_f32 v71, v71
    v_exp_f32 v72, v72
    v_exp_f32 v73, v73
    v_exp_f32 v74, v74
    v_exp_f32 v75, v75
    v_exp_f32 v76, v76
    v_smfmac_f32_32x32x32_bf16 a[0:15], a[154:157], v[64:71], v54
    v_exp_f32 v77, v77
    v_exp_f32 v78, v78
    v_exp_f32 v79, v79
    v_exp_f32 v80, v80
    v_exp_f32 v81, v81
    v_smfmac_f32_32x32x32_bf16 a[0:15], a[158:161], v[72:79], v54
    v_exp_f32 v82, v82
    v_exp_f32 v83, v83
    v_exp_f32 v84, v84
    v_mfma_f32_32x32x16_bf16 v[96:111], a[140:143], a[72:75], v[96:111]
    v_exp_f32 v85, v85
    v_exp_f32 v86, v86
    v_exp_f32 v87, v87
    v_mfma_f32_32x32x16_bf16 v[112:127], a[140:143], a[76:79], v[112:127]
    v_exp_f32 v88, v88
    v_exp_f32 v89, v89
    v_exp_f32 v90, v90
    v_smfmac_f32_32x32x32_bf16 a[16:31], a[154:157], v[80:87], v54
    v_exp_f32 v91, v91
    v_exp_f32 v92, v92
    v_exp_f32 v93, v93
    v_mfma_f32_32x32x16_bf16 a[32:47], a[204:207], a[236:239], a[32:47]
    v_exp_f32 v94, v94
    v_exp_f32 v95, v95
    v_exp_f32 v96, v96
    v_exp_f32 v97, v97
    v_smfmac_f32_32x32x32_bf16 a[16:31], a[158:161], v[88:95], v54
    s_waitcnt vmcnt(13)
    v_exp_f32 v98, v98
    v_exp_f32 v99, v99
    v_exp_f32 v100, v100
    v_mfma_f32_32x32x4bf16_1k v[64:95], a[92:93], a[80:81], v[128:159] cbsz:1 abid:0
    v_exp_f32 v101, v101
    v_exp_f32 v102, v102
    v_exp_f32 v103, v103
    v_exp_f32 v104, v104
    v_exp_f32 v105, v105
    v_exp_f32 v106, v106
    v_exp_f32 v107, v107
    v_exp_f32 v108, v108
    v_smfmac_f32_32x32x32_bf16 v[16:31], a[154:157], v[96:103], v54
    v_exp_f32 v109, v109
    v_exp_f32 v110, v110
    v_exp_f32 v111, v111
    v_exp_f32 v112, v112
    v_exp_f32 v113, v113
    v_smfmac_f32_32x32x32_bf16 v[16:31], a[158:161], v[104:111], v54
    v_exp_f32 v114, v114
    v_exp_f32 v115, v115
    v_exp_f32 v116, v116
    v_mfma_f32_32x32x16_bf16 v[64:79], a[84:87], a[64:67], v[64:79]
    v_exp_f32 v117, v117
    v_exp_f32 v118, v118
    v_exp_f32 v119, v119
    v_mfma_f32_32x32x16_bf16 v[80:95], a[84:87], a[68:71], v[80:95]
    v_exp_f32 v120, v120
    v_exp_f32 v121, v121
    v_exp_f32 v122, v122
    v_smfmac_f32_32x32x32_bf16 v[32:47], a[154:157], v[112:119], v54
    v_exp_f32 v123, v123
    v_exp_f32 v124, v124
    v_exp_f32 v125, v125
    v_exp_f32 v126, v126
    v_exp_f32 v127, v127
    v_exp_f32 v64, v64
    v_exp_f32 v65, v65
    v_smfmac_f32_32x32x32_bf16 v[32:47], a[158:161], v[120:127], v54
    buffer_load_dwordx2 a[144:145], v8, s[8:11], s27 offen offset:1024 sc1
    buffer_load_dwordx4 a[136:139], v0, s[8:11], s27 offen sc1
    v_exp_f32 v66, v66
    v_exp_f32 v67, v67
    v_exp_f32 v68, v68
    v_mfma_f32_32x32x4bf16_1k v[96:127], a[92:93], a[82:83], v[160:191] cbsz:1 abid:0
    v_exp_f32 v69, v69
    v_exp_f32 v70, v70
    v_exp_f32 v71, v71
    v_exp_f32 v72, v72
    v_exp_f32 v73, v73
    v_exp_f32 v74, v74
    v_exp_f32 v75, v75
    v_exp_f32 v76, v76
    v_smfmac_f32_32x32x32_bf16 a[0:15], a[94:97], v[64:71], v54
    buffer_load_dwordx4 a[146:149], v9, s[8:11], s27 offen offset:1280 sc1
    buffer_load_dwordx4 a[150:153], v9, s[8:11], s27 offen offset:1984 sc1
    v_exp_f32 v77, v77
    v_exp_f32 v78, v78
    v_exp_f32 v79, v79
    v_exp_f32 v80, v80
    v_exp_f32 v81, v81
    v_smfmac_f32_32x32x32_bf16 a[0:15], a[98:101], v[72:79], v54
    buffer_load_dwordx4 a[140:143], v254, s[8:11], s27 offen sc1
    buffer_load_dwordx4 a[154:157], v255, s[8:11], s27 offen offset:1280 sc1
    buffer_load_dwordx4 a[158:161], v255, s[8:11], s27 offen offset:1984 sc1
    v_exp_f32 v82, v82
    v_exp_f32 v83, v83
    v_exp_f32 v84, v84
    v_mfma_f32_32x32x16_bf16 v[96:111], a[84:87], a[72:75], v[96:111]
    v_exp_f32 v85, v85
    v_exp_f32 v86, v86
    v_exp_f32 v87, v87
    v_mfma_f32_32x32x16_bf16 v[112:127], a[84:87], a[76:79], v[112:127]
    v_exp_f32 v88, v88
    v_exp_f32 v89, v89
    v_exp_f32 v90, v90
    v_smfmac_f32_32x32x32_bf16 a[16:31], a[94:97], v[80:87], v54
    v_exp_f32 v91, v91
    v_exp_f32 v92, v92
    v_exp_f32 v93, v93
    v_exp_f32 v94, v94
    v_exp_f32 v95, v95
    v_exp_f32 v96, v96
    v_exp_f32 v97, v97
    v_smfmac_f32_32x32x32_bf16 a[16:31], a[98:101], v[88:95], v54
    v_exp_f32 v98, v98
    v_exp_f32 v99, v99
    v_exp_f32 v100, v100
    v_mfma_f32_32x32x4bf16_1k v[64:95], a[92:93], a[80:81], v[128:159] cbsz:1 abid:1
    v_exp_f32 v101, v101
    v_exp_f32 v102, v102
    v_exp_f32 v103, v103
    v_exp_f32 v104, v104
    v_exp_f32 v105, v105
    v_exp_f32 v106, v106
    v_exp_f32 v107, v107
    v_exp_f32 v108, v108
    v_smfmac_f32_32x32x32_bf16 v[16:31], a[94:97], v[96:103], v54
    v_exp_f32 v109, v109
    v_exp_f32 v110, v110
    v_exp_f32 v111, v111
    v_exp_f32 v112, v112
    v_exp_f32 v113, v113
    v_smfmac_f32_32x32x32_bf16 v[16:31], a[98:101], v[104:111], v54
    v_exp_f32 v114, v114
    v_exp_f32 v115, v115
    v_exp_f32 v116, v116
    v_mfma_f32_32x32x16_bf16 v[64:79], a[88:91], a[64:67], v[64:79]
    v_exp_f32 v117, v117
    v_exp_f32 v118, v118
    v_exp_f32 v119, v119
    v_mfma_f32_32x32x16_bf16 v[80:95], a[88:91], a[68:71], v[80:95]
    v_exp_f32 v120, v120
    v_exp_f32 v121, v121
    v_exp_f32 v122, v122
    v_smfmac_f32_32x32x32_bf16 v[32:47], a[94:97], v[112:119], v54
    v_exp_f32 v123, v123
    v_exp_f32 v124, v124
    v_exp_f32 v125, v125
    v_exp_f32 v126, v126
    v_exp_f32 v127, v127
    v_exp_f32 v64, v64
    v_exp_f32 v65, v65
    v_smfmac_f32_32x32x32_bf16 v[32:47], a[98:101], v[120:127], v54
    s_waitcnt vmcnt(16)
    ds_read_b64_tr_b16 a[240:241], v212 offset:4096
    ds_read_b64_tr_b16 a[242:243], v212 offset:4352
    ds_read_b128 a[208:211], v226 offset:128
    ds_read_b64_tr_b16 a[244:245], v211 offset:4096
    ds_read_b64_tr_b16 a[246:247], v211 offset:4352
    ds_read_b128 a[212:215], v226 offset:160
    ds_read_b64_tr_b16 a[248:249], v225 offset:6144
    ds_read_b64_tr_b16 a[250:251], v225 offset:6400
    ds_read_b128 a[216:219], v226 offset:192
    ds_read_b64_tr_b16 a[252:253], v211 offset:6144
    ds_read_b64_tr_b16 a[254:255], v211 offset:6400
    ds_read_b128 a[220:223], v226 offset:224
    v_exp_f32 v66, v66
    v_exp_f32 v67, v67
    v_exp_f32 v68, v68
    v_mfma_f32_32x32x4bf16_1k v[96:127], a[92:93], a[82:83], v[160:191] cbsz:1 abid:1
    v_exp_f32 v69, v69
    v_exp_f32 v70, v70
    v_exp_f32 v71, v71
    v_exp_f32 v72, v72
    v_exp_f32 v73, v73
    v_exp_f32 v74, v74
    v_exp_f32 v75, v75
    v_exp_f32 v76, v76
    v_smfmac_f32_32x32x32_bf16 a[0:15], a[102:105], v[64:71], v54
    v_exp_f32 v77, v77
    v_exp_f32 v78, v78
    v_exp_f32 v79, v79
    v_exp_f32 v80, v80
    v_exp_f32 v81, v81
    v_smfmac_f32_32x32x32_bf16 a[0:15], a[106:109], v[72:79], v54
    v_exp_f32 v82, v82
    v_exp_f32 v83, v83
    v_exp_f32 v84, v84
    v_mfma_f32_32x32x16_bf16 v[96:111], a[88:91], a[72:75], v[96:111]
    v_exp_f32 v85, v85
    v_exp_f32 v86, v86
    v_exp_f32 v87, v87
    v_mfma_f32_32x32x16_bf16 v[112:127], a[88:91], a[76:79], v[112:127]
    v_exp_f32 v88, v88
    v_exp_f32 v89, v89
    v_exp_f32 v90, v90
    v_smfmac_f32_32x32x32_bf16 a[16:31], a[102:105], v[80:87], v54
    v_exp_f32 v91, v91
    v_exp_f32 v92, v92
    v_exp_f32 v93, v93
    v_exp_f32 v94, v94
    v_exp_f32 v95, v95
    v_exp_f32 v96, v96
    v_exp_f32 v97, v97
    v_smfmac_f32_32x32x32_bf16 a[16:31], a[106:109], v[88:95], v54
    s_waitcnt lgkmcnt(0)
    s_add_u32 s70, s70, s71
    buffer_store_dwordx4 a[240:243], v1, s[8:11], s70 offen sc1
    s_add_u32 s70, s70, s71
    buffer_store_dwordx4 a[244:247], v210, s[8:11], s70 offen sc1
    s_waitcnt vmcnt(11)
    v_exp_f32 v98, v98
    v_exp_f32 v99, v99
    v_exp_f32 v100, v100
    v_mfma_f32_32x32x4bf16_1k v[64:95], a[118:119], a[80:81], v[128:159] cbsz:1 abid:0
    v_exp_f32 v101, v101
    v_exp_f32 v102, v102
    v_exp_f32 v103, v103
    v_exp_f32 v104, v104
    v_exp_f32 v105, v105
    v_exp_f32 v106, v106
    v_exp_f32 v107, v107
    v_exp_f32 v108, v108
    v_smfmac_f32_32x32x32_bf16 v[16:31], a[102:105], v[96:103], v54
    v_exp_f32 v109, v109
    v_exp_f32 v110, v110
    v_exp_f32 v111, v111
    v_exp_f32 v112, v112
    v_exp_f32 v113, v113
    v_smfmac_f32_32x32x32_bf16 v[16:31], a[106:109], v[104:111], v54
    v_exp_f32 v114, v114
    v_exp_f32 v115, v115
    v_exp_f32 v116, v116
    v_mfma_f32_32x32x16_bf16 v[64:79], a[110:113], a[64:67], v[64:79]
    v_exp_f32 v117, v117
    v_exp_f32 v118, v118
    v_exp_f32 v119, v119
    v_mfma_f32_32x32x16_bf16 v[80:95], a[110:113], a[68:71], v[80:95]
    v_exp_f32 v120, v120
    v_exp_f32 v121, v121
    v_exp_f32 v122, v122
    v_smfmac_f32_32x32x32_bf16 v[32:47], a[102:105], v[112:119], v54
    v_exp_f32 v123, v123
    v_exp_f32 v124, v124
    v_exp_f32 v125, v125
    v_mfma_f32_32x32x16_bf16 a[32:47], a[208:211], a[240:243], a[32:47]
    v_exp_f32 v126, v126
    v_exp_f32 v127, v127
    v_exp_f32 v64, v64
    v_exp_f32 v65, v65
    v_smfmac_f32_32x32x32_bf16 v[32:47], a[106:109], v[120:127], v54
    buffer_load_dwordx2 a[92:93], v8, s[8:11], s28 offen offset:1024 sc1
    buffer_load_dwordx4 a[84:87], v0, s[8:11], s28 offen sc1
    s_add_u32 m0, s65, 0
    s_add_u32 s50, s82, 0
    buffer_load_dwordx4 v248, s[12:15], s50 offen lds
    s_add_u32 m0, s65, 1024
    s_add_u32 s50, s82, 7680
    buffer_load_dwordx4 v248, s[12:15], s50 offen lds
    s_add_u32 m0, s65, 2048
    s_add_u32 s50, s82, 15360
    buffer_load_dwordx4 v249, s[12:15], s50 offen lds
    v_exp_f32 v66, v66
    v_exp_f32 v67, v67
    v_exp_f32 v68, v68
    v_mfma_f32_32x32x4bf16_1k v[96:127], a[118:119], a[82:83], v[160:191] cbsz:1 abid:0
    v_exp_f32 v69, v69
    v_exp_f32 v70, v70
    v_exp_f32 v71, v71
    v_exp_f32 v72, v72
    v_exp_f32 v73, v73
    v_exp_f32 v74, v74
    v_exp_f32 v75, v75
    v_exp_f32 v76, v76
L_pg0_3:
    s_cbranch_execz L_wr0
    v_smfmac_f32_32x32x32_bf16 a[0:15], a[120:123], v[64:71], v54
    buffer_load_dwordx4 a[94:97], v9, s[8:11], s28 offen offset:1280 sc1
    buffer_load_dwordx4 a[98:101], v9, s[8:11], s28 offen offset:1984 sc1
    v_exp_f32 v77, v77
    v_exp_f32 v78, v78
    v_exp_f32 v79, v79
    v_exp_f32 v80, v80
    v_exp_f32 v81, v81
    v_smfmac_f32_32x32x32_bf16 a[0:15], a[124:127], v[72:79], v54
    buffer_load_dwordx4 a[88:91], v254, s[8:11], s28 offen sc1
    buffer_load_dwordx4 a[102:105], v255, s[8:11], s28 offen offset:1280 sc1
    buffer_load_dwordx4 a[106:109], v255, s[8:11], s28 offen offset:1984 sc1
    v_exp_f32 v82, v82
    v_exp_f32 v83, v83
    v_exp_f32 v84, v84
    v_mfma_f32_32x32x16_bf16 v[96:111], a[110:113], a[72:75], v[96:111]
    v_exp_f32 v85, v85
    v_exp_f32 v86, v86
    v_exp_f32 v87, v87
    v_mfma_f32_32x32x16_bf16 v[112:127], a[110:113], a[76:79], v[112:127]
    v_exp_f32 v88, v88
    v_exp_f32 v89, v89
    v_exp_f32 v90, v90
    v_smfmac_f32_32x32x32_bf16 a[16:31], a[120:123], v[80:87], v54
    v_exp_f32 v91, v91
    v_exp_f32 v92, v92
    v_exp_f32 v93, v93
    v_mfma_f32_32x32x16_bf16 a[32:47], a[212:215], a[244:247], a[32:47]
    v_exp_f32 v94, v94
    v_exp_f32 v95, v95
    v_exp_f32 v96, v96
    v_exp_f32 v97, v97
    v_smfmac_f32_32x32x32_bf16 a[16:31], a[124:127], v[88:95], v54
    s_add_u32 s70, s70, s71
    buffer_store_dwordx4 a[248:251], v210, s[8:11], s70 offen sc1
    s_add_u32 s70, s70, s71
    buffer_store_dwordx4 a[252:255], v210, s[8:11], s70 offen sc1
    v_exp_f32 v98, v98
    v_exp_f32 v99, v99
    v_exp_f32 v100, v100
    v_mfma_f32_32x32x4bf16_1k v[64:95], a[118:119], a[80:81], v[128:159] cbsz:1 abid:1
    v_exp_f32 v101, v101
    v_exp_f32 v102, v102
    v_exp_f32 v103, v103
    v_exp_f32 v104, v104
    v_exp_f32 v105, v105
    v_exp_f32 v106, v106
    v_exp_f32 v107, v107
    v_exp_f32 v108, v108
    v_smfmac_f32_32x32x32_bf16 v[16:31], a[120:123], v[96:103], v54
    v_exp_f32 v109, v109
    v_exp_f32 v110, v110
    v_exp_f32 v111, v111
    v_exp_f32 v112, v112
    v_exp_f32 v113, v113
    v_smfmac_f32_32x32x32_bf16 v[16:31], a[124:127], v[104:111], v54
    v_exp_f32 v114, v114
    v_exp_f32 v115, v115
    v_exp_f32 v116, v116
    v_mfma_f32_32x32x16_bf16 v[64:79], a[114:117], a[64:67], v[64:79]
    v_exp_f32 v117, v117
    v_exp_f32 v118, v118
    v_exp_f32 v119, v119
    v_mfma_f32_32x32x16_bf16 v[80:95], a[114:117], a[68:71], v[80:95]
    v_exp_f32 v120, v120
    v_exp_f32 v121, v121
    v_exp_f32 v122, v122
    v_smfmac_f32_32x32x32_bf16 v[32:47], a[120:123], v[112:119], v54
    v_exp_f32 v123, v123
    v_exp_f32 v124, v124
    v_exp_f32 v125, v125
    v_mfma_f32_32x32x16_bf16 a[32:47], a[216:219], a[248:251], a[32:47]
    v_exp_f32 v126, v126
    v_exp_f32 v127, v127
    v_exp_f32 v64, v64
    v_exp_f32 v65, v65
    v_smfmac_f32_32x32x32_bf16 v[32:47], a[124:127], v[120:127], v54
    v_exp_f32 v66, v66
    v_exp_f32 v67, v67
    v_exp_f32 v68, v68
    v_mfma_f32_32x32x4bf16_1k v[96:127], a[118:119], a[82:83], v[160:191] cbsz:1 abid:1
    v_exp_f32 v69, v69
    v_exp_f32 v70, v70
    v_exp_f32 v71, v71
    v_exp_f32 v72, v72
    v_exp_f32 v73, v73
    v_exp_f32 v74, v74
    v_exp_f32 v75, v75
    v_exp_f32 v76, v76
    v_smfmac_f32_32x32x32_bf16 a[0:15], a[128:131], v[64:71], v54
    v_exp_f32 v77, v77
    v_exp_f32 v78, v78
    v_exp_f32 v79, v79
    v_exp_f32 v80, v80
    v_exp_f32 v81, v81
    v_smfmac_f32_32x32x32_bf16 a[0:15], a[132:135], v[72:79], v54
    v_exp_f32 v82, v82
    v_exp_f32 v83, v83
    v_exp_f32 v84, v84
    v_mfma_f32_32x32x16_bf16 v[96:111], a[114:117], a[72:75], v[96:111]
    v_exp_f32 v85, v85
    v_exp_f32 v86, v86
    v_exp_f32 v87, v87
    v_mfma_f32_32x32x16_bf16 v[112:127], a[114:117], a[76:79], v[112:127]
    v_exp_f32 v88, v88
    v_exp_f32 v89, v89
    v_exp_f32 v90, v90
    v_smfmac_f32_32x32x32_bf16 a[16:31], a[128:131], v[80:87], v54
    v_exp_f32 v91, v91
    v_exp_f32 v92, v92
    v_exp_f32 v93, v93
    v_mfma_f32_32x32x16_bf16 a[32:47], a[220:223], a[252:255], a[32:47]
    v_exp_f32 v94, v94
    v_exp_f32 v95, v95
    v_exp_f32 v96, v96
    v_exp_f32 v97, v97
    v_smfmac_f32_32x32x32_bf16 a[16:31], a[132:135], v[88:95], v54
    s_waitcnt vmcnt(14)
    v_exp_f32 v98, v98
    v_exp_f32 v99, v99
    v_exp_f32 v100, v100
    v_mfma_f32_32x32x4bf16_1k v[64:95], a[144:145], a[80:81], v[128:159] cbsz:1 abid:0
    v_exp_f32 v101, v101
    v_exp_f32 v102, v102
    v_exp_f32 v103, v103
    v_exp_f32 v104, v104
    v_exp_f32 v105, v105
    v_exp_f32 v106, v106
    v_exp_f32 v107, v107
    v_exp_f32 v108, v108
    v_smfmac_f32_32x32x32_bf16 v[16:31], a[128:131], v[96:103], v54
    v_exp_f32 v109, v109
    v_exp_f32 v110, v110
    v_exp_f32 v111, v111
    v_exp_f32 v112, v112
    v_exp_f32 v113, v113
    v_smfmac_f32_32x32x32_bf16 v[16:31], a[132:135], v[104:111], v54
    v_exp_f32 v114, v114
    v_exp_f32 v115, v115
    v_exp_f32 v116, v116
    v_mfma_f32_32x32x16_bf16 v[64:79], a[136:139], a[64:67], v[64:79]
    v_exp_f32 v117, v117
    v_exp_f32 v118, v118
    v_exp_f32 v119, v119
    v_mfma_f32_32x32x16_bf16 v[80:95], a[136:139], a[68:71], v[80:95]
    v_exp_f32 v120, v120
    v_exp_f32 v121, v121
    v_exp_f32 v122, v122
    v_smfmac_f32_32x32x32_bf16 v[32:47], a[128:131], v[112:119], v54
    v_exp_f32 v123, v123
    v_exp_f32 v124, v124
    v_exp_f32 v125, v125
    v_exp_f32 v126, v126
    v_exp_f32 v127, v127
    v_exp_f32 v64, v64
    v_exp_f32 v65, v65
    v_smfmac_f32_32x32x32_bf16 v[32:47], a[132:135], v[120:127], v54
    buffer_load_dwordx2 a[118:119], v8, s[8:11], s29 offen offset:1024 sc1
    buffer_load_dwordx4 a[110:113], v0, s[8:11], s29 offen sc1
    buffer_store_dwordx2 a[32:33], v227, s[8:11], s78 offen sc1
    v_exp_f32 v66, v66
    v_exp_f32 v67, v67
    v_exp_f32 v68, v68
    v_mfma_f32_32x32x4bf16_1k v[96:127], a[144:145], a[82:83], v[160:191] cbsz:1 abid:0
    v_exp_f32 v69, v69
    v_exp_f32 v70, v70
    v_exp_f32 v71, v71
    v_exp_f32 v72, v72
    v_exp_f32 v73, v73
    v_exp_f32 v74, v74
    v_exp_f32 v75, v75
    v_exp_f32 v76, v76
    v_smfmac_f32_32x32x32_bf16 a[0:15], a[146:149], v[64:71], v54
    buffer_load_dwordx4 a[120:123], v9, s[8:11], s29 offen offset:1280 sc1
    buffer_load_dwordx4 a[124:127], v9, s[8:11], s29 offen offset:1984 sc1
    buffer_store_dwordx4 a[48:51], v229, s[8:11], s88 offen sc1
    v_exp_f32 v77, v77
    v_exp_f32 v78, v78
    v_exp_f32 v79, v79
    v_exp_f32 v80, v80
    v_exp_f32 v81, v81
    v_smfmac_f32_32x32x32_bf16 a[0:15], a[150:153], v[72:79], v54
    buffer_load_dwordx4 a[114:117], v254, s[8:11], s29 offen sc1
    buffer_load_dwordx4 a[128:131], v255, s[8:11], s29 offen offset:1280 sc1
    buffer_load_dwordx4 a[132:135], v255, s[8:11], s29 offen offset:1984 sc1
    v_exp_f32 v82, v82
    v_exp_f32 v83, v83
    v_exp_f32 v84, v84
    v_mfma_f32_32x32x16_bf16 v[96:111], a[136:139], a[72:75], v[96:111]
    v_exp_f32 v85, v85
    v_exp_f32 v86, v86
    v_exp_f32 v87, v87
    v_mfma_f32_32x32x16_bf16 v[112:127], a[136:139], a[76:79], v[112:127]
    v_exp_f32 v88, v88
    v_exp_f32 v89, v89
    v_exp_f32 v90, v90
    v_smfmac_f32_32x32x32_bf16 a[16:31], a[146:149], v[80:87], v54
    v_exp_f32 v91, v91
    v_exp_f32 v92, v92
    v_exp_f32 v93, v93
    v_exp_f32 v94, v94
    v_exp_f32 v95, v95
    v_exp_f32 v96, v96
    v_exp_f32 v97, v97
    v_smfmac_f32_32x32x32_bf16 a[16:31], a[150:153], v[88:95], v54
    v_exp_f32 v98, v98
    v_exp_f32 v99, v99
    v_exp_f32 v100, v100
    v_mfma_f32_32x32x4bf16_1k v[64:95], a[144:145], a[80:81], v[128:159] cbsz:1 abid:1
    v_exp_f32 v101, v101
    v_exp_f32 v102, v102
    v_exp_f32 v103, v103
    v_exp_f32 v104, v104
    v_exp_f32 v105, v105
    v_exp_f32 v106, v106
    v_exp_f32 v107, v107
    v_exp_f32 v108, v108
    v_smfmac_f32_32x32x32_bf16 v[16:31], a[146:149], v[96:103], v54
    v_exp_f32 v109, v109
    v_exp_f32 v110, v110
    v_exp_f32 v111, v111
    v_exp_f32 v112, v112
    v_exp_f32 v113, v113
    v_smfmac_f32_32x32x32_bf16 v[16:31], a[150:153], v[104:111], v54
    v_exp_f32 v114, v114
    v_exp_f32 v115, v115
    v_exp_f32 v116, v116
    v_mfma_f32_32x32x16_bf16 v[64:79], a[140:143], a[64:67], v[64:79]
    v_exp_f32 v117, v117
    v_exp_f32 v118, v118
    v_exp_f32 v119, v119
    v_mfma_f32_32x32x16_bf16 v[80:95], a[140:143], a[68:71], v[80:95]
    v_exp_f32 v120, v120
    v_exp_f32 v121, v121
    v_exp_f32 v122, v122
    v_smfmac_f32_32x32x32_bf16 v[32:47], a[146:149], v[112:119], v54
    v_exp_f32 v123, v123
    v_exp_f32 v124, v124
    v_exp_f32 v125, v125
    v_exp_f32 v126, v126
    v_exp_f32 v127, v127
    v_exp_f32 v64, v64
    v_exp_f32 v65, v65
    v_smfmac_f32_32x32x32_bf16 v[32:47], a[150:153], v[120:127], v54
    buffer_store_dwordx4 a[48:51], v229, s[8:11], s90 offen sc1
    v_exp_f32 v66, v66
    v_exp_f32 v67, v67
    v_exp_f32 v68, v68
    v_mfma_f32_32x32x4bf16_1k v[96:127], a[144:145], a[82:83], v[160:191] cbsz:1 abid:1
    v_exp_f32 v69, v69
    v_exp_f32 v70, v70
    v_exp_f32 v71, v71
    v_exp_f32 v72, v72
    v_exp_f32 v73, v73
    v_exp_f32 v74, v74
    v_exp_f32 v75, v75
    v_exp_f32 v76, v76
    v_smfmac_f32_32x32x32_bf16 a[0:15], a[154:157], v[64:71], v54
    v_exp_f32 v77, v77
    v_exp_f32 v78, v78
    v_exp_f32 v79, v79
    v_exp_f32 v80, v80
    v_exp_f32 v81, v81
    v_smfmac_f32_32x32x32_bf16 a[0:15], a[158:161], v[72:79], v54
    v_exp_f32 v82, v82
    v_exp_f32 v83, v83
    v_exp_f32 v84, v84
    v_mfma_f32_32x32x16_bf16 v[96:111], a[140:143], a[72:75], v[96:111]
    v_exp_f32 v85, v85
    v_exp_f32 v86, v86
    v_exp_f32 v87, v87
    v_mfma_f32_32x32x16_bf16 v[112:127], a[140:143], a[76:79], v[112:127]
    v_exp_f32 v88, v88
    v_exp_f32 v89, v89
    v_exp_f32 v90, v90
    v_smfmac_f32_32x32x32_bf16 a[16:31], a[154:157], v[80:87], v54
    v_exp_f32 v91, v91
    v_exp_f32 v92, v92
    v_exp_f32 v93, v93
    v_exp_f32 v94, v94
    v_exp_f32 v95, v95
    v_exp_f32 v96, v96
    v_exp_f32 v97, v97
    v_smfmac_f32_32x32x32_bf16 a[16:31], a[158:161], v[88:95], v54
    s_waitcnt vmcnt(12)
    v_exp_f32 v98, v98
    v_exp_f32 v99, v99
    v_exp_f32 v100, v100
    v_mfma_f32_32x32x4bf16_1k v[64:95], a[92:93], a[80:81], v[128:159] cbsz:1 abid:0
    v_exp_f32 v101, v101
    v_exp_f32 v102, v102
    v_exp_f32 v103, v103
    v_exp_f32 v104, v104
    v_exp_f32 v105, v105
    v_exp_f32 v106, v106
    v_exp_f32 v107, v107
    v_exp_f32 v108, v108
    v_smfmac_f32_32x32x32_bf16 v[16:31], a[154:157], v[96:103], v54
    v_exp_f32 v109, v109
    v_exp_f32 v110, v110
    v_exp_f32 v111, v111
    v_exp_f32 v112, v112
    v_exp_f32 v113, v113
    v_smfmac_f32_32x32x32_bf16 v[16:31], a[158:161], v[104:111], v54
    v_exp_f32 v114, v114
    v_exp_f32 v115, v115
    v_exp_f32 v116, v116
    v_mfma_f32_32x32x16_bf16 v[64:79], a[84:87], a[64:67], v[64:79]
    v_exp_f32 v117, v117
    v_exp_f32 v118, v118
    v_exp_f32 v119, v119
    v_mfma_f32_32x32x16_bf16 v[80:95], a[84:87], a[68:71], v[80:95]
    v_exp_f32 v120, v120
    v_exp_f32 v121, v121
    v_exp_f32 v122, v122
    v_smfmac_f32_32x32x32_bf16 v[32:47], a[154:157], v[112:119], v54
    s_and_b32 s50, s3, 1
    s_mul_i32 s50, s50, 40952
    s_add_u32 s50, s50, s89
    buffer_store_dwordx4 a[48:51], v228, s[8:11], s50 offen offset:512 sc1
    v_exp_f32 v123, v123
    v_exp_f32 v124, v124
    v_exp_f32 v125, v125
    v_exp_f32 v126, v126
    v_exp_f32 v127, v127
    v_exp_f32 v64, v64
    v_exp_f32 v65, v65
    v_smfmac_f32_32x32x32_bf16 v[32:47], a[158:161], v[120:127], v54
    buffer_load_dwordx2 a[144:145], v8, s[8:11], s30 offen offset:1024 sc1
    buffer_load_dwordx4 a[136:139], v0, s[8:11], s30 offen sc1
    s_waitcnt vmcnt(10)
    buffer_atomic_swap v4, v7, s[8:11], s79 offen offset:0 sc1
    ds_read_b128 v[192:195], v250
    ds_read_b128 v[196:199], v250 offset:64
    ds_read_b64 v[200:201], v251 offset:128
    v_exp_f32 v66, v66
    v_exp_f32 v67, v67
    v_exp_f32 v68, v68
    v_mfma_f32_32x32x4bf16_1k v[96:127], a[92:93], a[82:83], v[160:191] cbsz:1 abid:0
    v_exp_f32 v69, v69
    v_exp_f32 v70, v70
    v_exp_f32 v71, v71
    v_exp_f32 v72, v72
    v_exp_f32 v73, v73
    v_exp_f32 v74, v74
    v_exp_f32 v75, v75
    v_exp_f32 v76, v76
    v_smfmac_f32_32x32x32_bf16 a[0:15], a[94:97], v[64:71], v54
    buffer_load_dwordx4 a[146:149], v9, s[8:11], s30 offen offset:1280 sc1
    buffer_load_dwordx4 a[150:153], v9, s[8:11], s30 offen offset:1984 sc1
    v_exp_f32 v77, v77
    v_exp_f32 v78, v78
    v_exp_f32 v79, v79
    v_exp_f32 v80, v80
    v_exp_f32 v81, v81
    v_smfmac_f32_32x32x32_bf16 a[0:15], a[98:101], v[72:79], v54
    buffer_load_dwordx4 a[140:143], v254, s[8:11], s30 offen sc1
    buffer_load_dwordx4 a[154:157], v255, s[8:11], s30 offen offset:1280 sc1
    buffer_load_dwordx4 a[158:161], v255, s[8:11], s30 offen offset:1984 sc1
    v_exp_f32 v82, v82
    v_exp_f32 v83, v83
    v_exp_f32 v84, v84
    v_mfma_f32_32x32x16_bf16 v[96:111], a[84:87], a[72:75], v[96:111]
    v_exp_f32 v85, v85
    v_exp_f32 v86, v86
    v_exp_f32 v87, v87
    v_mfma_f32_32x32x16_bf16 v[112:127], a[84:87], a[76:79], v[112:127]
    v_exp_f32 v88, v88
    v_exp_f32 v89, v89
    v_exp_f32 v90, v90
    v_smfmac_f32_32x32x32_bf16 a[16:31], a[94:97], v[80:87], v54
    v_exp_f32 v91, v91
    v_exp_f32 v92, v92
    v_exp_f32 v93, v93
    v_exp_f32 v94, v94
    v_exp_f32 v95, v95
    v_exp_f32 v96, v96
    v_exp_f32 v97, v97
    v_smfmac_f32_32x32x32_bf16 a[16:31], a[98:101], v[88:95], v54
    s_waitcnt lgkmcnt(0)
    v_exp_f32 v98, v98
    v_exp_f32 v99, v99
    v_exp_f32 v100, v100
    v_mfma_f32_32x32x4bf16_1k v[64:95], a[92:93], a[80:81], v[128:159] cbsz:1 abid:1
    v_exp_f32 v101, v101
    v_exp_f32 v102, v102
    v_exp_f32 v103, v103
    v_exp_f32 v104, v104
    v_exp_f32 v105, v105
    v_exp_f32 v106, v106
    v_exp_f32 v107, v107
    v_exp_f32 v108, v108
    v_smfmac_f32_32x32x32_bf16 v[16:31], a[94:97], v[96:103], v54
    v_exp_f32 v109, v109
    v_exp_f32 v110, v110
    v_exp_f32 v111, v111
    v_exp_f32 v112, v112
    v_exp_f32 v113, v113
    v_smfmac_f32_32x32x32_bf16 v[16:31], a[98:101], v[104:111], v54
    buffer_store_dwordx4 a[48:51], v1, s[8:11], s36 offen offset:0 sc1
    v_exp_f32 v114, v114
    v_exp_f32 v115, v115
    v_exp_f32 v116, v116
    v_mfma_f32_32x32x16_bf16 v[64:79], a[88:91], a[64:67], v[64:79]
    v_exp_f32 v117, v117
    v_exp_f32 v118, v118
    v_exp_f32 v119, v119
    v_mfma_f32_32x32x16_bf16 v[80:95], a[88:91], a[68:71], v[80:95]
    v_exp_f32 v120, v120
    v_exp_f32 v121, v121
    v_exp_f32 v122, v122
    v_smfmac_f32_32x32x32_bf16 v[32:47], a[94:97], v[112:119], v54
    v_exp_f32 v123, v123
    v_exp_f32 v124, v124
    v_exp_f32 v125, v125
    v_exp_f32 v126, v126
    v_exp_f32 v127, v127
    v_exp_f32 v64, v64
    v_exp_f32 v65, v65
    v_smfmac_f32_32x32x32_bf16 v[32:47], a[98:101], v[120:127], v54
    v_exp_f32 v66, v66
    v_exp_f32 v67, v67
    v_exp_f32 v68, v68
    v_mfma_f32_32x32x4bf16_1k v[96:127], a[92:93], a[82:83], v[160:191] cbsz:1 abid:1
    v_exp_f32 v69, v69
    v_exp_f32 v70, v70
    v_exp_f32 v71, v71
    v_exp_f32 v72, v72
    v_exp_f32 v73, v73
    v_exp_f32 v74, v74
    v_exp_f32 v75, v75
    v_exp_f32 v76, v76
    v_smfmac_f32_32x32x32_bf16 a[0:15], a[102:105], v[64:71], v54
    v_exp_f32 v77, v77
    v_exp_f32 v78, v78
    v_exp_f32 v79, v79
    v_exp_f32 v80, v80
    v_exp_f32 v81, v81
    v_smfmac_f32_32x32x32_bf16 a[0:15], a[106:109], v[72:79], v54
    v_exp_f32 v82, v82
    v_exp_f32 v83, v83
    v_exp_f32 v84, v84
    v_mfma_f32_32x32x16_bf16 v[96:111], a[88:91], a[72:75], v[96:111]
    v_exp_f32 v85, v85
    v_exp_f32 v86, v86
    v_exp_f32 v87, v87
    v_mfma_f32_32x32x16_bf16 v[112:127], a[88:91], a[76:79], v[112:127]
    v_exp_f32 v88, v88
    v_exp_f32 v89, v89
    v_exp_f32 v90, v90
    v_smfmac_f32_32x32x32_bf16 a[16:31], a[102:105], v[80:87], v54
    v_exp_f32 v91, v91
    v_exp_f32 v92, v92
    v_exp_f32 v93, v93
    v_exp_f32 v94, v94
    v_exp_f32 v95, v95
    v_exp_f32 v96, v96
    v_exp_f32 v97, v97
    v_smfmac_f32_32x32x32_bf16 a[16:31], a[106:109], v[88:95], v54
    s_waitcnt vmcnt(11)
    v_exp_f32 v98, v98
    v_exp_f32 v99, v99
    v_exp_f32 v100, v100
    v_mfma_f32_32x32x4bf16_1k v[64:95], a[118:119], a[80:81], v[128:159] cbsz:1 abid:0
    v_exp_f32 v101, v101
    v_exp_f32 v102, v102
    v_exp_f32 v103, v103
    v_exp_f32 v104, v104
    v_exp_f32 v105, v105
    v_exp_f32 v106, v106
    v_exp_f32 v107, v107
    v_exp_f32 v108, v108
    v_smfmac_f32_32x32x32_bf16 v[16:31], a[102:105], v[96:103], v54
    buffer_store_dwordx4 a[48:51], v1, s[8:11], s36 offen offset:1024 sc1
    v_exp_f32 v109, v109
    v_exp_f32 v110, v110
    v_exp_f32 v111, v111
    v_exp_f32 v112, v112
    v_exp_f32 v113, v113
    v_smfmac_f32_32x32x32_bf16 v[16:31], a[106:109], v[104:111], v54
    v_exp_f32 v114, v114
    v_exp_f32 v115, v115
    v_exp_f32 v116, v116
    v_mfma_f32_32x32x16_bf16 v[64:79], a[110:113], a[64:67], v[64:79]
    v_exp_f32 v117, v117
    v_exp_f32 v118, v118
    v_exp_f32 v119, v119
    v_mfma_f32_32x32x16_bf16 v[80:95], a[110:113], a[68:71], v[80:95]
    v_exp_f32 v120, v120
    v_exp_f32 v121, v121
    v_exp_f32 v122, v122
    v_smfmac_f32_32x32x32_bf16 v[32:47], a[102:105], v[112:119], v54
    v_exp_f32 v123, v123
    v_exp_f32 v124, v124
    v_exp_f32 v125, v125
    v_exp_f32 v126, v126
    v_exp_f32 v127, v127
    v_exp_f32 v64, v64
    v_exp_f32 v65, v65
    v_smfmac_f32_32x32x32_bf16 v[32:47], a[106:109], v[120:127], v54
    buffer_load_dwordx2 a[92:93], v8, s[8:11], s31 offen offset:1024 sc1
    buffer_load_dwordx4 a[84:87], v0, s[8:11], s31 offen sc1
    v_exp_f32 v66, v66
    v_exp_f32 v67, v67
    v_exp_f32 v68, v68
    v_mfma_f32_32x32x4bf16_1k v[96:127], a[118:119], a[82:83], v[160:191] cbsz:1 abid:0
    v_exp_f32 v69, v69
    v_exp_f32 v70, v70
    v_exp_f32 v71, v71
    v_exp_f32 v72, v72
    v_exp_f32 v73, v73
    v_exp_f32 v74, v74
    v_exp_f32 v75, v75
    v_exp_f32 v76, v76
    v_smfmac_f32_32x32x32_bf16 a[0:15], a[120:123], v[64:71], v54
    buffer_load_dwordx4 a[94:97], v9, s[8:11], s31 offen offset:1280 sc1
    buffer_load_dwordx4 a[98:101], v9, s[8:11], s31 offen offset:1984 sc1
    v_exp_f32 v77, v77
    v_exp_f32 v78, v78
    v_exp_f32 v79, v79
    v_exp_f32 v80, v80
    v_exp_f32 v81, v81
    v_smfmac_f32_32x32x32_bf16 a[0:15], a[124:127], v[72:79], v54
    buffer_load_dwordx4 a[88:91], v254, s[8:11], s31 offen sc1
    buffer_load_dwordx4 a[102:105], v255, s[8:11], s31 offen offset:1280 sc1
    buffer_load_dwordx4 a[106:109], v255, s[8:11], s31 offen offset:1984 sc1
    v_exp_f32 v82, v82
    v_exp_f32 v83, v83
    v_exp_f32 v84, v84
    v_mfma_f32_32x32x16_bf16 v[96:111], a[110:113], a[72:75], v[96:111]
    v_exp_f32 v85, v85
    v_exp_f32 v86, v86
    v_exp_f32 v87, v87
    v_mfma_f32_32x32x16_bf16 v[112:127], a[110:113], a[76:79], v[112:127]
    v_exp_f32 v88, v88
    v_exp_f32 v89, v89
    v_exp_f32 v90, v90
    v_smfmac_f32_32x32x32_bf16 a[16:31], a[120:123], v[80:87], v54
    v_exp_f32 v91, v91
    v_exp_f32 v92, v92
    v_exp_f32 v93, v93
    v_exp_f32 v94, v94
    v_exp_f32 v95, v95
    v_exp_f32 v96, v96
    v_exp_f32 v97, v97
    v_smfmac_f32_32x32x32_bf16 a[16:31], a[124:127], v[88:95], v54
    s_mov_b32 exec_hi, 0
    buffer_store_dwordx4 a[48:51], v1, s[8:11], s36 offen offset:2048 sc1
    s_mov_b64 exec, 255
    buffer_store_dwordx4 a[48:51], v1, s[8:11], s37 offen sc1
    s_mov_b64 exec, -1
    v_exp_f32 v98, v98
    v_exp_f32 v99, v99
    v_exp_f32 v100, v100
    v_mfma_f32_32x32x4bf16_1k v[64:95], a[118:119], a[80:81], v[128:159] cbsz:1 abid:1
    v_exp_f32 v101, v101
    v_exp_f32 v102, v102
    v_exp_f32 v103, v103
    v_exp_f32 v104, v104
    v_exp_f32 v105, v105
    v_exp_f32 v106, v106
    v_exp_f32 v107, v107
    v_exp_f32 v108, v108
    v_smfmac_f32_32x32x32_bf16 v[16:31], a[120:123], v[96:103], v54
    v_exp_f32 v109, v109
    v_exp_f32 v110, v110
    v_exp_f32 v111, v111
    v_exp_f32 v112, v112
    v_exp_f32 v113, v113
    v_smfmac_f32_32x32x32_bf16 v[16:31], a[124:127], v[104:111], v54
    v_exp_f32 v114, v114
    v_exp_f32 v115, v115
    v_exp_f32 v116, v116
    v_mfma_f32_32x32x16_bf16 v[64:79], a[114:117], a[64:67], v[64:79]
    v_exp_f32 v117, v117
    v_exp_f32 v118, v118
    v_exp_f32 v119, v119
    v_mfma_f32_32x32x16_bf16 v[80:95], a[114:117], a[68:71], v[80:95]
    v_exp_f32 v120, v120
    v_exp_f32 v121, v121
    v_exp_f32 v122, v122
    v_smfmac_f32_32x32x32_bf16 v[32:47], a[120:123], v[112:119], v54
    v_exp_f32 v123, v123
    v_exp_f32 v124, v124
    v_exp_f32 v125, v125
    v_exp_f32 v126, v126
    v_exp_f32 v127, v127
    v_exp_f32 v64, v64
    v_exp_f32 v65, v65
    v_smfmac_f32_32x32x32_bf16 v[32:47], a[124:127], v[120:127], v54
    v_exp_f32 v66, v66
    v_exp_f32 v67, v67
    v_exp_f32 v68, v68
    v_mfma_f32_32x32x4bf16_1k v[96:127], a[118:119], a[82:83], v[160:191] cbsz:1 abid:1
    v_exp_f32 v69, v69
    v_exp_f32 v70, v70
    v_exp_f32 v71, v71
    v_exp_f32 v72, v72
    v_exp_f32 v73, v73
    v_exp_f32 v74, v74
    v_exp_f32 v75, v75
    v_exp_f32 v76, v76
    v_smfmac_f32_32x32x32_bf16 a[0:15], a[128:131], v[64:71], v54
    v_exp_f32 v77, v77
    v_exp_f32 v78, v78
    v_exp_f32 v79, v79
    v_exp_f32 v80, v80
    v_exp_f32 v81, v81
    v_smfmac_f32_32x32x32_bf16 a[0:15], a[132:135], v[72:79], v54
    v_exp_f32 v82, v82
    v_exp_f32 v83, v83
    v_exp_f32 v84, v84
    v_mfma_f32_32x32x16_bf16 v[96:111], a[114:117], a[72:75], v[96:111]
    v_exp_f32 v85, v85
    v_exp_f32 v86, v86
    v_exp_f32 v87, v87
    v_mfma_f32_32x32x16_bf16 v[112:127], a[114:117], a[76:79], v[112:127]
    v_exp_f32 v88, v88
    v_exp_f32 v89, v89
    v_exp_f32 v90, v90
    v_smfmac_f32_32x32x32_bf16 a[16:31], a[128:131], v[80:87], v54
    buffer_store_dwordx4 a[48:51], v1, s[8:11], s38 offen offset:0 sc1
    v_exp_f32 v91, v91
    v_exp_f32 v92, v92
    v_exp_f32 v93, v93
    v_exp_f32 v94, v94
    v_exp_f32 v95, v95
    v_exp_f32 v96, v96
    v_exp_f32 v97, v97
    v_smfmac_f32_32x32x32_bf16 a[16:31], a[132:135], v[88:95], v54
    s_waitcnt vmcnt(12)
    v_exp_f32 v98, v98
    v_exp_f32 v99, v99
    v_exp_f32 v100, v100
    v_mfma_f32_32x32x4bf16_1k v[64:95], a[144:145], a[80:81], v[128:159] cbsz:1 abid:0
    v_exp_f32 v101, v101
    v_exp_f32 v102, v102
    v_exp_f32 v103, v103
    v_exp_f32 v104, v104
    v_exp_f32 v105, v105
    v_exp_f32 v106, v106
    v_exp_f32 v107, v107
    v_exp_f32 v108, v108
    v_smfmac_f32_32x32x32_bf16 v[16:31], a[128:131], v[96:103], v54
    v_exp_f32 v109, v109
    v_exp_f32 v110, v110
    v_exp_f32 v111, v111
    v_exp_f32 v112, v112
    v_exp_f32 v113, v113
    v_smfmac_f32_32x32x32_bf16 v[16:31], a[132:135], v[104:111], v54
    v_exp_f32 v114, v114
    v_exp_f32 v115, v115
    v_exp_f32 v116, v116
    v_mfma_f32_32x32x16_bf16 v[64:79], a[136:139], a[64:67], v[64:79]
    v_exp_f32 v117, v117
    v_exp_f32 v118, v118
    v_exp_f32 v119, v119
    v_mfma_f32_32x32x16_bf16 v[80:95], a[136:139], a[68:71], v[80:95]
    v_exp_f32 v120, v120
    v_exp_f32 v121, v121
    v_exp_f32 v122, v122
    v_smfmac_f32_32x32x32_bf16 v[32:47], a[128:131], v[112:119], v54
    v_exp_f32 v123, v123
    v_exp_f32 v124, v124
    v_exp_f32 v125, v125
    v_exp_f32 v126, v126
    v_exp_f32 v127, v127
    v_exp_f32 v64, v64
    v_exp_f32 v65, v65
    v_smfmac_f32_32x32x32_bf16 v[32:47], a[132:135], v[120:127], v54
    buffer_load_dwordx2 a[118:119], v8, s[8:11], s80 offen offset:1024 sc1
    buffer_load_dwordx4 a[110:113], v0, s[8:11], s80 offen sc1
    v_exp_f32 v66, v66
    v_exp_f32 v67, v67
    v_exp_f32 v68, v68
    v_mfma_f32_32x32x4bf16_1k v[96:127], a[144:145], a[82:83], v[160:191] cbsz:1 abid:0
    v_exp_f32 v69, v69
    v_exp_f32 v70, v70
    v_exp_f32 v71, v71
    v_exp_f32 v72, v72
    v_exp_f32 v73, v73
    v_exp_f32 v74, v74
    v_exp_f32 v75, v75
    v_exp_f32 v76, v76
    v_smfmac_f32_32x32x32_bf16 a[0:15], a[146:149], v[64:71], v54
    buffer_load_dwordx4 a[120:123], v9, s[8:11], s80 offen offset:1280 sc1
    buffer_load_dwordx4 a[124:127], v9, s[8:11], s80 offen offset:1984 sc1
    v_exp_f32 v77, v77
    v_exp_f32 v78, v78
    v_exp_f32 v79, v79
    v_exp_f32 v80, v80
    v_exp_f32 v81, v81
    v_smfmac_f32_32x32x32_bf16 a[0:15], a[150:153], v[72:79], v54
    buffer_load_dwordx4 a[114:117], v254, s[8:11], s80 offen sc1
    buffer_load_dwordx4 a[128:131], v255, s[8:11], s80 offen offset:1280 sc1
    buffer_load_dwordx4 a[132:135], v255, s[8:11], s80 offen offset:1984 sc1
    buffer_store_dwordx4 a[48:51], v1, s[8:11], s38 offen offset:1024 sc1
    v_exp_f32 v82, v82
    v_exp_f32 v83, v83
    v_exp_f32 v84, v84
    v_mfma_f32_32x32x16_bf16 v[96:111], a[136:139], a[72:75], v[96:111]
    v_exp_f32 v85, v85
    v_exp_f32 v86, v86
    v_exp_f32 v87, v87
    v_mfma_f32_32x32x16_bf16 v[112:127], a[136:139], a[76:79], v[112:127]
    v_exp_f32 v88, v88
    v_exp_f32 v89, v89
    v_exp_f32 v90, v90
    v_smfmac_f32_32x32x32_bf16 a[16:31], a[146:149], v[80:87], v54
    v_exp_f32 v91, v91
    v_exp_f32 v92, v92
    v_exp_f32 v93, v93
    v_exp_f32 v94, v94
    v_exp_f32 v95, v95
    v_exp_f32 v96, v96
    v_exp_f32 v97, v97
    v_smfmac_f32_32x32x32_bf16 a[16:31], a[150:153], v[88:95], v54
    v_exp_f32 v98, v98
    v_exp_f32 v99, v99
    v_exp_f32 v100, v100
    v_mfma_f32_32x32x4bf16_1k v[64:95], a[144:145], a[80:81], v[128:159] cbsz:1 abid:1
    v_exp_f32 v101, v101
    v_exp_f32 v102, v102
    v_exp_f32 v103, v103
    v_exp_f32 v104, v104
    v_exp_f32 v105, v105
    v_exp_f32 v106, v106
    v_exp_f32 v107, v107
    v_exp_f32 v108, v108
    v_smfmac_f32_32x32x32_bf16 v[16:31], a[146:149], v[96:103], v54
    v_exp_f32 v109, v109
    v_exp_f32 v110, v110
    v_exp_f32 v111, v111
    v_exp_f32 v112, v112
    v_exp_f32 v113, v113
    v_smfmac_f32_32x32x32_bf16 v[16:31], a[150:153], v[104:111], v54
    v_exp_f32 v114, v114
    v_exp_f32 v115, v115
    v_exp_f32 v116, v116
    v_mfma_f32_32x32x16_bf16 v[64:79], a[140:143], a[64:67], v[64:79]
    v_exp_f32 v117, v117
    v_exp_f32 v118, v118
    v_exp_f32 v119, v119
    v_mfma_f32_32x32x16_bf16 v[80:95], a[140:143], a[68:71], v[80:95]
    v_exp_f32 v120, v120
    v_exp_f32 v121, v121
    v_exp_f32 v122, v122
    v_smfmac_f32_32x32x32_bf16 v[32:47], a[146:149], v[112:119], v54
    v_exp_f32 v123, v123
    v_exp_f32 v124, v124
    v_exp_f32 v125, v125
    v_exp_f32 v126, v126
    v_exp_f32 v127, v127
    v_exp_f32 v64, v64
    v_exp_f32 v65, v65
    v_smfmac_f32_32x32x32_bf16 v[32:47], a[150:153], v[120:127], v54
    v_exp_f32 v66, v66
    v_exp_f32 v67, v67
    v_exp_f32 v68, v68
    v_mfma_f32_32x32x4bf16_1k v[96:127], a[144:145], a[82:83], v[160:191] cbsz:1 abid:1
    v_exp_f32 v69, v69
    v_exp_f32 v70, v70
    v_exp_f32 v71, v71
    v_exp_f32 v72, v72
    v_exp_f32 v73, v73
    v_exp_f32 v74, v74
    v_exp_f32 v75, v75
    v_exp_f32 v76, v76
    v_smfmac_f32_32x32x32_bf16 a[0:15], a[154:157], v[64:71], v54
    buffer_store_dwordx4 a[48:51], v1, s[8:11], s38 offen offset:2048 sc1
    v_exp_f32 v77, v77
    v_exp_f32 v78, v78
    v_exp_f32 v79, v79
    v_exp_f32 v80, v80
    v_exp_f32 v81, v81
    v_smfmac_f32_32x32x32_bf16 a[0:15], a[158:161], v[72:79], v54
    v_exp_f32 v82, v82
    v_exp_f32 v83, v83
    v_exp_f32 v84, v84
    v_mfma_f32_32x32x16_bf16 v[96:111], a[140:143], a[72:75], v[96:111]
    v_exp_f32 v85, v85
    v_exp_f32 v86, v86
    v_exp_f32 v87, v87
    v_mfma_f32_32x32x16_bf16 v[112:127], a[140:143], a[76:79], v[112:127]
    v_exp_f32 v88, v88
    v_exp_f32 v89, v89
    v_exp_f32 v90, v90
    v_smfmac_f32_32x32x32_bf16 a[16:31], a[154:157], v[80:87], v54
    v_exp_f32 v91, v91
    v_exp_f32 v92, v92
    v_exp_f32 v93, v93
    v_exp_f32 v94, v94
    v_exp_f32 v95, v95
    v_exp_f32 v96, v96
    v_exp_f32 v97, v97
    v_smfmac_f32_32x32x32_bf16 a[16:31], a[158:161], v[88:95], v54
    s_waitcnt vmcnt(12)
    v_exp_f32 v98, v98
    v_exp_f32 v99, v99
    v_exp_f32 v100, v100
    v_mfma_f32_32x32x4bf16_1k v[64:95], a[92:93], a[80:81], v[128:159] cbsz:1 abid:0
    v_exp_f32 v101, v101
    v_exp_f32 v102, v102
    v_exp_f32 v103, v103
    v_exp_f32 v104, v104
    v_exp_f32 v105, v105
    v_exp_f32 v106, v106
    v_exp_f32 v107, v107
    v_exp_f32 v108, v108
    v_smfmac_f32_32x32x32_bf16 v[16:31], a[154:157], v[96:103], v54
    v_exp_f32 v109, v109
    v_exp_f32 v110, v110
    v_exp_f32 v111, v111
    v_exp_f32 v112, v112
    v_exp_f32 v113, v113
    v_smfmac_f32_32x32x32_bf16 v[16:31], a[158:161], v[104:111], v54
    v_exp_f32 v114, v114
    v_exp_f32 v115, v115
    v_exp_f32 v116, v116
    v_mfma_f32_32x32x16_bf16 v[64:79], a[84:87], a[64:67], v[64:79]
    v_exp_f32 v117, v117
    v_exp_f32 v118, v118
    v_exp_f32 v119, v119
    v_mfma_f32_32x32x16_bf16 v[80:95], a[84:87], a[68:71], v[80:95]
    v_exp_f32 v120, v120
    v_exp_f32 v121, v121
    v_exp_f32 v122, v122
    v_smfmac_f32_32x32x32_bf16 v[32:47], a[154:157], v[112:119], v54
    v_exp_f32 v123, v123
    v_exp_f32 v124, v124
L_pg1_0:
    s_cbranch_execz L_wr1
    v_exp_f32 v125, v125
    v_exp_f32 v126, v126
    v_exp_f32 v127, v127
    v_exp_f32 v64, v64
    v_exp_f32 v65, v65
    v_smfmac_f32_32x32x32_bf16 v[32:47], a[158:161], v[120:127], v54
    buffer_load_dwordx2 a[144:145], v8, s[8:11], s81 offen offset:1024 sc1
    buffer_load_dwordx4 a[136:139], v0, s[8:11], s81 offen sc1
    buffer_store_dwordx4 a[48:51], v1, s[8:11], s38 offen offset:3072 sc1
    buffer_load_dword v10, v213, s[8:11], 0 offen sc1
    buffer_load_dword v11, v214, s[8:11], 0 offen sc1
    v_exp_f32 v66, v66
    v_exp_f32 v67, v67
    v_exp_f32 v68, v68
    v_mfma_f32_32x32x4bf16_1k v[96:127], a[92:93], a[82:83], v[160:191] cbsz:1 abid:0
    v_exp_f32 v69, v69
    v_exp_f32 v70, v70
    v_exp_f32 v71, v71
    v_exp_f32 v72, v72
    v_exp_f32 v73, v73
    v_exp_f32 v74, v74
    v_exp_f32 v75, v75
    v_exp_f32 v76, v76
    v_smfmac_f32_32x32x32_bf16 a[0:15], a[94:97], v[64:71], v54
    buffer_load_dwordx4 a[146:149], v9, s[8:11], s81 offen offset:1280 sc1
    buffer_load_dwordx4 a[150:153], v9, s[8:11], s81 offen offset:1984 sc1
    v_exp_f32 v77, v77
    v_exp_f32 v78, v78
    v_exp_f32 v79, v79
    v_exp_f32 v80, v80
    v_exp_f32 v81, v81
    v_smfmac_f32_32x32x32_bf16 a[0:15], a[98:101], v[72:79], v54
    buffer_load_dwordx4 a[140:143], v254, s[8:11], s81 offen sc1
    buffer_load_dwordx4 a[154:157], v255, s[8:11], s81 offen offset:1280 sc1
    buffer_load_dwordx4 a[158:161], v255, s[8:11], s81 offen offset:1984 sc1
    v_exp_f32 v82, v82
    v_exp_f32 v83, v83
    v_exp_f32 v84, v84
    v_mfma_f32_32x32x16_bf16 v[96:111], a[84:87], a[72:75], v[96:111]
    v_exp_f32 v85, v85
    v_exp_f32 v86, v86
    v_exp_f32 v87, v87
    v_mfma_f32_32x32x16_bf16 v[112:127], a[84:87], a[76:79], v[112:127]
    v_exp_f32 v88, v88
    v_exp_f32 v89, v89
    v_exp_f32 v90, v90
    v_smfmac_f32_32x32x32_bf16 a[16:31], a[94:97], v[80:87], v54
    v_exp_f32 v91, v91
    v_exp_f32 v92, v92
    v_exp_f32 v93, v93
    v_exp_f32 v94, v94
    v_exp_f32 v95, v95
    v_exp_f32 v96, v96
    v_exp_f32 v97, v97
    v_smfmac_f32_32x32x32_bf16 a[16:31], a[98:101], v[88:95], v54
    v_exp_f32 v98, v98
    v_exp_f32 v99, v99
    v_exp_f32 v100, v100
    v_mfma_f32_32x32x4bf16_1k v[64:95], a[92:93], a[80:81], v[128:159] cbsz:1 abid:1
    v_exp_f32 v101, v101
    v_exp_f32 v102, v102
    v_exp_f32 v103, v103
    v_exp_f32 v104, v104
    v_exp_f32 v105, v105
    v_exp_f32 v106, v106
    v_exp_f32 v107, v107
    v_exp_f32 v108, v108
    v_smfmac_f32_32x32x32_bf16 v[16:31], a[94:97], v[96:103], v54
    v_exp_f32 v109, v109
    v_exp_f32 v110, v110
    v_exp_f32 v111, v111
    v_exp_f32 v112, v112
    v_exp_f32 v113, v113
    v_smfmac_f32_32x32x32_bf16 v[16:31], a[98:101], v[104:111], v54
    v_exp_f32 v114, v114
    v_exp_f32 v115, v115
    v_exp_f32 v116, v116
    v_mfma_f32_32x32x16_bf16 v[64:79], a[88:91], a[64:67], v[64:79]
    v_exp_f32 v117, v117
    v_exp_f32 v118, v118
    v_exp_f32 v119, v119
    v_mfma_f32_32x32x16_bf16 v[80:95], a[88:91], a[68:71], v[80:95]
    v_exp_f32 v120, v120
    v_exp_f32 v121, v121
    v_exp_f32 v122, v122
    v_smfmac_f32_32x32x32_bf16 v[32:47], a[94:97], v[112:119], v54
    s_add_u32 s38, s38, 4096
    buffer_store_dwordx4 a[48:51], v1, s[8:11], s38 offen offset:0 sc1
    v_exp_f32 v123, v123
    v_exp_f32 v124, v124
    v_exp_f32 v125, v125
    v_exp_f32 v126, v126
    v_exp_f32 v127, v127
    v_exp_f32 v64, v64
    v_exp_f32 v65, v65
    v_smfmac_f32_32x32x32_bf16 v[32:47], a[98:101], v[120:127], v54
    v_exp_f32 v66, v66
    v_exp_f32 v67, v67
    v_exp_f32 v68, v68
    v_mfma_f32_32x32x4bf16_1k v[96:127], a[92:93], a[82:83], v[160:191] cbsz:1 abid:1
    v_exp_f32 v69, v69
    v_exp_f32 v70, v70
    v_exp_f32 v71, v71
    v_exp_f32 v72, v72
    v_exp_f32 v73, v73
    v_exp_f32 v74, v74
    v_exp_f32 v75, v75
    v_exp_f32 v76, v76
    v_smfmac_f32_32x32x32_bf16 a[0:15], a[102:105], v[64:71], v54
    v_exp_f32 v77, v77
    v_exp_f32 v78, v78
    v_exp_f32 v79, v79
    v_exp_f32 v80, v80
    v_exp_f32 v81, v81
    v_smfmac_f32_32x32x32_bf16 a[0:15], a[106:109], v[72:79], v54
    v_exp_f32 v82, v82
    v_exp_f32 v83, v83
    v_exp_f32 v84, v84
    v_mfma_f32_32x32x16_bf16 v[96:111], a[88:91], a[72:75], v[96:111]
    v_exp_f32 v85, v85
    v_exp_f32 v86, v86
    v_exp_f32 v87, v87
    v_mfma_f32_32x32x16_bf16 v[112:127], a[88:91], a[76:79], v[112:127]
    v_exp_f32 v88, v88
    v_exp_f32 v89, v89
    v_exp_f32 v90, v90
    v_smfmac_f32_32x32x32_bf16 a[16:31], a[102:105], v[80:87], v54
    v_exp_f32 v91, v91
    v_exp_f32 v92, v92
    v_exp_f32 v93, v93
    v_exp_f32 v94, v94
    v_exp_f32 v95, v95
    v_exp_f32 v96, v96
    v_exp_f32 v97, v97
    v_smfmac_f32_32x32x32_bf16 a[16:31], a[106:109], v[88:95], v54
    s_waitcnt vmcnt(13)
    v_exp_f32 v98, v98
    v_exp_f32 v99, v99
    v_exp_f32 v100, v100
    v_mfma_f32_32x32x4bf16_1k v[64:95], a[118:119], a[80:81], v[128:159] cbsz:1 abid:0
    v_exp_f32 v101, v101
    v_exp_f32 v102, v102
    v_exp_f32 v103, v103
    v_exp_f32 v104, v104
    v_exp_f32 v105, v105
    v_exp_f32 v106, v106
    v_exp_f32 v107, v107
    v_exp_f32 v108, v108
    v_smfmac_f32_32x32x32_bf16 v[16:31], a[102:105], v[96:103], v54
    v_exp_f32 v109, v109
    v_exp_f32 v110, v110
    v_exp_f32 v111, v111
    v_exp_f32 v112, v112
    v_exp_f32 v113, v113
    v_smfmac_f32_32x32x32_bf16 v[16:31], a[106:109], v[104:111], v54
    buffer_store_dwordx4 a[48:51], v1, s[8:11], s38 offen offset:1024 sc1
    v_exp_f32 v114, v114
    v_exp_f32 v115, v115
    v_exp_f32 v116, v116
    v_mfma_f32_32x32x16_bf16 v[64:79], a[110:113], a[64:67], v[64:79]
    v_exp_f32 v117, v117
    v_exp_f32 v118, v118
    v_exp_f32 v119, v119
    v_mfma_f32_32x32x16_bf16 v[80:95], a[110:113], a[68:71], v[80:95]
    v_exp_f32 v120, v120
    v_exp_f32 v121, v121
    v_exp_f32 v122, v122
    v_smfmac_f32_32x32x32_bf16 v[32:47], a[102:105], v[112:119], v54
    v_exp_f32 v123, v123
    v_exp_f32 v124, v124
    v_exp_f32 v125, v125
    v_exp_f32 v126, v126
    v_exp_f32 v127, v127
    v_exp_f32 v64, v64
    v_exp_f32 v65, v65
    v_smfmac_f32_32x32x32_bf16 v[32:47], a[106:109], v[120:127], v54
    buffer_load_dwordx2 a[92:93], v8, s[8:11], s100 offen offset:1024 sc1
    buffer_load_dwordx4 a[84:87], v0, s[8:11], s100 offen sc1
    s_waitcnt vmcnt(9)
    v_cmp_ne_u32 vcc, s6, v10
    v_cmp_ne_u32 s[60:61], s6, v11
    s_or_b64 vcc, vcc, s[60:61]
    s_cbranch_vccnz cold_36
coldr_37:
    v_exp_f32 v66, v66
    v_exp_f32 v67, v67
    v_exp_f32 v68, v68
    v_mfma_f32_32x32x4bf16_1k v[96:127], a[118:119], a[82:83], v[160:191] cbsz:1 abid:0
    v_exp_f32 v69, v69
    v_exp_f32 v70, v70
    v_exp_f32 v71, v71
    v_exp_f32 v72, v72
    v_exp_f32 v73, v73
    v_exp_f32 v74, v74
    v_exp_f32 v75, v75
    v_exp_f32 v76, v76
    v_smfmac_f32_32x32x32_bf16 a[0:15], a[120:123], v[64:71], v54
    buffer_load_dwordx4 a[94:97], v9, s[8:11], s100 offen offset:1280 sc1
    buffer_load_dwordx4 a[98:101], v9, s[8:11], s100 offen offset:1984 sc1
    v_exp_f32 v77, v77
    v_exp_f32 v78, v78
    v_exp_f32 v79, v79
    v_exp_f32 v80, v80
    v_exp_f32 v81, v81
    v_smfmac_f32_32x32x32_bf16 a[0:15], a[124:127], v[72:79], v54
    buffer_load_dwordx4 a[88:91], v254, s[8:11], s100 offen sc1
    buffer_load_dwordx4 a[102:105], v255, s[8:11], s100 offen offset:1280 sc1
    buffer_load_dwordx4 a[106:109], v255, s[8:11], s100 offen offset:1984 sc1
    v_exp_f32 v82, v82
    v_exp_f32 v83, v83
    v_exp_f32 v84, v84
    v_mfma_f32_32x32x16_bf16 v[96:111], a[110:113], a[72:75], v[96:111]
    v_exp_f32 v85, v85
    v_exp_f32 v86, v86
    v_exp_f32 v87, v87
    v_mfma_f32_32x32x16_bf16 v[112:127], a[110:113], a[76:79], v[112:127]
    v_exp_f32 v88, v88
    v_exp_f32 v89, v89
    v_exp_f32 v90, v90
    v_smfmac_f32_32x32x32_bf16 a[16:31], a[120:123], v[80:87], v54
    s_add_u32 m0, s101, 0
    s_add_u32 s42, s42, 4096
    buffer_load_dwordx4 v1, s[8:11], s42 offen offset:0 sc1 lds
    buffer_load_dwordx4 v1, s[8:11], s42 offen offset:1024 sc1 lds
    v_exp_f32 v91, v91
    v_exp_f32 v92, v92
    v_exp_f32 v93, v93
    v_exp_f32 v94, v94
    v_exp_f32 v95, v95
    v_exp_f32 v96, v96
    v_exp_f32 v97, v97
    v_smfmac_f32_32x32x32_bf16 a[16:31], a[124:127], v[88:95], v54
    v_exp_f32 v98, v98
    v_exp_f32 v99, v99
    v_exp_f32 v100, v100
    v_mfma_f32_32x32x4bf16_1k v[64:95], a[118:119], a[80:81], v[128:159] cbsz:1 abid:1
    v_exp_f32 v101, v101
    v_exp_f32 v102, v102
    v_exp_f32 v103, v103
    v_exp_f32 v104, v104
    v_exp_f32 v105, v105
    v_exp_f32 v106, v106
    v_exp_f32 v107, v107
    v_exp_f32 v108, v108
    v_smfmac_f32_32x32x32_bf16 v[16:31], a[120:123], v[96:103], v54
    v_exp_f32 v109, v109
    v_exp_f32 v110, v110
    v_exp_f32 v111, v111
    v_exp_f32 v112, v112
    v_exp_f32 v113, v113
    v_smfmac_f32_32x32x32_bf16 v[16:31], a[124:127], v[104:111], v54
    buffer_load_dwordx4 v1, s[8:11], s42 offen offset:2048 sc1 lds
    buffer_load_dwordx4 v1, s[8:11], s42 offen offset:3072 sc1 lds
    v_exp_f32 v114, v114
    v_exp_f32 v115, v115
    v_exp_f32 v116, v116
    v_mfma_f32_32x32x16_bf16 v[64:79], a[114:117], a[64:67], v[64:79]
    v_exp_f32 v117, v117
    v_exp_f32 v118, v118
    v_exp_f32 v119, v119
    v_mfma_f32_32x32x16_bf16 v[80:95], a[114:117], a[68:71], v[80:95]
    v_exp_f32 v120, v120
    v_exp_f32 v121, v121
    v_exp_f32 v122, v122
    v_smfmac_f32_32x32x32_bf16 v[32:47], a[120:123], v[112:119], v54
    v_exp_f32 v123, v123
    v_exp_f32 v124, v124
    v_exp_f32 v125, v125
    v_exp_f32 v126, v126
    v_exp_f32 v127, v127
    v_exp_f32 v64, v64
    v_exp_f32 v65, v65
    v_smfmac_f32_32x32x32_bf16 v[32:47], a[124:127], v[120:127], v54
    v_exp_f32 v66, v66
    v_exp_f32 v67, v67
    v_exp_f32 v68, v68
    v_mfma_f32_32x32x4bf16_1k v[96:127], a[118:119], a[82:83], v[160:191] cbsz:1 abid:1
    v_exp_f32 v69, v69
    v_exp_f32 v70, v70
    v_exp_f32 v71, v71
    v_exp_f32 v72, v72
    v_exp_f32 v73, v73
    v_exp_f32 v74, v74
    v_exp_f32 v75, v75
    v_exp_f32 v76, v76
    v_smfmac_f32_32x32x32_bf16 a[0:15], a[128:131], v[64:71], v54
    s_add_u32 m0, s101, 4096
    s_add_u32 s42, s42, 4096
    buffer_load_dwordx4 v1, s[8:11], s42 offen offset:0 sc1 lds
    buffer_load_dwordx4 v1, s[8:11], s42 offen offset:1024 sc1 lds
    v_exp_f32 v77, v77
    v_exp_f32 v78, v78
    v_exp_f32 v79, v79
    v_exp_f32 v80, v80
    v_exp_f32 v81, v81
    v_smfmac_f32_32x32x32_bf16 a[0:15], a[132:135], v[72:79], v54
    v_exp_f32 v82, v82
    v_exp_f32 v83, v83
    v_exp_f32 v84, v84
    v_mfma_f32_32x32x16_bf16 v[96:111], a[114:117], a[72:75], v[96:111]
    v_exp_f32 v85, v85
    v_exp_f32 v86, v86
    v_exp_f32 v87, v87
    v_mfma_f32_32x32x16_bf16 v[112:127], a[114:117], a[76:79], v[112:127]
    v_exp_f32 v88, v88
    v_exp_f32 v89, v89
    v_exp_f32 v90, v90
    v_smfmac_f32_32x32x32_bf16 a[16:31], a[128:131], v[80:87], v54
    v_exp_f32 v91, v91
    v_exp_f32 v92, v92
    v_exp_f32 v93, v93
    v_exp_f32 v94, v94
    v_exp_f32 v95, v95
    v_exp_f32 v96, v96
    v_exp_f32 v97, v97
    v_smfmac_f32_32x32x32_bf16 a[16:31], a[132:135], v[88:95], v54
    buffer_load_dwordx4 v1, s[8:11], s42 offen offset:2048 sc1 lds
    buffer_load_dwordx4 v1, s[8:11], s42 offen offset:3072 sc1 lds
    s_waitcnt vmcnt(17)
    v_exp_f32 v98, v98
    v_exp_f32 v99, v99
    v_exp_f32 v100, v100
    v_mfma_f32_32x32x4bf16_1k v[64:95], a[144:145], a[80:81], v[128:159] cbsz:1 abid:0
    v_exp_f32 v101, v101
    v_exp_f32 v102, v102
    v_exp_f32 v103, v103
    v_exp_f32 v104, v104
    v_exp_f32 v105, v105
    v_exp_f32 v106, v106
    v_exp_f32 v107, v107
    v_exp_f32 v108, v108
    v_smfmac_f32_32x32x32_bf16 v[16:31], a[128:131], v[96:103], v54
    v_exp_f32 v109, v109
    v_exp_f32 v110, v110
    v_exp_f32 v111, v111
    v_exp_f32 v112, v112
    v_exp_f32 v113, v113
    v_smfmac_f32_32x32x32_bf16 v[16:31], a[132:135], v[104:111], v54
    v_exp_f32 v114, v114
    v_exp_f32 v115, v115
    v_exp_f32 v116, v116
    v_mfma_f32_32x32x16_bf16 v[64:79], a[136:139], a[64:67], v[64:79]
    v_exp_f32 v117, v117
    v_exp_f32 v118, v118
    v_exp_f32 v119, v119
    v_mfma_f32_32x32x16_bf16 v[80:95], a[136:139], a[68:71], v[80:95]
    v_exp_f32 v120, v120
    v_exp_f32 v121, v121
    v_exp_f32 v122, v122
    v_smfmac_f32_32x32x32_bf16 v[32:47], a[128:131], v[112:119], v54
    s_add_u32 m0, s101, 8192
    s_add_u32 s42, s42, 4096
    buffer_load_dwordx4 v1, s[8:11], s42 offen offset:0 sc1 lds
    buffer_load_dwordx4 v1, s[8:11], s42 offen offset:1024 sc1 lds
    v_exp_f32 v123, v123
    v_exp_f32 v124, v124
    v_exp_f32 v125, v125
    v_exp_f32 v126, v126
    v_exp_f32 v127, v127
    v_exp_f32 v64, v64
    v_exp_f32 v65, v65
    v_smfmac_f32_32x32x32_bf16 v[32:47], a[132:135], v[120:127], v54
    v_exp_f32 v66, v66
    v_exp_f32 v67, v67
    v_exp_f32 v68, v68
    v_mfma_f32_32x32x4bf16_1k v[96:127], a[144:145], a[82:83], v[160:191] cbsz:1 abid:0
    v_exp_f32 v69, v69
    v_exp_f32 v70, v70
    v_exp_f32 v71, v71
    v_exp_f32 v72, v72
    v_exp_f32 v73, v73
    v_exp_f32 v74, v74
    v_exp_f32 v75, v75
    v_exp_f32 v76, v76
    v_smfmac_f32_32x32x32_bf16 a[0:15], a[146:149], v[64:71], v54
    v_exp_f32 v77, v77
    v_exp_f32 v78, v78
    v_exp_f32 v79, v79
    v_exp_f32 v80, v80
    v_exp_f32 v81, v81
    v_smfmac_f32_32x32x32_bf16 a[0:15], a[150:153], v[72:79], v54
    buffer_load_dwordx4 v1, s[8:11], s42 offen offset:2048 sc1 lds
    buffer_load_dwordx4 v1, s[8:11], s42 offen offset:3072 sc1 lds
    v_exp_f32 v82, v82
    v_exp_f32 v83, v83
    v_exp_f32 v84, v84
    v_mfma_f32_32x32x16_bf16 v[96:111], a[136:139], a[72:75], v[96:111]
    v_exp_f32 v85, v85
    v_exp_f32 v86, v86
    v_exp_f32 v87, v87
    v_mfma_f32_32x32x16_bf16 v[112:127], a[136:139], a[76:79], v[112:127]
    v_exp_f32 v88, v88
    v_exp_f32 v89, v89
    v_exp_f32 v90, v90
    v_smfmac_f32_32x32x32_bf16 a[16:31], a[146:149], v[80:87], v54
    v_exp_f32 v91, v91
    v_exp_f32 v92, v92
    v_exp_f32 v93, v93
    v_exp_f32 v94, v94
    v_exp_f32 v95, v95
    v_exp_f32 v96, v96
    v_exp_f32 v97, v97
    v_smfmac_f32_32x32x32_bf16 a[16:31], a[150:153], v[88:95], v54
    v_exp_f32 v98, v98
    v_exp_f32 v99, v99
    v_exp_f32 v100, v100
    v_mfma_f32_32x32x4bf16_1k v[64:95], a[144:145], a[80:81], v[128:159] cbsz:1 abid:1
    v_exp_f32 v101, v101
    v_exp_f32 v102, v102
    v_exp_f32 v103, v103
    v_exp_f32 v104, v104
    v_exp_f32 v105, v105
    v_exp_f32 v106, v106
    v_exp_f32 v107, v107
    v_exp_f32 v108, v108
    v_smfmac_f32_32x32x32_bf16 v[16:31], a[146:149], v[96:103], v54
    s_add_u32 m0, s101, 12288
    s_add_u32 s42, s42, 4096
    buffer_load_dwordx4 v1, s[8:11], s42 offen offset:0 sc1 lds
    buffer_load_dwordx4 v1, s[8:11], s42 offen offset:1024 sc1 lds
    v_exp_f32 v109, v109
    v_exp_f32 v110, v110
    v_exp_f32 v111, v111
    v_exp_f32 v112, v112
    v_exp_f32 v113, v113
    v_smfmac_f32_32x32x32_bf16 v[16:31], a[150:153], v[104:111], v54
    v_exp_f32 v114, v114
    v_exp_f32 v115, v115
    v_exp_f32 v116, v116
    v_mfma_f32_32x32x16_bf16 v[64:79], a[140:143], a[64:67], v[64:79]
    v_exp_f32 v117, v117
    v_exp_f32 v118, v118
    v_exp_f32 v119, v119
    v_mfma_f32_32x32x16_bf16 v[80:95], a[140:143], a[68:71], v[80:95]
    v_exp_f32 v120, v120
    v_exp_f32 v121, v121
    v_exp_f32 v122, v122
    v_smfmac_f32_32x32x32_bf16 v[32:47], a[146:149], v[112:119], v54
    v_exp_f32 v123, v123
    v_exp_f32 v124, v124
    v_exp_f32 v125, v125
    v_exp_f32 v126, v126
    v_exp_f32 v127, v127
    v_exp_f32 v64, v64
    v_exp_f32 v65, v65
    v_smfmac_f32_32x32x32_bf16 v[32:47], a[150:153], v[120:127], v54
    buffer_load_dwordx4 v1, s[8:11], s42 offen offset:2048 sc1 lds
    buffer_load_dwordx4 v1, s[8:11], s42 offen offset:3072 sc1 lds
    v_exp_f32 v66, v66
    v_exp_f32 v67, v67
    v_exp_f32 v68, v68
    v_mfma_f32_32x32x4bf16_1k v[96:127], a[144:145], a[82:83], v[160:191] cbsz:1 abid:1
    v_exp_f32 v69, v69
    v_exp_f32 v70, v70
    v_exp_f32 v71, v71
    v_exp_f32 v72, v72
    v_exp_f32 v73, v73
    v_exp_f32 v74, v74
    v_exp_f32 v75, v75
    v_exp_f32 v76, v76
    v_smfmac_f32_32x32x32_bf16 a[0:15], a[154:157], v[64:71], v54
    buffer_load_dwordx2 v[204:205], v247, s[8:11], s84 offen offset:0 sc1
    buffer_load_dwordx2 v[206:207], v247, s[8:11], s84 offen offset:512 sc1
    buffer_load_dwordx2 v[208:209], v223, s[8:11], s84 offen offset:1024 sc1
    v_exp_f32 v77, v77
    v_exp_f32 v78, v78
    v_exp_f32 v79, v79
    v_exp_f32 v80, v80
    v_exp_f32 v81, v81
    v_smfmac_f32_32x32x32_bf16 a[0:15], a[158:161], v[72:79], v54
    v_exp_f32 v82, v82
    v_exp_f32 v83, v83
    v_exp_f32 v84, v84
    v_mfma_f32_32x32x16_bf16 v[96:111], a[140:143], a[72:75], v[96:111]
    v_exp_f32 v85, v85
    v_exp_f32 v86, v86
    v_exp_f32 v87, v87
    v_mfma_f32_32x32x16_bf16 v[112:127], a[140:143], a[76:79], v[112:127]
    v_exp_f32 v88, v88
    v_exp_f32 v89, v89
    v_exp_f32 v90, v90
    v_smfmac_f32_32x32x32_bf16 a[16:31], a[154:157], v[80:87], v54
    s_add_u32 m0, s101, 16384
    s_add_u32 s42, s42, 4096
    buffer_load_dwordx4 v1, s[8:11], s42 offen offset:0 sc1 lds
    buffer_load_dwordx4 v1, s[8:11], s42 offen offset:1024 sc1 lds
    v_exp_f32 v91, v91
    v_exp_f32 v92, v92
    v_exp_f32 v93, v93
    v_exp_f32 v94, v94
    v_exp_f32 v95, v95
    v_exp_f32 v96, v96
    v_exp_f32 v97, v97
    v_smfmac_f32_32x32x32_bf16 a[16:31], a[158:161], v[88:95], v54
    s_waitcnt vmcnt(21)
    v_exp_f32 v98, v98
    v_exp_f32 v99, v99
    v_exp_f32 v100, v100
    v_mfma_f32_32x32x4bf16_1k v[64:95], a[92:93], a[80:81], v[128:159] cbsz:1 abid:0
    v_exp_f32 v101, v101
    v_exp_f32 v102, v102
    v_exp_f32 v103, v103
    v_exp_f32 v104, v104
    v_exp_f32 v105, v105
    v_exp_f32 v106, v106
    v_exp_f32 v107, v107
    v_exp_f32 v108, v108
    v_smfmac_f32_32x32x32_bf16 v[16:31], a[154:157], v[96:103], v54
    v_exp_f32 v109, v109
    v_exp_f32 v110, v110
    v_exp_f32 v111, v111
    v_exp_f32 v112, v112
    v_exp_f32 v113, v113
    v_smfmac_f32_32x32x32_bf16 v[16:31], a[158:161], v[104:111], v54
    buffer_load_dwordx4 v1, s[8:11], s42 offen offset:2048 sc1 lds
    buffer_load_dwordx4 v1, s[8:11], s42 offen offset:3072 sc1 lds
    v_exp_f32 v114, v114
    v_exp_f32 v115, v115
    v_exp_f32 v116, v116
    v_mfma_f32_32x32x16_bf16 v[64:79], a[84:87], a[64:67], v[64:79]
    v_exp_f32 v117, v117
    v_exp_f32 v118, v118
    v_exp_f32 v119, v119
    v_mfma_f32_32x32x16_bf16 v[80:95], a[84:87], a[68:71], v[80:95]
    v_exp_f32 v120, v120
    v_exp_f32 v121, v121
    v_exp_f32 v122, v122
    v_smfmac_f32_32x32x32_bf16 v[32:47], a[154:157], v[112:119], v54
    v_exp_f32 v123, v123
    v_exp_f32 v124, v124
    v_exp_f32 v125, v125
    v_exp_f32 v126, v126
    v_exp_f32 v127, v127
    v_exp_f32 v64, v64
    v_exp_f32 v65, v65
    v_smfmac_f32_32x32x32_bf16 v[32:47], a[158:161], v[120:127], v54
    v_exp_f32 v66, v66
    v_exp_f32 v67, v67
    v_exp_f32 v68, v68
    v_mfma_f32_32x32x4bf16_1k v[96:127], a[92:93], a[82:83], v[160:191] cbsz:1 abid:0
    v_exp_f32 v69, v69
    v_exp_f32 v70, v70
    v_exp_f32 v71, v71
    v_exp_f32 v72, v72
    v_exp_f32 v73, v73
    v_exp_f32 v74, v74
    v_exp_f32 v75, v75
    v_exp_f32 v76, v76
    v_smfmac_f32_32x32x32_bf16 a[0:15], a[94:97], v[64:71], v54
    buffer_load_dwordx2 v[210:211], v247, s[8:11], s85 offen offset:0 sc1
    buffer_load_dwordx2 v[212:213], v247, s[8:11], s85 offen offset:512 sc1
    buffer_load_dwordx2 v[214:215], v223, s[8:11], s85 offen offset:1024 sc1
    s_add_u32 m0, s101, 20480
    s_add_u32 s42, s42, 4096
    buffer_load_dwordx4 v1, s[8:11], s42 offen offset:0 sc1 lds
    buffer_load_dwordx4 v1, s[8:11], s42 offen offset:1024 sc1 lds
    v_exp_f32 v77, v77
    v_exp_f32 v78, v78
    v_exp_f32 v79, v79
    v_exp_f32 v80, v80
    v_exp_f32 v81, v81
    v_smfmac_f32_32x32x32_bf16 a[0:15], a[98:101], v[72:79], v54
    v_exp_f32 v82, v82
    v_exp_f32 v83, v83
    v_exp_f32 v84, v84
    v_mfma_f32_32x32x16_bf16 v[96:111], a[84:87], a[72:75], v[96:111]
    v_exp_f32 v85, v85
    v_exp_f32 v86, v86
    v_exp_f32 v87, v87
    v_mfma_f32_32x32x16_bf16 v[112:127], a[84:87], a[76:79], v[112:127]
    v_exp_f32 v88, v88
    v_exp_f32 v89, v89
    v_exp_f32 v90, v90
    v_smfmac_f32_32x32x32_bf16 a[16:31], a[94:97], v[80:87], v54
    v_exp_f32 v91, v91
    v_exp_f32 v92, v92
    v_exp_f32 v93, v93
    v_exp_f32 v94, v94
    v_exp_f32 v95, v95
    v_exp_f32 v96, v96
    v_exp_f32 v97, v97
    v_smfmac_f32_32x32x32_bf16 a[16:31], a[98:101], v[88:95], v54
    buffer_load_dwordx4 v1, s[8:11], s42 offen offset:2048 sc1 lds
    buffer_load_dwordx4 v1, s[8:11], s42 offen offset:3072 sc1 lds
    v_exp_f32 v98, v98
    v_exp_f32 v99, v99
    v_exp_f32 v100, v100
    v_mfma_f32_32x32x4bf16_1k v[64:95], a[92:93], a[80:81], v[128:159] cbsz:1 abid:1
    v_exp_f32 v101, v101
    v_exp_f32 v102, v102
    v_exp_f32 v103, v103
    v_exp_f32 v104, v104
    v_exp_f32 v105, v105
    v_exp_f32 v106, v106
    v_exp_f32 v107, v107
    v_exp_f32 v108, v108
    v_smfmac_f32_32x32x32_bf16 v[16:31], a[94:97], v[96:103], v54
    v_exp_f32 v109, v109
    v_exp_f32 v110, v110
    v_exp_f32 v111, v111
    v_exp_f32 v112, v112
    v_exp_f32 v113, v113
    v_smfmac_f32_32x32x32_bf16 v[16:31], a[98:101], v[104:111], v54
    v_exp_f32 v114, v114
    v_exp_f32 v115, v115
    v_exp_f32 v116, v116
    v_mfma_f32_32x32x16_bf16 v[64:79], a[88:91], a[64:67], v[64:79]
    v_exp_f32 v117, v117
    v_exp_f32 v118, v118
    v_exp_f32 v119, v119
    v_mfma_f32_32x32x16_bf16 v[80:95], a[88:91], a[68:71], v[80:95]
    v_exp_f32 v120, v120
    v_exp_f32 v121, v121
    v_exp_f32 v122, v122
    v_smfmac_f32_32x32x32_bf16 v[32:47], a[94:97], v[112:119], v54
    s_add_u32 m0, s101, 24576
    s_add_u32 s42, s42, 4096
    buffer_load_dwordx4 v1, s[8:11], s42 offen offset:0 sc1 lds
    v_exp_f32 v123, v123
    v_exp_f32 v124, v124
    v_exp_f32 v125, v125
    v_exp_f32 v126, v126
    v_exp_f32 v127, v127
    v_exp_f32 v64, v64
    v_exp_f32 v65, v65
    v_smfmac_f32_32x32x32_bf16 v[32:47], a[98:101], v[120:127], v54
    s_waitcnt vmcnt(38)
    v_exp_f32 v66, v66
    v_exp_f32 v67, v67
    v_exp_f32 v68, v68
    v_mfma_f32_32x32x4bf16_1k v[96:127], a[92:93], a[82:83], v[160:191] cbsz:1 abid:1
    v_exp_f32 v69, v69
    v_exp_f32 v70, v70
    v_exp_f32 v71, v71
    v_exp_f32 v72, v72
    v_exp_f32 v73, v73
    v_exp_f32 v74, v74
    v_exp_f32 v75, v75
    v_exp_f32 v76, v76
    v_smfmac_f32_32x32x32_bf16 a[0:15], a[102:105], v[64:71], v54
    v_exp_f32 v77, v77
    v_exp_f32 v78, v78
    v_exp_f32 v79, v79
    v_exp_f32 v80, v80
    v_exp_f32 v81, v81
    v_smfmac_f32_32x32x32_bf16 a[0:15], a[106:109], v[72:79], v54
    v_exp_f32 v82, v82
    v_exp_f32 v83, v83
    v_exp_f32 v84, v84
    v_mfma_f32_32x32x16_bf16 v[96:111], a[88:91], a[72:75], v[96:111]
    v_exp_f32 v85, v85
    v_exp_f32 v86, v86
    v_exp_f32 v87, v87
    v_mfma_f32_32x32x16_bf16 v[112:127], a[88:91], a[76:79], v[112:127]
    v_exp_f32 v88, v88
    v_exp_f32 v89, v89
    v_exp_f32 v90, v90
    v_smfmac_f32_32x32x32_bf16 a[16:31], a[102:105], v[80:87], v54
    ds_write_b128 v202, a[0:3] offset:0
    ds_write_b128 v202, a[4:7] offset:1024
    v_exp_f32 v91, v91
    v_exp_f32 v92, v92
    v_exp_f32 v93, v93
    v_exp_f32 v94, v94
    v_exp_f32 v95, v95
    v_exp_f32 v96, v96
    v_exp_f32 v97, v97
    v_smfmac_f32_32x32x32_bf16 a[16:31], a[106:109], v[88:95], v54
    ds_write_b128 v202, a[8:11] offset:2048
    ds_write_b32 v202, a12 offset:3072
    v_exp_f32 v98, v98
    v_exp_f32 v99, v99
    v_exp_f32 v100, v100
    v_exp_f32 v101, v101
    v_exp_f32 v102, v102
    v_exp_f32 v103, v103
    v_exp_f32 v104, v104
    v_exp_f32 v105, v105
    v_exp_f32 v106, v106
    v_exp_f32 v107, v107
    v_exp_f32 v108, v108
    v_smfmac_f32_32x32x32_bf16 v[16:31], a[102:105], v[96:103], v54
    ds_write_b128 v202, a[16:19] offset:4096
    ds_write_b128 v202, a[20:23] offset:5120
    v_exp_f32 v109, v109
    v_exp_f32 v110, v110
    v_exp_f32 v111, v111
    v_exp_f32 v112, v112
    v_exp_f32 v113, v113
    v_smfmac_f32_32x32x32_bf16 v[16:31], a[106:109], v[104:111], v54
    ds_write_b128 v202, a[24:27] offset:6144
    ds_write_b32 v202, a28 offset:7168
    v_exp_f32 v114, v114
    v_exp_f32 v115, v115
    v_exp_f32 v116, v116
    v_exp_f32 v117, v117
    v_exp_f32 v118, v118
    v_exp_f32 v119, v119
    v_exp_f32 v120, v120
    v_exp_f32 v121, v121
    v_exp_f32 v122, v122
    v_smfmac_f32_32x32x32_bf16 v[32:47], a[102:105], v[112:119], v54
    v_exp_f32 v123, v123
    v_exp_f32 v124, v124
    v_exp_f32 v125, v125
    s_waitcnt lgkmcnt(0)
    s_barrier
    ds_read_b128 v[64:67], v203 offset:0
    ds_read_b128 v[68:71], v203 offset:1024
    ds_read_b128 v[72:75], v203 offset:2048
    ds_read_b32 v76, v203 offset:3072
    ds_read_b128 v[80:83], v203 offset:4096
    ds_read_b128 v[84:87], v203 offset:5120
    ds_read_b128 v[88:91], v203 offset:6144
    ds_read_b32 v92, v203 offset:7168
    v_exp_f32 v126, v126
    v_exp_f32 v127, v127
    s_nop 1
    v_smfmac_f32_32x32x32_bf16 v[32:47], a[106:109], v[120:127], v54
attmerge_26:
    s_waitcnt lgkmcnt(4)
    v_add_f32 v28, v28, v76
    v_rcp_f32 v30, v28
    v_cmp_ge_f32 vcc, s76, v28
    v_pk_add_f32 v[16:17], v[16:17], v[64:65]
    v_pk_add_f32 v[18:19], v[18:19], v[66:67]
    v_pk_add_f32 v[20:21], v[20:21], v[68:69]
    v_pk_add_f32 v[22:23], v[22:23], v[70:71]
    v_pk_add_f32 v[24:25], v[24:25], v[72:73]
    v_pk_add_f32 v[26:27], v[26:27], v[74:75]
    s_or_b64 vcc, vcc, s[68:69]
    v_pk_mul_f32 v[16:17], v[16:17], v[30:31] op_sel_hi:[1,0]
    v_pk_mul_f32 v[18:19], v[18:19], v[30:31] op_sel_hi:[1,0]
    v_pk_mul_f32 v[20:21], v[20:21], v[30:31] op_sel_hi:[1,0]
    v_pk_mul_f32 v[22:23], v[22:23], v[30:31] op_sel_hi:[1,0]
    v_pk_mul_f32 v[24:25], v[24:25], v[30:31] op_sel_hi:[1,0]
    v_pk_mul_f32 v[26:27], v[26:27], v[30:31] op_sel_hi:[1,0]
    s_and_b64 vcc, vcc, s[72:73]
    s_andn2_b64 s[72:73], s[72:73], vcc
    v_cndmask_b32 v64, v231, v229, vcc
    v_cndmask_b32 v65, v231, v228, vcc
    v_cvt_pk_bf16_f32 v96, v16, v17
    v_cvt_pk_bf16_f32 v97, v18, v19
    v_cvt_pk_bf16_f32 v98, v20, v21
    v_cvt_pk_bf16_f32 v99, v22, v23
    v_cvt_pk_bf16_f32 v100, v24, v25
    v_cvt_pk_bf16_f32 v101, v26, v27
    buffer_store_dwordx4 v[96:99], v64, s[8:11], s88 offen sc1
    buffer_store_dwordx2 v[100:101], v65, s[8:11], s89 offen offset:512 sc1
    s_waitcnt lgkmcnt(0)
    v_add_f32 v44, v44, v92
    v_rcp_f32 v46, v44
    v_cmp_ge_f32 vcc, s76, v44
    v_pk_add_f32 v[32:33], v[32:33], v[80:81]
    v_pk_add_f32 v[34:35], v[34:35], v[82:83]
    v_pk_add_f32 v[36:37], v[36:37], v[84:85]
    v_pk_add_f32 v[38:39], v[38:39], v[86:87]
    v_pk_add_f32 v[40:41], v[40:41], v[88:89]
    v_pk_add_f32 v[42:43], v[42:43], v[90:91]
    s_or_b64 vcc, vcc, s[68:69]
    v_pk_mul_f32 v[32:33], v[32:33], v[46:47] op_sel_hi:[1,0]
    v_pk_mul_f32 v[34:35], v[34:35], v[46:47] op_sel_hi:[1,0]
    v_pk_mul_f32 v[36:37], v[36:37], v[46:47] op_sel_hi:[1,0]
    v_pk_mul_f32 v[38:39], v[38:39], v[46:47] op_sel_hi:[1,0]
    v_pk_mul_f32 v[40:41], v[40:41], v[46:47] op_sel_hi:[1,0]
    v_pk_mul_f32 v[42:43], v[42:43], v[46:47] op_sel_hi:[1,0]
    s_and_b64 vcc, vcc, s[74:75]
    s_andn2_b64 s[74:75], s[74:75], vcc
    v_cndmask_b32 v80, v231, v229, vcc
    v_cndmask_b32 v81, v231, v228, vcc
    v_cvt_pk_bf16_f32 v104, v32, v33
    v_cvt_pk_bf16_f32 v105, v34, v35
    v_cvt_pk_bf16_f32 v106, v36, v37
    v_cvt_pk_bf16_f32 v107, v38, v39
    v_cvt_pk_bf16_f32 v108, v40, v41
    v_cvt_pk_bf16_f32 v109, v42, v43
    buffer_store_dwordx4 v[104:107], v80, s[8:11], s90 offen sc1
    buffer_store_dwordx2 v[108:109], v81, s[8:11], s91 offen offset:512 sc1
    buffer_atomic_swap v4, v253, s[8:11], s92 offen offset:0 sc1
    s_mov_b32 exec_hi, 0
    v_mov_b32 v88, 0
    buffer_atomic_or v88, v252, s[8:11], s77 offen sc0 sc1
    s_mov_b64 exec, -1
    s_lshl_b32 s52, s3, 2
    s_add_u32 s52, s52, 159488
    v_mov_b32 v82, s52
    v_mov_b32 v83, 159488
    s_or_b64 vcc, s[72:73], s[74:75]
    s_cselect_b32 s54, 1, 0
    v_mov_b32 v84, s54
L_pg1_1:
    s_cbranch_execz L_wr1
    ds_write_b32 v82, v84
    s_waitcnt lgkmcnt(0)
    s_barrier
    ds_read_b128 v[84:87], v83
    s_waitcnt lgkmcnt(0)
    v_or3_b32 v84, v84, v85, v86
    v_or_b32 v84, v84, v87
    s_nop 0
    v_readfirstlane_b32 s54, v84
    s_nop 0
    s_cmp_lg_u32 s54, 0
    s_cbranch_scc1 attfb_27
    s_add_u32 m0, s39, 114688
    s_add_u32 s43, s43, 16384
    buffer_load_dwordx4 v1, s[8:11], s43 offen offset:0 sc1 lds
    buffer_load_dwordx4 v1, s[8:11], s43 offen offset:1024 sc1 lds
    buffer_load_dwordx4 v1, s[8:11], s43 offen offset:2048 sc1 lds
    buffer_load_dwordx4 v1, s[8:11], s43 offen offset:3072 sc1 lds
    s_add_u32 m0, s39, 131072
    s_add_u32 s43, s43, 16384
    buffer_load_dwordx4 v1, s[8:11], s43 offen offset:0 sc1 lds
    buffer_load_dwordx4 v1, s[8:11], s43 offen offset:1024 sc1 lds
    buffer_load_dwordx4 v1, s[8:11], s43 offen offset:2048 sc1 lds
    buffer_load_dwordx4 v1, s[8:11], s43 offen offset:3072 sc1 lds
    s_waitcnt vmcnt(14)
    ds_read_b128 v[108:111], v218 offset:0
    ds_read_b128 v[112:115], v218 offset:64
    ds_read_b64 v[116:117], v219 offset:128
    ds_read_b128 v[120:123], v218 offset:2560
    ds_read_b128 v[124:127], v218 offset:2624
    ds_read_b64 v[128:129], v219 offset:2688
    s_lshr_b32 s48, s40, 1
    s_mul_i32 s51, s40, 20480
    s_add_u32 s51, s51, 19394560
    v_lshlrev_b32 v8, 4, v220
    v_lshl_add_u32 v9, v221, 9, v8
    v_and_b32 v10, 1, v221
    v_lshl_add_u32 v8, v10, 3, v8
    v_lshrrev_b32 v10, 1, v221
    v_lshl_add_u32 v8, v10, 9, v8
    v_add_u32 v8, 0x1000, v8
    v_cmp_eq_u32 vcc, 0, v221
    v_lshlrev_b32 v10, 6, v220
    v_mov_b32 v11, 0x80000000
    s_mul_i32 s52, s48, 40960
    v_cndmask_b32 v10, v11, v10, vcc
    s_and_b32 s45, s40, 1
    s_lshl_b32 s53, s45, 8
    s_add_u32 s52, s52, s53
    s_mul_i32 s53, s41, 5120
    s_add_u32 s52, s52, s53
    s_add_u32 s52, s52, 22020096
    s_lshl_b32 s53, s40, 10
    s_lshl_b32 s54, s41, 3
    s_add_u32 s53, s53, s54
    s_add_u32 s53, s53, 393216
    s_waitcnt lgkmcnt(0)
    v_lshlrev_b32 v136, 16, v108
    v_and_b32 v137, 0xffff0000, v108
    v_lshlrev_b32 v160, 16, v120
    v_and_b32 v161, 0xffff0000, v120
    v_lshlrev_b32 v138, 16, v109
    v_and_b32 v139, 0xffff0000, v109
    v_lshlrev_b32 v162, 16, v121
    v_and_b32 v163, 0xffff0000, v121
    v_lshlrev_b32 v140, 16, v110
    v_and_b32 v141, 0xffff0000, v110
    v_lshlrev_b32 v164, 16, v122
    v_and_b32 v165, 0xffff0000, v122
    v_lshlrev_b32 v142, 16, v111
    v_and_b32 v143, 0xffff0000, v111
    v_lshlrev_b32 v166, 16, v123
    v_and_b32 v167, 0xffff0000, v123
    v_lshlrev_b32 v144, 16, v112
    v_and_b32 v145, 0xffff0000, v112
    v_lshlrev_b32 v168, 16, v124
    v_and_b32 v169, 0xffff0000, v124
    v_lshlrev_b32 v146, 16, v113
    v_and_b32 v147, 0xffff0000, v113
    v_lshlrev_b32 v170, 16, v125
    v_and_b32 v171, 0xffff0000, v125
    v_lshlrev_b32 v148, 16, v114
    v_and_b32 v149, 0xffff0000, v114
    v_lshlrev_b32 v172, 16, v126
    v_and_b32 v173, 0xffff0000, v126
    v_lshlrev_b32 v150, 16, v115
    v_and_b32 v151, 0xffff0000, v115
    v_lshlrev_b32 v174, 16, v127
    v_and_b32 v175, 0xffff0000, v127
    v_lshlrev_b32 v152, 16, v116
    v_and_b32 v153, 0xffff0000, v116
    v_lshlrev_b32 v176, 16, v128
    v_and_b32 v177, 0xffff0000, v128
    v_lshlrev_b32 v154, 16, v117
    v_and_b32 v155, 0xffff0000, v117
    v_lshlrev_b32 v178, 16, v129
    v_and_b32 v179, 0xffff0000, v129
    s_waitcnt vmcnt(8)
    s_mov_b32 exec_hi, 0
    v_cmp_ne_u32 vcc, s6, v88
    s_mov_b64 exec, -1
    s_cbranch_vccnz cold_40
coldr_41:
    s_add_u32 s51, s51, 4096
    buffer_load_dwordx4 a[0:3], v1, s[8:11], s51 offen offset:0 sc1
    buffer_load_dwordx4 a[4:7], v1, s[8:11], s51 offen offset:1024 sc1
    buffer_load_dwordx4 a[8:11], v1, s[8:11], s51 offen offset:2048 sc1
    s_waitcnt vmcnt(12)
    buffer_atomic_swap v4, v253, s[8:11], s92 offen offset:128 sc1
    s_lshl_b32 s50, s3, 10
    s_add_u32 s50, s50, 152576
    v_add_u32 v12, s50, v1
    s_and_b32 s50, s3, 1
    s_lshl_b32 s50, s50, 10
    s_add_u32 s50, s50, 156672
    v_add_u32 v13, s50, v1
    v_pk_add_f32 v[204:205], v[204:205], v[206:207]
    v_pk_add_f32 v[204:205], v[204:205], v[208:209]
    v_cvt_pk_bf16_f32 v96, v204, v204
    v_lshlrev_b32 v206, 16, v96
    v_sub_f32 v206, v204, v206
    v_cvt_pk_bf16_f32 v97, v206, v205
    v_and_b32 v207, 0xffff0000, v97
    v_sub_f32 v207, v205, v207
    v_cvt_pk_bf16_f32 v98, v205, v207
    v_mov_b32 v99, 0
    ds_write_b128 v12, v[96:99]
    v_pk_add_f32 v[210:211], v[210:211], v[212:213]
    v_pk_add_f32 v[210:211], v[210:211], v[214:215]
    v_cvt_pk_bf16_f32 v100, v210, v210
    v_lshlrev_b32 v212, 16, v100
    v_sub_f32 v212, v210, v212
    v_cvt_pk_bf16_f32 v101, v212, v211
    v_and_b32 v213, 0xffff0000, v101
    v_sub_f32 v213, v211, v213
    v_cvt_pk_bf16_f32 v102, v211, v213
    v_mov_b32 v103, 0
    ds_write_b128 v13, v[100:103]
    v_lshlrev_b32 v232, 16, v192
    v_and_b32 v233, 0xffff0000, v192
    v_lshlrev_b32 v234, 16, v193
    v_and_b32 v235, 0xffff0000, v193
    v_lshlrev_b32 v236, 16, v194
    v_and_b32 v237, 0xffff0000, v194
    v_lshlrev_b32 v238, 16, v195
    v_and_b32 v239, 0xffff0000, v195
    v_lshlrev_b32 v240, 16, v196
    v_and_b32 v241, 0xffff0000, v196
    v_lshlrev_b32 v242, 16, v197
    v_and_b32 v243, 0xffff0000, v197
    v_lshlrev_b32 v244, 16, v198
    v_and_b32 v245, 0xffff0000, v198
    v_lshlrev_b32 v246, 16, v199
    v_and_b32 v247, 0xffff0000, v199
    v_lshlrev_b32 v248, 16, v200
    v_and_b32 v249, 0xffff0000, v200
    v_lshlrev_b32 v250, 16, v201
    v_and_b32 v251, 0xffff0000, v201
    s_waitcnt lgkmcnt(0)
    buffer_load_dwordx4 a[12:15], v1, s[8:11], s51 offen offset:3072 sc1
    s_add_u32 s51, s51, 4096
    buffer_load_dwordx4 a[16:19], v1, s[8:11], s51 offen offset:0 sc1
    buffer_load_dwordx4 a[20:23], v1, s[8:11], s51 offen offset:1024 sc1
    s_barrier
    buffer_load_dwordx4 a[24:27], v1, s[8:11], s51 offen offset:2048 sc1
    buffer_load_dwordx4 a[28:31], v1, s[8:11], s51 offen offset:3072 sc1
    s_add_u32 s51, s51, 4096
    buffer_load_dwordx4 a[32:35], v1, s[8:11], s51 offen offset:0 sc1
    s_barrier
    buffer_load_dwordx4 a[36:39], v1, s[8:11], s51 offen offset:1024 sc1
    s_barrier
    ds_read_b128 v[24:27], v1 offset:0
    ds_read_b128 v[28:31], v1 offset:1024
    ds_read_b128 v[32:35], v1 offset:2048
    ds_read_b128 v[36:39], v1 offset:3072
    ds_read_b128 v[40:43], v1 offset:4096
    ds_read_b128 v[44:47], v1 offset:5120
    ds_read_b128 v[48:51], v1 offset:6144
    ds_read_b128 v[52:55], v1 offset:7168
    ds_read_b128 v[56:59], v1 offset:8192
    ds_read_b128 v[60:63], v1 offset:9216
    s_waitcnt vmcnt(10) lgkmcnt(8)
    v_mfma_f32_16x16x32_bf16 v[64:67], v[24:27], a[0:3], 0
    ds_read_b128 v[24:27], v1 offset:10240
    buffer_load_dwordx4 a[40:43], v1, s[8:11], s51 offen offset:2048 sc1
    v_mfma_f32_16x16x32_bf16 v[68:71], v[28:31], a[0:3], 0
    ds_read_b128 v[28:31], v1 offset:11264
    s_waitcnt lgkmcnt(7)
    v_mfma_f32_16x16x32_bf16 v[72:75], v[32:35], a[0:3], 0
    ds_read_b128 v[32:35], v1 offset:12288
    v_mfma_f32_16x16x32_bf16 v[76:79], v[36:39], a[0:3], 0
    ds_read_b128 v[36:39], v1 offset:13312
    buffer_load_dwordx4 a[44:47], v1, s[8:11], s51 offen offset:3072 sc1
    v_mfma_f32_16x16x32_bf16 v[80:83], v[40:43], a[0:3], 0
    ds_read_b128 v[40:43], v1 offset:14336
    s_waitcnt vmcnt(11) lgkmcnt(8)
    v_mfma_f32_16x16x32_bf16 v[64:67], v[44:47], a[4:7], v[64:67]
    ds_read_b128 v[44:47], v1 offset:15360
    v_mfma_f32_16x16x32_bf16 v[68:71], v[48:51], a[4:7], v[68:71]
    ds_read_b128 v[48:51], v1 offset:16384
    s_waitcnt lgkmcnt(7)
    v_mfma_f32_16x16x32_bf16 v[72:75], v[52:55], a[4:7], v[72:75]
    ds_read_b128 v[52:55], v1 offset:17408
    s_add_u32 s51, s51, 4096
    buffer_load_dwordx4 a[48:51], v1, s[8:11], s51 offen offset:0 sc1
    v_mfma_f32_16x16x32_bf16 v[76:79], v[56:59], a[4:7], v[76:79]
    ds_read_b128 v[56:59], v1 offset:18432
    v_mfma_f32_16x16x32_bf16 v[80:83], v[60:63], a[4:7], v[80:83]
    ds_read_b128 v[60:63], v1 offset:19456
    s_waitcnt vmcnt(11) lgkmcnt(8)
    v_mfma_f32_16x16x32_bf16 v[64:67], v[24:27], a[8:11], v[64:67]
    ds_read_b128 v[24:27], v1 offset:20480
    v_mfma_f32_16x16x32_bf16 v[68:71], v[28:31], a[8:11], v[68:71]
    ds_read_b128 v[28:31], v1 offset:21504
    buffer_load_dwordx4 a[52:55], v1, s[8:11], s51 offen offset:1024 sc1
    s_waitcnt lgkmcnt(7)
    v_mfma_f32_16x16x32_bf16 v[72:75], v[32:35], a[8:11], v[72:75]
    ds_read_b128 v[32:35], v1 offset:22528
    v_mfma_f32_16x16x32_bf16 v[76:79], v[36:39], a[8:11], v[76:79]
    ds_read_b128 v[36:39], v1 offset:23552
    v_mfma_f32_16x16x32_bf16 v[80:83], v[40:43], a[8:11], v[80:83]
    ds_read_b128 v[40:43], v1 offset:24576
    s_waitcnt vmcnt(10) lgkmcnt(8)
    v_mfma_f32_16x16x32_bf16 v[64:67], v[44:47], a[12:15], v[64:67]
    ds_read_b128 v[44:47], v1 offset:25600
    buffer_load_dwordx4 a[56:59], v1, s[8:11], s51 offen offset:2048 sc1
    v_mfma_f32_16x16x32_bf16 v[68:71], v[48:51], a[12:15], v[68:71]
    ds_read_b128 v[48:51], v1 offset:26624
    s_waitcnt lgkmcnt(7)
    v_mfma_f32_16x16x32_bf16 v[72:75], v[52:55], a[12:15], v[72:75]
    ds_read_b128 v[52:55], v1 offset:27648
    v_mfma_f32_16x16x32_bf16 v[76:79], v[56:59], a[12:15], v[76:79]
    ds_read_b128 v[56:59], v1 offset:28672
    v_mfma_f32_16x16x32_bf16 v[80:83], v[60:63], a[12:15], v[80:83]
    ds_read_b128 v[60:63], v1 offset:29696
    buffer_load_dwordx4 a[60:63], v1, s[8:11], s51 offen offset:3072 sc1
    s_waitcnt vmcnt(11) lgkmcnt(8)
    v_mfma_f32_16x16x32_bf16 v[64:67], v[24:27], a[16:19], v[64:67]
    ds_read_b128 v[24:27], v1 offset:30720
    v_mfma_f32_16x16x32_bf16 v[68:71], v[28:31], a[16:19], v[68:71]
    ds_read_b128 v[28:31], v1 offset:31744
    s_waitcnt lgkmcnt(7)
    v_mfma_f32_16x16x32_bf16 v[72:75], v[32:35], a[16:19], v[72:75]
    ds_read_b128 v[32:35], v1 offset:32768
    v_mfma_f32_16x16x32_bf16 v[76:79], v[36:39], a[16:19], v[76:79]
    ds_read_b128 v[36:39], v1 offset:33792
    s_add_u32 s51, s51, 4096
    buffer_load_dwordx4 a[64:67], v1, s[8:11], s51 offen offset:0 sc1
    v_mfma_f32_16x16x32_bf16 v[80:83], v[40:43], a[16:19], v[80:83]
    ds_read_b128 v[40:43], v1 offset:34816
    s_waitcnt vmcnt(11) lgkmcnt(8)
    v_mfma_f32_16x16x32_bf16 v[64:67], v[44:47], a[20:23], v[64:67]
    ds_read_b128 v[44:47], v1 offset:35840
    v_mfma_f32_16x16x32_bf16 v[68:71], v[48:51], a[20:23], v[68:71]
    ds_read_b128 v[48:51], v1 offset:36864
    s_waitcnt lgkmcnt(7)
    v_mfma_f32_16x16x32_bf16 v[72:75], v[52:55], a[20:23], v[72:75]
    ds_read_b128 v[52:55], v1 offset:37888
    buffer_load_dwordx4 a[68:71], v1, s[8:11], s51 offen offset:1024 sc1
    v_mfma_f32_16x16x32_bf16 v[76:79], v[56:59], a[20:23], v[76:79]
    ds_read_b128 v[56:59], v1 offset:38912
    v_mfma_f32_16x16x32_bf16 v[80:83], v[60:63], a[20:23], v[80:83]
    ds_read_b128 v[60:63], v1 offset:39936
    s_waitcnt vmcnt(11) lgkmcnt(8)
    v_mfma_f32_16x16x32_bf16 v[64:67], v[24:27], a[24:27], v[64:67]
    ds_read_b128 v[24:27], v1 offset:40960
    v_mfma_f32_16x16x32_bf16 v[68:71], v[28:31], a[24:27], v[68:71]
    ds_read_b128 v[28:31], v1 offset:41984
    buffer_load_dwordx4 a[72:75], v1, s[8:11], s51 offen offset:2048 sc1
    s_waitcnt lgkmcnt(7)
    v_mfma_f32_16x16x32_bf16 v[72:75], v[32:35], a[24:27], v[72:75]
    ds_read_b128 v[32:35], v1 offset:43008
    v_mfma_f32_16x16x32_bf16 v[76:79], v[36:39], a[24:27], v[76:79]
    ds_read_b128 v[36:39], v1 offset:44032
    v_mfma_f32_16x16x32_bf16 v[80:83], v[40:43], a[24:27], v[80:83]
    ds_read_b128 v[40:43], v1 offset:45056
    s_waitcnt vmcnt(11) lgkmcnt(8)
    v_mfma_f32_16x16x32_bf16 v[64:67], v[44:47], a[28:31], v[64:67]
    ds_read_b128 v[44:47], v1 offset:46080
    buffer_load_dwordx4 a[76:79], v1, s[8:11], s51 offen offset:3072 sc1
    v_mfma_f32_16x16x32_bf16 v[68:71], v[48:51], a[28:31], v[68:71]
    ds_read_b128 v[48:51], v1 offset:47104
    s_waitcnt lgkmcnt(7)
    v_mfma_f32_16x16x32_bf16 v[72:75], v[52:55], a[28:31], v[72:75]
    ds_read_b128 v[52:55], v1 offset:48128
    v_mfma_f32_16x16x32_bf16 v[76:79], v[56:59], a[28:31], v[76:79]
    ds_read_b128 v[56:59], v1 offset:49152
    v_mfma_f32_16x16x32_bf16 v[80:83], v[60:63], a[28:31], v[80:83]
    ds_read_b128 v[60:63], v1 offset:50176
    s_waitcnt vmcnt(11) lgkmcnt(8)
    v_mfma_f32_16x16x32_bf16 v[64:67], v[24:27], a[32:35], v[64:67]
    ds_read_b128 v[24:27], v1 offset:51200
    v_mfma_f32_16x16x32_bf16 v[68:71], v[28:31], a[32:35], v[68:71]
    ds_read_b128 v[28:31], v1 offset:52224
    s_waitcnt lgkmcnt(7)
    v_mfma_f32_16x16x32_bf16 v[72:75], v[32:35], a[32:35], v[72:75]
    ds_read_b128 v[32:35], v1 offset:53248
    v_mfma_f32_16x16x32_bf16 v[76:79], v[36:39], a[32:35], v[76:79]
    ds_read_b128 v[36:39], v1 offset:54272
    v_mfma_f32_16x16x32_bf16 v[80:83], v[40:43], a[32:35], v[80:83]
    ds_read_b128 v[40:43], v1 offset:55296
    s_waitcnt vmcnt(10) lgkmcnt(8)
    v_mfma_f32_16x16x32_bf16 v[64:67], v[44:47], a[36:39], v[64:67]
    ds_read_b128 v[44:47], v1 offset:56320
    v_mfma_f32_16x16x32_bf16 v[68:71], v[48:51], a[36:39], v[68:71]
    ds_read_b128 v[48:51], v1 offset:57344
    s_waitcnt lgkmcnt(7)
    v_mfma_f32_16x16x32_bf16 v[72:75], v[52:55], a[36:39], v[72:75]
    ds_read_b128 v[52:55], v1 offset:58368
    v_mfma_f32_16x16x32_bf16 v[76:79], v[56:59], a[36:39], v[76:79]
    ds_read_b128 v[56:59], v1 offset:59392
    v_mfma_f32_16x16x32_bf16 v[80:83], v[60:63], a[36:39], v[80:83]
    ds_read_b128 v[60:63], v1 offset:60416
    s_waitcnt vmcnt(9) lgkmcnt(8)
    v_mfma_f32_16x16x32_bf16 v[64:67], v[24:27], a[40:43], v[64:67]
    ds_read_b128 v[24:27], v1 offset:61440
    v_mfma_f32_16x16x32_bf16 v[68:71], v[28:31], a[40:43], v[68:71]
    ds_read_b128 v[28:31], v1 offset:62464
    s_waitcnt lgkmcnt(7)
    v_mfma_f32_16x16x32_bf16 v[72:75], v[32:35], a[40:43], v[72:75]
    ds_read_b128 v[32:35], v1 offset:63488
    v_mfma_f32_16x16x32_bf16 v[76:79], v[36:39], a[40:43], v[76:79]
    ds_read_b128 v[36:39], v1 offset:64512
    v_mfma_f32_16x16x32_bf16 v[80:83], v[40:43], a[40:43], v[80:83]
    s_barrier
    ds_read_b128 v[40:43], v2 offset:0
    s_add_u32 m0, s39, 0
    s_add_u32 s43, s43, 16384
    buffer_load_dwordx4 v1, s[8:11], s43 offen offset:0 sc1 lds
    s_waitcnt vmcnt(9) lgkmcnt(8)
    v_mfma_f32_16x16x32_bf16 v[64:67], v[44:47], a[44:47], v[64:67]
    ds_read_b128 v[44:47], v2 offset:1024
    v_mfma_f32_16x16x32_bf16 v[68:71], v[48:51], a[44:47], v[68:71]
    ds_read_b128 v[48:51], v2 offset:2048
    s_waitcnt lgkmcnt(7)
    v_mfma_f32_16x16x32_bf16 v[72:75], v[52:55], a[44:47], v[72:75]
    ds_read_b128 v[52:55], v2 offset:3072
    buffer_load_dwordx4 v1, s[8:11], s43 offen offset:1024 sc1 lds
    v_mfma_f32_16x16x32_bf16 v[76:79], v[56:59], a[44:47], v[76:79]
    ds_read_b128 v[56:59], v2 offset:4096
    v_mfma_f32_16x16x32_bf16 v[80:83], v[60:63], a[44:47], v[80:83]
    ds_read_b128 v[60:63], v2 offset:5120
    s_waitcnt vmcnt(9) lgkmcnt(8)
    v_mfma_f32_16x16x32_bf16 v[64:67], v[24:27], a[48:51], v[64:67]
    ds_read_b128 v[24:27], v2 offset:6144
    v_mfma_f32_16x16x32_bf16 v[68:71], v[28:31], a[48:51], v[68:71]
    ds_read_b128 v[28:31], v2 offset:7168
    buffer_load_dwordx4 v1, s[8:11], s43 offen offset:2048 sc1 lds
    s_waitcnt lgkmcnt(7)
    v_mfma_f32_16x16x32_bf16 v[72:75], v[32:35], a[48:51], v[72:75]
    ds_read_b128 v[32:35], v2 offset:8192
    v_mfma_f32_16x16x32_bf16 v[76:79], v[36:39], a[48:51], v[76:79]
    ds_read_b128 v[36:39], v2 offset:9216
    v_mfma_f32_16x16x32_bf16 v[80:83], v[40:43], a[48:51], v[80:83]
    ds_read_b128 v[40:43], v2 offset:10240
    s_waitcnt vmcnt(9) lgkmcnt(8)
    v_mfma_f32_16x16x32_bf16 v[64:67], v[44:47], a[52:55], v[64:67]
    ds_read_b128 v[44:47], v2 offset:11264
    buffer_load_dwordx4 v1, s[8:11], s43 offen offset:3072 sc1 lds
    v_mfma_f32_16x16x32_bf16 v[68:71], v[48:51], a[52:55], v[68:71]
    ds_read_b128 v[48:51], v2 offset:12288
    s_waitcnt lgkmcnt(7)
    v_mfma_f32_16x16x32_bf16 v[72:75], v[52:55], a[52:55], v[72:75]
    ds_read_b128 v[52:55], v2 offset:13312
    v_mfma_f32_16x16x32_bf16 v[76:79], v[56:59], a[52:55], v[76:79]
    ds_read_b128 v[56:59], v2 offset:14336
    v_mfma_f32_16x16x32_bf16 v[80:83], v[60:63], a[52:55], v[80:83]
    ds_read_b128 v[60:63], v2 offset:15360
    s_add_u32 m0, s39, 16384
    s_add_u32 s43, s43, 16384
    buffer_load_dwordx4 v1, s[8:11], s43 offen offset:0 sc1 lds
    s_waitcnt vmcnt(10) lgkmcnt(8)
    v_mfma_f32_16x16x32_bf16 v[64:67], v[24:27], a[56:59], v[64:67]
    ds_read_b128 v[24:27], v2 offset:16384
    v_mfma_f32_16x16x32_bf16 v[68:71], v[28:31], a[56:59], v[68:71]
    ds_read_b128 v[28:31], v2 offset:17408
    s_waitcnt lgkmcnt(7)
    v_mfma_f32_16x16x32_bf16 v[72:75], v[32:35], a[56:59], v[72:75]
    ds_read_b128 v[32:35], v2 offset:18432
    v_mfma_f32_16x16x32_bf16 v[76:79], v[36:39], a[56:59], v[76:79]
    ds_read_b128 v[36:39], v2 offset:19456
    buffer_load_dwordx4 v1, s[8:11], s43 offen offset:1024 sc1 lds
    v_mfma_f32_16x16x32_bf16 v[80:83], v[40:43], a[56:59], v[80:83]
    ds_read_b128 v[40:43], v2 offset:20480
    s_waitcnt vmcnt(10) lgkmcnt(8)
    v_mfma_f32_16x16x32_bf16 v[64:67], v[44:47], a[60:63], v[64:67]
    ds_read_b128 v[44:47], v2 offset:21504
    v_mfma_f32_16x16x32_bf16 v[68:71], v[48:51], a[60:63], v[68:71]
    ds_read_b128 v[48:51], v2 offset:22528
    s_waitcnt lgkmcnt(7)
    v_mfma_f32_16x16x32_bf16 v[72:75], v[52:55], a[60:63], v[72:75]
    ds_read_b128 v[52:55], v2 offset:23552
    buffer_load_dwordx4 v1, s[8:11], s43 offen offset:2048 sc1 lds
    v_mfma_f32_16x16x32_bf16 v[76:79], v[56:59], a[60:63], v[76:79]
    ds_read_b128 v[56:59], v2 offset:24576
    v_mfma_f32_16x16x32_bf16 v[80:83], v[60:63], a[60:63], v[80:83]
    ds_read_b128 v[60:63], v2 offset:25600
    s_waitcnt vmcnt(10) lgkmcnt(8)
    v_mfma_f32_16x16x32_bf16 v[64:67], v[24:27], a[64:67], v[64:67]
    ds_read_b128 v[24:27], v2 offset:26624
    v_mfma_f32_16x16x32_bf16 v[68:71], v[28:31], a[64:67], v[68:71]
    ds_read_b128 v[28:31], v2 offset:27648
    buffer_load_dwordx4 v1, s[8:11], s43 offen offset:3072 sc1 lds
    s_waitcnt lgkmcnt(7)
    v_mfma_f32_16x16x32_bf16 v[72:75], v[32:35], a[64:67], v[72:75]
    ds_read_b128 v[32:35], v2 offset:28672
    v_mfma_f32_16x16x32_bf16 v[76:79], v[36:39], a[64:67], v[76:79]
    ds_read_b128 v[36:39], v2 offset:29696
    v_mfma_f32_16x16x32_bf16 v[80:83], v[40:43], a[64:67], v[80:83]
    ds_read_b128 v[40:43], v2 offset:30720
    s_waitcnt vmcnt(10) lgkmcnt(8)
    v_mfma_f32_16x16x32_bf16 v[64:67], v[44:47], a[68:71], v[64:67]
    ds_read_b128 v[44:47], v2 offset:31744
    s_add_u32 m0, s39, 32768
    s_add_u32 s43, s43, 16384
    buffer_load_dwordx4 v1, s[8:11], s43 offen offset:0 sc1 lds
    v_mfma_f32_16x16x32_bf16 v[68:71], v[48:51], a[68:71], v[68:71]
    ds_read_b128 v[48:51], v2 offset:32768
    s_waitcnt lgkmcnt(7)
    v_mfma_f32_16x16x32_bf16 v[72:75], v[52:55], a[68:71], v[72:75]
    ds_read_b128 v[52:55], v2 offset:33792
    v_mfma_f32_16x16x32_bf16 v[76:79], v[56:59], a[68:71], v[76:79]
    ds_read_b128 v[56:59], v2 offset:34816
    v_mfma_f32_16x16x32_bf16 v[80:83], v[60:63], a[68:71], v[80:83]
    ds_read_b128 v[60:63], v2 offset:35840
    buffer_load_dwordx4 v1, s[8:11], s43 offen offset:1024 sc1 lds
    s_waitcnt vmcnt(11) lgkmcnt(8)
    v_mfma_f32_16x16x32_bf16 v[64:67], v[24:27], a[72:75], v[64:67]
    v_mfma_f32_16x16x32_bf16 v[68:71], v[28:31], a[72:75], v[68:71]
    s_waitcnt lgkmcnt(5)
    v_mfma_f32_16x16x32_bf16 v[72:75], v[32:35], a[72:75], v[72:75]
    v_mfma_f32_16x16x32_bf16 v[76:79], v[36:39], a[72:75], v[76:79]
    buffer_load_dwordx4 v1, s[8:11], s43 offen offset:2048 sc1 lds
    v_mfma_f32_16x16x32_bf16 v[80:83], v[40:43], a[72:75], v[80:83]
    s_waitcnt vmcnt(11) lgkmcnt(3)
    v_mfma_f32_16x16x32_bf16 v[64:67], v[44:47], a[76:79], v[64:67]
    v_mfma_f32_16x16x32_bf16 v[68:71], v[48:51], a[76:79], v[68:71]
    s_waitcnt lgkmcnt(0)
    v_mfma_f32_16x16x32_bf16 v[72:75], v[52:55], a[76:79], v[72:75]
    buffer_load_dwordx4 v1, s[8:11], s43 offen offset:3072 sc1 lds
    v_mfma_f32_16x16x32_bf16 v[76:79], v[56:59], a[76:79], v[76:79]
    v_mfma_f32_16x16x32_bf16 v[80:83], v[60:63], a[76:79], v[80:83]
    s_nop 1
    v_cmp_u_f32 vcc, v64, v64
    s_cbranch_vccnz cold_44
coldr_45:
    s_lshl_b32 s44, s48, 8
    s_lshl_b32 s51, s41, 1
    s_add_u32 s51, s51, s45
    s_lshl_b32 s51, s51, 2
    s_add_u32 s44, s44, s51
    s_add_u32 s44, s44, 86016
    v_pk_fma_f32 v[232:233], v[64:65], v[136:137], v[232:233]
    v_pk_fma_f32 v[234:235], v[66:67], v[138:139], v[234:235]
    v_pk_fma_f32 v[236:237], v[68:69], v[140:141], v[236:237]
    v_pk_fma_f32 v[238:239], v[70:71], v[142:143], v[238:239]
    v_pk_mul_f32 v[160:161], v[160:161], v[232:233]
    v_pk_mul_f32 v[162:163], v[162:163], v[234:235]
    v_pk_mul_f32 v[164:165], v[164:165], v[236:237]
    v_pk_mul_f32 v[166:167], v[166:167], v[238:239]
    v_cvt_pk_bf16_f32 v100, v160, v161
    v_cvt_pk_bf16_f32 v101, v162, v163
    v_cvt_pk_bf16_f32 v102, v164, v165
    v_cvt_pk_bf16_f32 v103, v166, v167
    buffer_store_dwordx4 v[100:103], v9, s[8:11], s52 offen sc1
    v_pk_fma_f32 v[240:241], v[72:73], v[144:145], v[240:241]
    v_pk_fma_f32 v[242:243], v[74:75], v[146:147], v[242:243]
    v_pk_fma_f32 v[244:245], v[76:77], v[148:149], v[244:245]
    v_pk_fma_f32 v[246:247], v[78:79], v[150:151], v[246:247]
    v_pk_mul_f32 v[168:169], v[168:169], v[240:241]
    v_pk_mul_f32 v[170:171], v[170:171], v[242:243]
    v_pk_mul_f32 v[172:173], v[172:173], v[244:245]
    v_pk_mul_f32 v[174:175], v[174:175], v[246:247]
    v_cvt_pk_bf16_f32 v104, v168, v169
    v_cvt_pk_bf16_f32 v105, v170, v171
    v_cvt_pk_bf16_f32 v106, v172, v173
    v_cvt_pk_bf16_f32 v107, v174, v175
    buffer_store_dwordx4 v[104:107], v9, s[8:11], s52 offen offset:2048 sc1
    v_pk_fma_f32 v[248:249], v[80:81], v[152:153], v[248:249]
    v_pk_fma_f32 v[250:251], v[82:83], v[154:155], v[250:251]
    v_pk_mul_f32 v[176:177], v[176:177], v[248:249]
    v_pk_mul_f32 v[178:179], v[178:179], v[250:251]
    v_cvt_pk_bf16_f32 v108, v176, v177
    v_cvt_pk_bf16_f32 v109, v178, v179
    buffer_store_dwordx2 v[108:109], v8, s[8:11], s52 offen sc1
    buffer_atomic_swap v4, v7, s[8:11], s44 offen offset:0 sc1
    v_pk_add_f32 v[112:113], v[232:233], v[234:235]
    v_pk_mul_f32 v[114:115], v[232:233], v[232:233]
    v_pk_fma_f32 v[114:115], v[234:235], v[234:235], v[114:115]
    v_pk_add_f32 v[112:113], v[112:113], v[236:237]
    v_pk_fma_f32 v[114:115], v[236:237], v[236:237], v[114:115]
    v_pk_add_f32 v[112:113], v[112:113], v[238:239]
    v_pk_fma_f32 v[114:115], v[238:239], v[238:239], v[114:115]
    v_pk_add_f32 v[112:113], v[112:113], v[240:241]
    v_pk_fma_f32 v[114:115], v[240:241], v[240:241], v[114:115]
    v_pk_add_f32 v[112:113], v[112:113], v[242:243]
    v_pk_fma_f32 v[114:115], v[242:243], v[242:243], v[114:115]
    v_pk_add_f32 v[112:113], v[112:113], v[244:245]
    v_pk_fma_f32 v[114:115], v[244:245], v[244:245], v[114:115]
    v_pk_add_f32 v[112:113], v[112:113], v[246:247]
    v_pk_fma_f32 v[114:115], v[246:247], v[246:247], v[114:115]
    v_pk_add_f32 v[112:113], v[112:113], v[248:249]
    v_pk_fma_f32 v[114:115], v[248:249], v[248:249], v[114:115]
    v_pk_add_f32 v[112:113], v[112:113], v[250:251]
    v_pk_fma_f32 v[114:115], v[250:251], v[250:251], v[114:115]
    v_add_f32 v112, v112, v113
    v_add_f32 v113, v114, v115
    v_mov_b32 v114, v112
    v_mov_b32 v115, v113
    s_nop 0
    v_permlane16_swap_b32 v112, v114
    v_permlane16_swap_b32 v113, v115
    v_pk_add_f32 v[112:113], v[112:113], v[114:115]
    v_mov_b32 v114, v112
    v_mov_b32 v115, v113
    s_nop 0
    v_permlane32_swap_b32 v112, v114
    v_permlane32_swap_b32 v113, v115
    v_pk_add_f32 v[112:113], v[112:113], v[114:115]
    buffer_store_dwordx2 v[112:113], v10, s[8:11], s53 offen sc1
    s_barrier
    s_add_u32 m0, s39, 49152
    s_add_u32 s43, s43, 16384
    buffer_load_dwordx4 v1, s[8:11], s43 offen offset:0 sc1 lds
    buffer_load_dwordx4 v1, s[8:11], s43 offen offset:1024 sc1 lds
    buffer_load_dwordx4 v1, s[8:11], s43 offen offset:2048 sc1 lds
    buffer_load_dwordx4 v1, s[8:11], s43 offen offset:3072 sc1 lds
    s_lshl_b32 s50, s7, 8
    s_add_u32 s50, s50, 86016
    s_mov_b64 exec, 65535
    v_mov_b32 v23, 0
    buffer_atomic_or v23, v252, s[8:11], s50 offen sc0 sc1
    s_mov_b64 exec, -1
    s_add_u32 m0, s39, 65536
    s_add_u32 s43, s43, 16384
    buffer_load_dwordx4 v1, s[8:11], s43 offen offset:0 sc1 lds
    buffer_load_dwordx4 v1, s[8:11], s43 offen offset:1024 sc1 lds
    buffer_load_dwordx4 v1, s[8:11], s43 offen offset:2048 sc1 lds
    buffer_load_dwordx4 v1, s[8:11], s43 offen offset:3072 sc1 lds
    s_lshl_b32 s51, s7, 11
    s_add_u32 s51, s51, 393216
    s_mul_i32 s52, s7, 40960
    s_add_u32 s52, s52, 22016000
    ds_read_b128 v[160:163], v3 offset:21504
    ds_read_b128 v[164:167], v3 offset:22528
    ds_read_b128 v[168:171], v3 offset:23552
    ds_read_b128 v[172:175], v3 offset:24576
    ds_read_b128 v[176:179], v3 offset:25600
    ds_read_b128 v[180:183], v3 offset:26624
    s_mov_b64 exec, 0
    s_cmp_eq_u32 s3, 0
    s_cbranch_scc1 L_pg2_0
    s_cmp_eq_u32 s3, 1
    s_cbranch_scc1 L_pg2_1
    s_cmp_eq_u32 s3, 2
    s_cbranch_scc1 L_wr2
    s_cmp_eq_u32 s3, 3
    s_cbranch_scc1 L_wr2
L_wr2:
    s_mov_b64 exec, -1
    s_waitcnt vmcnt(4)
    s_mov_b64 exec, 65535
    v_cmp_ne_u32 vcc, s6, v23
    s_mov_b64 exec, -1
    s_cbranch_vccnz cold_49
coldr_50:
    s_add_u32 s52, s52, 4096
    buffer_load_dwordx4 a[0:3], v1, s[8:11], s52 offen offset:0 sc1
    buffer_load_dwordx4 a[4:7], v1, s[8:11], s52 offen offset:1024 sc1
    buffer_load_dwordx4 a[8:11], v1, s[8:11], s52 offen offset:2048 sc1
    buffer_load_dwordx4 a[12:15], v1, s[8:11], s52 offen offset:3072 sc1
    s_add_u32 s52, s52, 4096
    buffer_load_dwordx4 a[16:19], v1, s[8:11], s52 offen offset:0 sc1
    buffer_load_dwordx4 a[20:23], v1, s[8:11], s52 offen offset:1024 sc1
    buffer_load_dwordx4 a[24:27], v1, s[8:11], s52 offen offset:2048 sc1
    buffer_load_dwordx4 a[28:31], v1, s[8:11], s52 offen offset:3072 sc1
    s_add_u32 s52, s52, 4096
    buffer_load_dwordx4 a[32:35], v1, s[8:11], s52 offen offset:0 sc1
    buffer_load_dwordx4 a[36:39], v1, s[8:11], s52 offen offset:1024 sc1
    s_waitcnt vmcnt(19)
    buffer_atomic_swap v4, v7, s[8:11], s44 offen offset:128 sc1
    s_barrier
    ds_read_b128 v[32:35], v2 offset:49152
    ds_read_b128 v[36:39], v2 offset:50176
    ds_read_b128 v[40:43], v2 offset:51200
    ds_read_b128 v[44:47], v2 offset:52224
    s_waitcnt vmcnt(10) lgkmcnt(3)
    v_mfma_f32_32x32x16_bf16 v[64:79], v[32:35], a[0:3], 0
    ds_read_b128 v[32:35], v2 offset:53248
    buffer_load_dwordx4 a[40:43], v1, s[8:11], s52 offen offset:2048 sc1
    s_waitcnt lgkmcnt(2)
    v_mfma_f32_32x32x16_bf16 v[80:95], v[36:39], a[0:3], 0
    ds_read_b128 v[36:39], v2 offset:54272
    v_mfma_f32_32x32x16_bf16 v[96:111], v[40:43], a[0:3], 0
    ds_read_b128 v[40:43], v2 offset:55296
    buffer_load_dwordx4 a[44:47], v1, s[8:11], s52 offen offset:3072 sc1
    s_waitcnt vmcnt(11) lgkmcnt(3)
    v_mfma_f32_32x32x16_bf16 v[64:79], v[44:47], a[4:7], v[64:79]
L_pg1_2:
    s_cbranch_execz L_wr1
    ds_read_b128 v[44:47], v2 offset:56320
    v_bfe_u32 v8, v5, 4, 1
    v_mul_u32_u24 v8, 49152, v8
    v_lshl_add_u32 v8, v220, 4, v8
    v_lshrrev_b32 v9, 5, v5
    s_waitcnt lgkmcnt(2)
    v_mfma_f32_32x32x16_bf16 v[80:95], v[32:35], a[4:7], v[80:95]
    ds_read_b128 v[32:35], v2 offset:57344
    s_add_u32 s52, s52, 4096
    buffer_load_dwordx4 a[48:51], v1, s[8:11], s52 offen offset:0 sc1
    v_mfma_f32_32x32x16_bf16 v[96:111], v[36:39], a[4:7], v[96:111]
    ds_read_b128 v[36:39], v2 offset:58368
    v_lshl_add_u32 v8, v9, 8, v8
    s_mul_i32 s53, s7, 98304
    s_add_u32 s53, s53, 24641536
    s_lshl_b32 s55, s5, 10
    s_waitcnt vmcnt(11) lgkmcnt(3)
    v_mfma_f32_32x32x16_bf16 v[64:79], v[40:43], a[8:11], v[64:79]
    ds_read_b128 v[40:43], v2 offset:59392
    buffer_load_dwordx4 a[52:55], v1, s[8:11], s52 offen offset:1024 sc1
    s_waitcnt lgkmcnt(2)
    v_mfma_f32_32x32x16_bf16 v[80:95], v[44:47], a[8:11], v[80:95]
    ds_read_b128 v[44:47], v2 offset:60416
    s_add_u32 s53, s53, s55
    s_lshl_b32 s55, s7, 8
    s_lshl_b32 s56, s5, 2
    s_add_u32 s55, s55, s56
    v_mfma_f32_32x32x16_bf16 v[96:111], v[32:35], a[8:11], v[96:111]
    ds_read_b128 v[32:35], v2 offset:61440
    s_add_u32 s55, s55, 102400
    s_lshl_b32 s57, s48, 8
    s_add_u32 s57, s57, 102400
    s_and_b32 s56, s3, 1
    s_waitcnt vmcnt(11) lgkmcnt(3)
    v_mfma_f32_32x32x16_bf16 v[64:79], v[36:39], a[12:15], v[64:79]
    ds_read_b128 v[36:39], v2 offset:62464
    buffer_load_dwordx4 a[56:59], v1, s[8:11], s52 offen offset:2048 sc1
    s_waitcnt lgkmcnt(2)
    v_mfma_f32_32x32x16_bf16 v[80:95], v[40:43], a[12:15], v[80:95]
    ds_read_b128 v[40:43], v2 offset:63488
    s_mul_i32 s59, s48, 98304
    s_lshl_b32 s58, s56, 10
    s_add_u32 s59, s59, s58
    s_add_u32 s59, s59, 24637440
    v_mfma_f32_32x32x16_bf16 v[96:111], v[44:47], a[12:15], v[96:111]
    ds_read_b128 v[44:47], v2 offset:64512
    buffer_load_dwordx4 a[60:63], v1, s[8:11], s52 offen offset:3072 sc1
    s_waitcnt vmcnt(12) lgkmcnt(3)
    v_mfma_f32_32x32x16_bf16 v[64:79], v[32:35], a[16:19], v[64:79]
    ds_read_b128 v[32:35], v3 offset:0
    v_add_u32 v12, s58, v1
    v_add_u32 v13, s58, v2
    v_add_u32 v14, s58, v3
    s_mul_i32 s58, s56, 49152
    s_waitcnt lgkmcnt(2)
    v_mfma_f32_32x32x16_bf16 v[80:95], v[36:39], a[16:19], v[80:95]
    ds_read_b128 v[36:39], v3 offset:1024
    s_add_u32 s52, s52, 4096
    buffer_load_dwordx4 a[64:67], v1, s[8:11], s52 offen offset:0 sc1
    v_mfma_f32_32x32x16_bf16 v[96:111], v[40:43], a[16:19], v[96:111]
    ds_read_b128 v[40:43], v3 offset:2048
    v_add_u32 v10, s58, v1
    s_sub_u32 s58, 49152, s58
    v_add_u32 v11, s58, v1
    s_mul_i32 s58, s3, 5120
    s_waitcnt vmcnt(12) lgkmcnt(3)
    v_mfma_f32_32x32x16_bf16 v[64:79], v[44:47], a[20:23], v[64:79]
    ds_read_b128 v[44:47], v3 offset:3072
    buffer_load_dwordx4 a[68:71], v1, s[8:11], s52 offen offset:1024 sc1
    s_waitcnt lgkmcnt(2)
    v_mfma_f32_32x32x16_bf16 v[80:95], v[32:35], a[20:23], v[80:95]
    ds_read_b128 v[32:35], v3 offset:4096
    s_add_u32 s58, s58, 65536
    v_add_u32 v15, s58, v1
    s_xor_b32 s58, s3, 1
    s_mul_i32 s58, s58, 5120
    v_mfma_f32_32x32x16_bf16 v[96:111], v[36:39], a[20:23], v[96:111]
    ds_read_b128 v[36:39], v3 offset:5120
    s_add_u32 s58, s58, 65536
    v_add_u32 v16, s58, v1
    v_add_u32 v17, s39, v1
    v_add_u32 v18, 81920, v17
    s_waitcnt vmcnt(12) lgkmcnt(3)
    v_mfma_f32_32x32x16_bf16 v[64:79], v[40:43], a[24:27], v[64:79]
    ds_read_b128 v[40:43], v3 offset:6144
    buffer_load_dwordx4 a[72:75], v1, s[8:11], s52 offen offset:2048 sc1
    s_waitcnt lgkmcnt(2)
    v_mfma_f32_32x32x16_bf16 v[80:95], v[44:47], a[24:27], v[80:95]
    ds_read_b128 v[44:47], v3 offset:7168
    s_add_u32 s58, s39, 32768
    v_mul_u32_u24 v19, 160, v220
    v_add_u32 v19, s58, v19
    v_lshl_add_u32 v20, v221, 3, v19
    v_mfma_f32_32x32x16_bf16 v[96:111], v[32:35], a[24:27], v[96:111]
    ds_read_b128 v[32:35], v3 offset:8192
    buffer_load_dwordx4 a[76:79], v1, s[8:11], s52 offen offset:3072 sc1
    s_waitcnt vmcnt(13) lgkmcnt(3)
    v_mfma_f32_32x32x16_bf16 v[64:79], v[36:39], a[28:31], v[64:79]
    ds_read_b128 v[36:39], v3 offset:9216
    v_lshl_add_u32 v19, v221, 4, v19
    v_add_u32 v48, 0, v5
    v_mul_u32_u24 v51, 6554, v48
    v_lshrrev_b32 v51, 16, v51
    s_waitcnt lgkmcnt(2)
    v_mfma_f32_32x32x16_bf16 v[80:95], v[40:43], a[28:31], v[80:95]
    ds_read_b128 v[40:43], v3 offset:10240
    s_add_u32 s52, s52, 4096
    buffer_load_dwordx4 a[80:83], v1, s[8:11], s52 offen offset:0 sc1
    v_mfma_f32_32x32x16_bf16 v[96:111], v[44:47], a[28:31], v[96:111]
    ds_read_b128 v[44:47], v3 offset:11264
    v_mul_u32_u24 v51, 1120, v51
    v_lshl_add_u32 v48, v48, 4, v51
    v_add_u32 v49, 64, v5
    v_mul_u32_u24 v51, 6554, v49
    s_waitcnt vmcnt(13) lgkmcnt(3)
    v_mfma_f32_32x32x16_bf16 v[64:79], v[32:35], a[32:35], v[64:79]
    ds_read_b128 v[32:35], v3 offset:12288
    buffer_load_dwordx4 a[84:87], v1, s[8:11], s52 offen offset:1024 sc1
    s_waitcnt lgkmcnt(2)
    v_mfma_f32_32x32x16_bf16 v[80:95], v[36:39], a[32:35], v[80:95]
    ds_read_b128 v[36:39], v3 offset:13312
    v_lshrrev_b32 v51, 16, v51
    v_mul_u32_u24 v51, 1120, v51
    v_lshl_add_u32 v49, v49, 4, v51
    v_add_u32 v50, 128, v5
    v_mfma_f32_32x32x16_bf16 v[96:111], v[40:43], a[32:35], v[96:111]
    ds_read_b128 v[40:43], v3 offset:14336
    v_mul_u32_u24 v51, 6554, v50
    v_lshrrev_b32 v51, 16, v51
    v_mul_u32_u24 v51, 1120, v51
    v_lshl_add_u32 v50, v50, 4, v51
    s_waitcnt vmcnt(13) lgkmcnt(3)
    v_mfma_f32_32x32x16_bf16 v[64:79], v[44:47], a[36:39], v[64:79]
    ds_read_b128 v[44:47], v3 offset:15360
    buffer_load_dwordx4 a[88:91], v1, s[8:11], s52 offen offset:2048 sc1
    s_waitcnt lgkmcnt(2)
    v_mfma_f32_32x32x16_bf16 v[80:95], v[32:35], a[36:39], v[80:95]
    s_barrier
    ds_read_b128 v[32:35], v1 offset:0
    v_lshrrev_b32 v51, 5, v5
    v_lshl_or_b32 v50, v51, 31, v50
    v_mfma_f32_32x32x16_bf16 v[96:111], v[36:39], a[36:39], v[96:111]
    ds_read_b128 v[36:39], v1 offset:1024
    buffer_load_dwordx4 a[92:95], v1, s[8:11], s52 offen offset:3072 sc1
    s_waitcnt vmcnt(13) lgkmcnt(3)
    v_mfma_f32_32x32x16_bf16 v[64:79], v[40:43], a[40:43], v[64:79]
    ds_read_b128 v[40:43], v1 offset:2048
    s_waitcnt lgkmcnt(2)
    v_mfma_f32_32x32x16_bf16 v[80:95], v[44:47], a[40:43], v[80:95]
    ds_read_b128 v[44:47], v1 offset:3072
    s_add_u32 s52, s52, 4096
    buffer_load_dwordx4 a[96:99], v1, s[8:11], s52 offen offset:0 sc1
    v_mfma_f32_32x32x16_bf16 v[96:111], v[32:35], a[40:43], v[96:111]
    ds_read_b128 v[32:35], v1 offset:4096
    s_waitcnt vmcnt(13) lgkmcnt(3)
    v_mfma_f32_32x32x16_bf16 v[64:79], v[36:39], a[44:47], v[64:79]
    ds_read_b128 v[36:39], v1 offset:5120
    buffer_load_dwordx4 a[100:103], v1, s[8:11], s52 offen offset:1024 sc1
    s_waitcnt lgkmcnt(2)
    v_mfma_f32_32x32x16_bf16 v[80:95], v[40:43], a[44:47], v[80:95]
    ds_read_b128 v[40:43], v1 offset:6144
    v_mfma_f32_32x32x16_bf16 v[96:111], v[44:47], a[44:47], v[96:111]
    ds_read_b128 v[44:47], v1 offset:7168
    s_waitcnt vmcnt(13) lgkmcnt(3)
    v_mfma_f32_32x32x16_bf16 v[64:79], v[32:35], a[48:51], v[64:79]
    ds_read_b128 v[32:35], v1 offset:8192
    buffer_load_dwordx4 a[104:107], v1, s[8:11], s52 offen offset:2048 sc1
    s_waitcnt lgkmcnt(2)
    v_mfma_f32_32x32x16_bf16 v[80:95], v[36:39], a[48:51], v[80:95]
    ds_read_b128 v[36:39], v1 offset:9216
    v_mfma_f32_32x32x16_bf16 v[96:111], v[40:43], a[48:51], v[96:111]
    ds_read_b128 v[40:43], v1 offset:10240
    buffer_load_dwordx4 v[200:203], v222, s[8:11], s51 offen offset:0 sc1
    s_waitcnt vmcnt(14) lgkmcnt(3)
    v_mfma_f32_32x32x16_bf16 v[64:79], v[44:47], a[52:55], v[64:79]
    ds_read_b128 v[44:47], v1 offset:11264
    s_waitcnt lgkmcnt(2)
    v_mfma_f32_32x32x16_bf16 v[80:95], v[32:35], a[52:55], v[80:95]
    ds_read_b128 v[32:35], v1 offset:12288
    buffer_load_dwordx4 v[204:207], v222, s[8:11], s51 offen offset:16 sc1
    v_mfma_f32_32x32x16_bf16 v[96:111], v[36:39], a[52:55], v[96:111]
    ds_read_b128 v[36:39], v1 offset:13312
    s_waitcnt vmcnt(14) lgkmcnt(3)
    v_mfma_f32_32x32x16_bf16 v[64:79], v[40:43], a[56:59], v[64:79]
    ds_read_b128 v[40:43], v1 offset:14336
    buffer_load_dwordx4 a[108:111], v1, s[8:11], s52 offen offset:3072 sc1
    s_waitcnt lgkmcnt(2)
    v_mfma_f32_32x32x16_bf16 v[80:95], v[44:47], a[56:59], v[80:95]
    ds_read_b128 v[44:47], v1 offset:15360
    v_mfma_f32_32x32x16_bf16 v[96:111], v[32:35], a[56:59], v[96:111]
    s_barrier
    ds_read_b128 v[32:35], v1 offset:16384
    s_waitcnt vmcnt(14) lgkmcnt(3)
    v_mfma_f32_32x32x16_bf16 v[64:79], v[36:39], a[60:63], v[64:79]
    ds_read_b128 v[36:39], v1 offset:17408
    s_add_u32 s52, s52, 4096
    buffer_load_dwordx4 a[112:115], v1, s[8:11], s52 offen offset:0 sc1
    s_waitcnt lgkmcnt(2)
    v_mfma_f32_32x32x16_bf16 v[80:95], v[40:43], a[60:63], v[80:95]
    ds_read_b128 v[40:43], v1 offset:18432
    v_mfma_f32_32x32x16_bf16 v[96:111], v[44:47], a[60:63], v[96:111]
    ds_read_b128 v[44:47], v1 offset:19456
    buffer_load_dwordx4 a[116:119], v1, s[8:11], s52 offen offset:1024 sc1
    s_waitcnt vmcnt(15) lgkmcnt(3)
    v_mfma_f32_32x32x16_bf16 v[64:79], v[32:35], a[64:67], v[64:79]
    ds_read_b128 v[32:35], v1 offset:20480
    s_waitcnt lgkmcnt(2)
    v_mfma_f32_32x32x16_bf16 v[80:95], v[36:39], a[64:67], v[80:95]
    ds_read_b128 v[36:39], v1 offset:21504
    buffer_load_dwordx4 a[120:123], v1, s[8:11], s52 offen offset:2048 sc1
    v_mfma_f32_32x32x16_bf16 v[96:111], v[40:43], a[64:67], v[96:111]
    ds_read_b128 v[40:43], v1 offset:22528
    s_waitcnt vmcnt(15) lgkmcnt(3)
    v_mfma_f32_32x32x16_bf16 v[64:79], v[44:47], a[68:71], v[64:79]
    ds_read_b128 v[44:47], v1 offset:23552
    buffer_load_dwordx4 a[124:127], v1, s[8:11], s52 offen offset:3072 sc1
    s_waitcnt lgkmcnt(2)
    v_mfma_f32_32x32x16_bf16 v[80:95], v[32:35], a[68:71], v[80:95]
    ds_read_b128 v[32:35], v1 offset:24576
    v_mfma_f32_32x32x16_bf16 v[96:111], v[36:39], a[68:71], v[96:111]
    ds_read_b128 v[36:39], v1 offset:25600
    s_waitcnt vmcnt(15) lgkmcnt(3)
    v_mfma_f32_32x32x16_bf16 v[64:79], v[40:43], a[72:75], v[64:79]
    ds_read_b128 v[40:43], v1 offset:26624
    s_add_u32 s52, s52, 4096
    buffer_load_dwordx4 a[128:131], v1, s[8:11], s52 offen offset:0 sc1
    s_waitcnt lgkmcnt(2)
    v_mfma_f32_32x32x16_bf16 v[80:95], v[44:47], a[72:75], v[80:95]
    ds_read_b128 v[44:47], v1 offset:27648
    v_mfma_f32_32x32x16_bf16 v[96:111], v[32:35], a[72:75], v[96:111]
    ds_read_b128 v[32:35], v1 offset:28672
    buffer_load_dwordx4 a[132:135], v1, s[8:11], s52 offen offset:1024 sc1
    s_waitcnt vmcnt(16) lgkmcnt(3)
    v_mfma_f32_32x32x16_bf16 v[64:79], v[36:39], a[76:79], v[64:79]
    ds_read_b128 v[36:39], v1 offset:29696
    s_waitcnt lgkmcnt(2)
    v_mfma_f32_32x32x16_bf16 v[80:95], v[40:43], a[76:79], v[80:95]
    ds_read_b128 v[40:43], v1 offset:30720
    buffer_load_dwordx4 a[136:139], v1, s[8:11], s52 offen offset:2048 sc1
    v_mfma_f32_32x32x16_bf16 v[96:111], v[44:47], a[76:79], v[96:111]
    ds_read_b128 v[44:47], v1 offset:31744
    s_waitcnt vmcnt(16) lgkmcnt(3)
    v_mfma_f32_32x32x16_bf16 v[64:79], v[32:35], a[80:83], v[64:79]
    s_barrier
    ds_read_b128 v[32:35], v1 offset:32768
    s_add_u32 m0, s39, 81920
    s_add_u32 s43, s43, 16384
    buffer_load_dwordx4 v1, s[8:11], s43 offen offset:0 sc1 lds
    s_waitcnt lgkmcnt(2)
    v_mfma_f32_32x32x16_bf16 v[80:95], v[36:39], a[80:83], v[80:95]
    ds_read_b128 v[36:39], v1 offset:33792
    v_mfma_f32_32x32x16_bf16 v[96:111], v[40:43], a[80:83], v[96:111]
    ds_read_b128 v[40:43], v1 offset:34816
    s_waitcnt vmcnt(16) lgkmcnt(3)
    v_mfma_f32_32x32x16_bf16 v[64:79], v[44:47], a[84:87], v[64:79]
    ds_read_b128 v[44:47], v1 offset:35840
    buffer_load_dwordx4 v1, s[8:11], s43 offen offset:1024 sc1 lds
    s_waitcnt lgkmcnt(2)
    v_mfma_f32_32x32x16_bf16 v[80:95], v[32:35], a[84:87], v[80:95]
    ds_read_b128 v[32:35], v1 offset:36864
    v_mfma_f32_32x32x16_bf16 v[96:111], v[36:39], a[84:87], v[96:111]
    ds_read_b128 v[36:39], v1 offset:37888
    buffer_load_dwordx4 a[140:143], v1, s[8:11], s52 offen offset:3072 sc1
    s_waitcnt vmcnt(17) lgkmcnt(3)
    v_mfma_f32_32x32x16_bf16 v[64:79], v[40:43], a[88:91], v[64:79]
    ds_read_b128 v[40:43], v1 offset:38912
    s_waitcnt lgkmcnt(2)
    v_mfma_f32_32x32x16_bf16 v[80:95], v[44:47], a[88:91], v[80:95]
    ds_read_b128 v[44:47], v1 offset:39936
    buffer_load_dwordx4 v1, s[8:11], s43 offen offset:2048 sc1 lds
    v_mfma_f32_32x32x16_bf16 v[96:111], v[32:35], a[88:91], v[96:111]
    ds_read_b128 v[32:35], v1 offset:40960
    s_waitcnt vmcnt(17) lgkmcnt(3)
    v_mfma_f32_32x32x16_bf16 v[64:79], v[36:39], a[92:95], v[64:79]
    ds_read_b128 v[36:39], v1 offset:41984
    s_add_u32 s52, s52, 4096
    buffer_load_dwordx4 a[144:147], v1, s[8:11], s52 offen offset:0 sc1
    s_waitcnt lgkmcnt(2)
    v_mfma_f32_32x32x16_bf16 v[80:95], v[40:43], a[92:95], v[80:95]
    ds_read_b128 v[40:43], v1 offset:43008
    v_mfma_f32_32x32x16_bf16 v[96:111], v[44:47], a[92:95], v[96:111]
    ds_read_b128 v[44:47], v1 offset:44032
    s_waitcnt vmcnt(17) lgkmcnt(3)
    v_mfma_f32_32x32x16_bf16 v[64:79], v[32:35], a[96:99], v[64:79]
    ds_read_b128 v[32:35], v1 offset:45056
    buffer_load_dwordx4 v1, s[8:11], s43 offen offset:3072 sc1 lds
    s_waitcnt lgkmcnt(2)
    v_mfma_f32_32x32x16_bf16 v[80:95], v[36:39], a[96:99], v[80:95]
    ds_read_b128 v[36:39], v1 offset:46080
    v_mfma_f32_32x32x16_bf16 v[96:111], v[40:43], a[96:99], v[96:111]
    ds_read_b128 v[40:43], v1 offset:47104
    buffer_load_dwordx4 a[148:151], v1, s[8:11], s52 offen offset:1024 sc1
    s_waitcnt vmcnt(18) lgkmcnt(3)
    v_mfma_f32_32x32x16_bf16 v[64:79], v[44:47], a[100:103], v[64:79]
    ds_read_b128 v[44:47], v1 offset:48128
    s_waitcnt lgkmcnt(2)
    v_mfma_f32_32x32x16_bf16 v[80:95], v[32:35], a[100:103], v[80:95]
    s_barrier
    ds_read_b128 v[32:35], v1 offset:49152
    buffer_load_dwordx4 a[152:155], v1, s[8:11], s52 offen offset:2048 sc1
    v_mfma_f32_32x32x16_bf16 v[96:111], v[36:39], a[100:103], v[96:111]
    ds_read_b128 v[36:39], v1 offset:50176
    s_waitcnt vmcnt(18) lgkmcnt(3)
    v_mfma_f32_32x32x16_bf16 v[64:79], v[40:43], a[104:107], v[64:79]
    ds_read_b128 v[40:43], v1 offset:51200
    buffer_load_dwordx4 a[156:159], v1, s[8:11], s52 offen offset:3072 sc1
    s_waitcnt lgkmcnt(2)
    v_mfma_f32_32x32x16_bf16 v[80:95], v[44:47], a[104:107], v[80:95]
    ds_read_b128 v[44:47], v1 offset:52224
    v_mfma_f32_32x32x16_bf16 v[96:111], v[32:35], a[104:107], v[96:111]
    ds_read_b128 v[32:35], v1 offset:53248
    s_waitcnt vmcnt(17)
    v_add_f32 v200, v200, v202
    v_add_f32 v201, v201, v203
    v_add_f32 v204, v204, v206
    s_waitcnt vmcnt(16) lgkmcnt(3)
    v_mfma_f32_32x32x16_bf16 v[64:79], v[36:39], a[108:111], v[64:79]
    ds_read_b128 v[36:39], v1 offset:54272
    s_add_u32 m0, s39, 98304
    s_add_u32 s43, s43, 16384
    buffer_load_dwordx4 v1, s[8:11], s43 offen offset:0 sc1 lds
    s_waitcnt lgkmcnt(2)
    v_mfma_f32_32x32x16_bf16 v[80:95], v[40:43], a[108:111], v[80:95]
    ds_read_b128 v[40:43], v1 offset:55296
    v_add_f32 v205, v205, v207
    v_add_f32 v200, v200, v204
    v_add_f32 v201, v201, v205
    v_mov_b32 v202, v200
    v_mfma_f32_32x32x16_bf16 v[96:111], v[44:47], a[108:111], v[96:111]
    ds_read_b128 v[44:47], v1 offset:56320
    buffer_load_dwordx4 v1, s[8:11], s43 offen offset:1024 sc1 lds
    s_waitcnt vmcnt(17) lgkmcnt(3)
    v_mfma_f32_32x32x16_bf16 v[64:79], v[32:35], a[112:115], v[64:79]
    ds_read_b128 v[32:35], v1 offset:57344
    v_mov_b32 v203, v201
    v_mov_b32 v187, 0
    v_permlane32_swap_b32 v200, v202
    v_permlane32_swap_b32 v201, v203
    s_waitcnt lgkmcnt(2)
    v_mfma_f32_32x32x16_bf16 v[80:95], v[36:39], a[112:115], v[80:95]
    ds_read_b128 v[36:39], v1 offset:58368
    buffer_load_dwordx4 v1, s[8:11], s43 offen offset:2048 sc1 lds
    v_mfma_f32_32x32x16_bf16 v[96:111], v[40:43], a[112:115], v[96:111]
    ds_read_b128 v[40:43], v1 offset:59392
    v_add_f32 v200, v200, v202
    v_add_f32 v201, v201, v203
    v_mul_f32 v200, 0xbacccccd, v200
    v_mul_f32 v201, 0x3acccccd, v201
    s_waitcnt vmcnt(17) lgkmcnt(3)
    v_mfma_f32_32x32x16_bf16 v[64:79], v[44:47], a[116:119], v[64:79]
    ds_read_b128 v[44:47], v1 offset:60416
    buffer_load_dwordx4 v1, s[8:11], s43 offen offset:3072 sc1 lds
    s_waitcnt lgkmcnt(2)
    v_mfma_f32_32x32x16_bf16 v[80:95], v[32:35], a[116:119], v[80:95]
    ds_read_b128 v[32:35], v1 offset:61440
    v_fma_f32 v201, -v200, v200, v201
    v_fma_f32 v200, v201, 0, v200
    v_max_f32 v201, 0, v201
    v_add_f32 v194, 0x3727c5ac, v201
    v_mfma_f32_32x32x16_bf16 v[96:111], v[36:39], a[116:119], v[96:111]
    ds_read_b128 v[36:39], v1 offset:62464
    v_rsq_f32 v202, v194
    s_nop 0
    v_mul_f32 v201, v194, v202
    s_waitcnt vmcnt(17) lgkmcnt(3)
    v_mfma_f32_32x32x16_bf16 v[64:79], v[40:43], a[120:123], v[64:79]
    ds_read_b128 v[40:43], v1 offset:63488
    s_add_u32 m0, s39, 114688
    s_add_u32 s43, s43, 16384
    buffer_load_dwordx4 v1, s[8:11], s43 offen offset:0 sc1 lds
    s_waitcnt lgkmcnt(2)
    v_mfma_f32_32x32x16_bf16 v[80:95], v[44:47], a[120:123], v[80:95]
    ds_read_b128 v[44:47], v1 offset:64512
    v_cvt_pk_bf16_f32 v185, v200, v201
    v_lshlrev_b32 v204, 16, v185
    v_and_b32 v205, 0xffff0000, v185
    v_sub_f32 v204, v200, v204
    v_mfma_f32_32x32x16_bf16 v[96:111], v[32:35], a[120:123], v[96:111]
    s_waitcnt vmcnt(52)
    s_barrier
    ds_read_b128 v[32:35], v2 offset:0
    buffer_load_dwordx4 v1, s[8:11], s43 offen offset:1024 sc1 lds
    s_waitcnt vmcnt(18) lgkmcnt(3)
    v_mfma_f32_32x32x16_bf16 v[64:79], v[36:39], a[124:127], v[64:79]
    ds_read_b128 v[36:39], v2 offset:1024
    v_sub_f32 v205, v201, v205
    v_cvt_pk_bf16_f32 v184, v200, v204
    v_cvt_pk_bf16_f32 v186, v205, v201
    v_mul_f32 v190, 0xc0135761, v202
    s_waitcnt lgkmcnt(2)
    v_mfma_f32_32x32x16_bf16 v[80:95], v[40:43], a[124:127], v[80:95]
    ds_read_b128 v[40:43], v2 offset:2048
    buffer_load_dwordx4 v1, s[8:11], s43 offen offset:2048 sc1 lds
    v_mfma_f32_32x32x16_bf16 v[96:111], v[44:47], a[124:127], v[96:111]
    ds_read_b128 v[44:47], v2 offset:3072
    v_mul_f32 v203, v202, v202
    v_mul_f32 v192, 0x3d372713, v203
    v_mul_f32 v192, v192, v190
    s_waitcnt vmcnt(18) lgkmcnt(3)
    v_mfma_f32_32x32x16_bf16 v[64:79], v[32:35], a[128:131], v[64:79]
    ds_read_b128 v[32:35], v2 offset:4096
    buffer_load_dwordx4 v1, s[8:11], s43 offen offset:3072 sc1 lds
    s_waitcnt lgkmcnt(2)
    v_mfma_f32_32x32x16_bf16 v[80:95], v[36:39], a[128:131], v[80:95]
    ds_read_b128 v[36:39], v2 offset:5120
    v_mfma_f32_32x32x16_bf16 v[96:111], v[40:43], a[128:131], v[96:111]
    ds_read_b128 v[40:43], v2 offset:6144
    s_waitcnt vmcnt(18) lgkmcnt(3)
    v_mfma_f32_32x32x16_bf16 v[64:79], v[44:47], a[132:135], v[64:79]
    ds_read_b128 v[44:47], v2 offset:7168
    s_add_u32 m0, s39, 131072
    s_add_u32 s43, s43, 16384
    buffer_load_dwordx4 v1, s[8:11], s43 offen offset:0 sc1 lds
    s_waitcnt lgkmcnt(2)
    v_mfma_f32_32x32x16_bf16 v[80:95], v[32:35], a[132:135], v[80:95]
    ds_read_b128 v[32:35], v2 offset:8192
    v_mfma_f32_32x32x16_bf16 v[96:111], v[36:39], a[132:135], v[96:111]
    ds_read_b128 v[36:39], v2 offset:9216
    buffer_load_dwordx4 v1, s[8:11], s43 offen offset:1024 sc1 lds
    s_waitcnt vmcnt(19) lgkmcnt(3)
    v_mfma_f32_32x32x16_bf16 v[64:79], v[40:43], a[136:139], v[64:79]
    ds_read_b128 v[40:43], v2 offset:10240
    s_waitcnt lgkmcnt(2)
    v_mfma_f32_32x32x16_bf16 v[80:95], v[44:47], a[136:139], v[80:95]
    ds_read_b128 v[44:47], v2 offset:11264
    buffer_load_dwordx4 v1, s[8:11], s43 offen offset:2048 sc1 lds
    v_mfma_f32_32x32x16_bf16 v[96:111], v[32:35], a[136:139], v[96:111]
    ds_read_b128 v[32:35], v2 offset:12288
    s_waitcnt vmcnt(17) lgkmcnt(3)
    v_mfma_f32_32x32x16_bf16 v[64:79], v[36:39], a[140:143], v[64:79]
    ds_read_b128 v[36:39], v2 offset:13312
    buffer_load_dwordx4 v1, s[8:11], s43 offen offset:3072 sc1 lds
    s_waitcnt lgkmcnt(2)
    v_mfma_f32_32x32x16_bf16 v[80:95], v[40:43], a[140:143], v[80:95]
    ds_read_b128 v[40:43], v2 offset:14336
    v_mfma_f32_32x32x16_bf16 v[96:111], v[44:47], a[140:143], v[96:111]
    ds_read_b128 v[44:47], v2 offset:15360
    s_waitcnt vmcnt(16) lgkmcnt(3)
    v_mfma_f32_32x32x16_bf16 v[64:79], v[32:35], a[144:147], v[64:79]
    s_waitcnt vmcnt(15)
    s_barrier
    ds_read_b128 v[32:35], v2 offset:16384
    s_add_u32 m0, s39, 0
    s_add_u32 s43, s43, 16384
    buffer_load_dwordx4 v1, s[8:11], s43 offen offset:0 sc1 lds
    s_waitcnt lgkmcnt(2)
    v_mfma_f32_32x32x16_bf16 v[80:95], v[36:39], a[144:147], v[80:95]
    ds_read_b128 v[36:39], v2 offset:17408
    v_mfma_f32_32x32x16_bf16 v[96:111], v[40:43], a[144:147], v[96:111]
    ds_read_b128 v[40:43], v2 offset:18432
    buffer_load_dwordx4 v1, s[8:11], s43 offen offset:1024 sc1 lds
    s_waitcnt vmcnt(16) lgkmcnt(3)
    v_mfma_f32_32x32x16_bf16 v[64:79], v[44:47], a[148:151], v[64:79]
    ds_read_b128 v[44:47], v2 offset:19456
    s_waitcnt lgkmcnt(2)
    v_mfma_f32_32x32x16_bf16 v[80:95], v[32:35], a[148:151], v[80:95]
    ds_read_b128 v[32:35], v2 offset:20480
    buffer_load_dwordx4 v1, s[8:11], s43 offen offset:2048 sc1 lds
    v_mfma_f32_32x32x16_bf16 v[96:111], v[36:39], a[148:151], v[96:111]
    ds_read_b128 v[36:39], v2 offset:21504
    v_mfma_f32_32x32x16_bf16 v[64:79], v[160:163], v[184:187], v[64:79]
    v_mfma_f32_32x32x16_bf16 v[80:95], v[164:167], v[184:187], v[80:95]
    v_mfma_f32_32x32x16_bf16 v[96:111], v[168:171], v[184:187], v[96:111]
    s_waitcnt vmcnt(16) lgkmcnt(3)
    v_mfma_f32_32x32x16_bf16 v[64:79], v[40:43], a[152:155], v[64:79]
    ds_read_b128 v[40:43], v2 offset:22528
    buffer_load_dwordx4 v1, s[8:11], s43 offen offset:3072 sc1 lds
    s_waitcnt lgkmcnt(2)
    v_mfma_f32_32x32x16_bf16 v[80:95], v[44:47], a[152:155], v[80:95]
    ds_read_b128 v[44:47], v2 offset:23552
    v_mfma_f32_32x32x16_bf16 v[96:111], v[32:35], a[152:155], v[96:111]
    ds_read_b128 v[32:35], v2 offset:24576
    s_waitcnt vmcnt(16) lgkmcnt(3)
    v_mfma_f32_32x32x16_bf16 v[64:79], v[36:39], a[156:159], v[64:79]
    ds_read_b128 v[36:39], v2 offset:25600
    s_add_u32 m0, s39, 16384
    s_add_u32 s43, s43, 16384
    buffer_load_dwordx4 v1, s[8:11], s43 offen offset:0 sc1 lds
    s_waitcnt lgkmcnt(2)
    v_mfma_f32_32x32x16_bf16 v[80:95], v[40:43], a[156:159], v[80:95]
    ds_read_b128 v[40:43], v2 offset:26624
    v_mfma_f32_32x32x16_bf16 v[96:111], v[44:47], a[156:159], v[96:111]
    ds_read_b128 v[44:47], v2 offset:27648
    buffer_load_dwordx4 v1, s[8:11], s43 offen offset:1024 sc1 lds
    buffer_load_dwordx4 v1, s[8:11], s43 offen offset:2048 sc1 lds
    buffer_load_dwordx4 v1, s[8:11], s43 offen offset:3072 sc1 lds
    v_cmp_u_f32 vcc, v64, v64
    s_cbranch_vccnz cold_53
coldr_54:
    v_mfma_f32_32x32x16_bf16 v[112:127], v[172:175], v[184:187], 0
    s_add_u32 m0, s39, 32768
    s_add_u32 s43, s43, 16384
    buffer_load_dwordx4 v1, s[8:11], s43 offen offset:0 sc1 lds
    buffer_load_dwordx4 v1, s[8:11], s43 offen offset:1024 sc1 lds
    v_pk_mul_f32 v[200:201], v[64:65], v[64:65]
    v_pk_mul_f32 v[202:203], v[66:67], v[66:67]
    v_pk_mul_f32 v[204:205], v[68:69], v[68:69]
    v_pk_mul_f32 v[206:207], v[70:71], v[70:71]
    v_pk_fma_f32 v[200:201], v[200:201], v[192:193], v[190:191] op_sel_hi:[1,0,0]
    v_pk_fma_f32 v[202:203], v[202:203], v[192:193], v[190:191] op_sel_hi:[1,0,0]
    v_pk_fma_f32 v[204:205], v[204:205], v[192:193], v[190:191] op_sel_hi:[1,0,0]
    v_pk_fma_f32 v[206:207], v[206:207], v[192:193], v[190:191] op_sel_hi:[1,0,0]
    v_pk_mul_f32 v[200:201], v[200:201], v[64:65]
    v_pk_mul_f32 v[202:203], v[202:203], v[66:67]
    v_pk_mul_f32 v[204:205], v[204:205], v[68:69]
    v_pk_mul_f32 v[206:207], v[206:207], v[70:71]
    v_exp_f32 v200, v200
    v_exp_f32 v201, v201
    v_exp_f32 v202, v202
    v_exp_f32 v203, v203
    v_exp_f32 v204, v204
    v_exp_f32 v205, v205
    v_exp_f32 v206, v206
    v_exp_f32 v207, v207
    v_pk_mul_f32 v[80:81], v[80:81], v[64:65]
    v_pk_mul_f32 v[82:83], v[82:83], v[66:67]
    v_pk_mul_f32 v[84:85], v[84:85], v[68:69]
    v_pk_mul_f32 v[86:87], v[86:87], v[70:71]
    buffer_load_dwordx4 v1, s[8:11], s43 offen offset:2048 sc1 lds
    v_pk_fma_f32 v[200:201], v[200:201], v[194:195], v[194:195] op_sel_hi:[1,0,0]
    v_pk_fma_f32 v[202:203], v[202:203], v[194:195], v[194:195] op_sel_hi:[1,0,0]
    v_pk_fma_f32 v[204:205], v[204:205], v[194:195], v[194:195] op_sel_hi:[1,0,0]
    v_pk_fma_f32 v[206:207], v[206:207], v[194:195], v[194:195] op_sel_hi:[1,0,0]
    v_rcp_f32 v200, v200
    v_rcp_f32 v201, v201
    v_rcp_f32 v202, v202
    v_rcp_f32 v203, v203
    v_rcp_f32 v204, v204
    v_rcp_f32 v205, v205
    v_rcp_f32 v206, v206
    v_rcp_f32 v207, v207
    v_pk_mul_f32 v[80:81], v[80:81], v[200:201]
    v_pk_mul_f32 v[82:83], v[82:83], v[202:203]
    v_pk_mul_f32 v[84:85], v[84:85], v[204:205]
    v_pk_mul_f32 v[86:87], v[86:87], v[206:207]
    v_cvt_pk_bf16_f32 v64, v80, v81
    v_cvt_pk_bf16_f32 v65, v82, v83
    v_cvt_pk_bf16_f32 v66, v84, v85
    v_cvt_pk_bf16_f32 v67, v86, v87
    buffer_store_dwordx4 v[64:67], v8, s[8:11], s53 offen offset:0 sc1
    buffer_load_dwordx4 v1, s[8:11], s43 offen offset:3072 sc1 lds
    s_add_u32 m0, s39, 49152
    s_add_u32 s43, s43, 16384
    buffer_load_dwordx4 v1, s[8:11], s43 offen offset:0 sc1 lds
    v_pk_mul_f32 v[208:209], v[72:73], v[72:73]
    v_pk_mul_f32 v[210:211], v[74:75], v[74:75]
    v_pk_mul_f32 v[212:213], v[76:77], v[76:77]
    v_pk_mul_f32 v[214:215], v[78:79], v[78:79]
    v_pk_fma_f32 v[208:209], v[208:209], v[192:193], v[190:191] op_sel_hi:[1,0,0]
    v_pk_fma_f32 v[210:211], v[210:211], v[192:193], v[190:191] op_sel_hi:[1,0,0]
    v_pk_fma_f32 v[212:213], v[212:213], v[192:193], v[190:191] op_sel_hi:[1,0,0]
    v_pk_fma_f32 v[214:215], v[214:215], v[192:193], v[190:191] op_sel_hi:[1,0,0]
    v_pk_mul_f32 v[208:209], v[208:209], v[72:73]
    v_pk_mul_f32 v[210:211], v[210:211], v[74:75]
    v_pk_mul_f32 v[212:213], v[212:213], v[76:77]
    v_pk_mul_f32 v[214:215], v[214:215], v[78:79]
    v_exp_f32 v208, v208
    v_exp_f32 v209, v209
    v_exp_f32 v210, v210
    v_exp_f32 v211, v211
    v_exp_f32 v212, v212
    v_exp_f32 v213, v213
    v_exp_f32 v214, v214
    v_exp_f32 v215, v215
    v_pk_mul_f32 v[88:89], v[88:89], v[72:73]
    v_pk_mul_f32 v[90:91], v[90:91], v[74:75]
    v_pk_mul_f32 v[92:93], v[92:93], v[76:77]
    v_pk_mul_f32 v[94:95], v[94:95], v[78:79]
    buffer_load_dwordx4 v1, s[8:11], s43 offen offset:1024 sc1 lds
    v_pk_fma_f32 v[208:209], v[208:209], v[194:195], v[194:195] op_sel_hi:[1,0,0]
    v_pk_fma_f32 v[210:211], v[210:211], v[194:195], v[194:195] op_sel_hi:[1,0,0]
    v_pk_fma_f32 v[212:213], v[212:213], v[194:195], v[194:195] op_sel_hi:[1,0,0]
    v_pk_fma_f32 v[214:215], v[214:215], v[194:195], v[194:195] op_sel_hi:[1,0,0]
    v_rcp_f32 v208, v208
    v_rcp_f32 v209, v209
    v_rcp_f32 v210, v210
    v_rcp_f32 v211, v211
    v_rcp_f32 v212, v212
    v_rcp_f32 v213, v213
    v_rcp_f32 v214, v214
    v_rcp_f32 v215, v215
    v_pk_mul_f32 v[88:89], v[88:89], v[208:209]
    v_pk_mul_f32 v[90:91], v[90:91], v[210:211]
    v_pk_mul_f32 v[92:93], v[92:93], v[212:213]
    v_pk_mul_f32 v[94:95], v[94:95], v[214:215]
    v_cvt_pk_bf16_f32 v72, v88, v89
    v_cvt_pk_bf16_f32 v73, v90, v91
    v_cvt_pk_bf16_f32 v74, v92, v93
    v_cvt_pk_bf16_f32 v75, v94, v95
    buffer_store_dwordx4 v[72:75], v8, s[8:11], s53 offen offset:512 sc1
    s_add_u32 s53, s53, 16384
    s_waitcnt lgkmcnt(2)
    v_mfma_f32_32x32x16_bf16 v[112:127], v[32:35], a[0:3], v[112:127]
    ds_read_b128 v[32:35], v2 offset:28672
    buffer_atomic_swap v4, v7, s[8:11], s55 offen offset:0 sc1
    s_add_u32 s55, s55, 16384
    v_mfma_f32_32x32x16_bf16 v[112:127], v[36:39], a[4:7], v[112:127]
L_pg1_3:
    s_cbranch_execz L_wr1
    ds_read_b128 v[36:39], v2 offset:29696
    buffer_load_dwordx4 v1, s[8:11], s43 offen offset:2048 sc1 lds
    s_waitcnt lgkmcnt(2)
    v_mfma_f32_32x32x16_bf16 v[112:127], v[40:43], a[8:11], v[112:127]
    ds_read_b128 v[40:43], v2 offset:30720
    v_mfma_f32_32x32x16_bf16 v[112:127], v[44:47], a[12:15], v[112:127]
    ds_read_b128 v[44:47], v2 offset:31744
    buffer_load_dwordx4 v1, s[8:11], s43 offen offset:3072 sc1 lds
    s_waitcnt lgkmcnt(2)
    v_mfma_f32_32x32x16_bf16 v[112:127], v[32:35], a[16:19], v[112:127]
    s_waitcnt vmcnt(27)
    s_barrier
    ds_read_b128 v[32:35], v2 offset:32768
    v_mfma_f32_32x32x16_bf16 v[112:127], v[36:39], a[20:23], v[112:127]
    ds_read_b128 v[36:39], v2 offset:33792
    s_add_u32 m0, s39, 65536
    s_add_u32 s49, s49, 16384
    buffer_load_dwordx4 v1, s[8:11], s49 offen offset:0 sc1 lds
    s_waitcnt lgkmcnt(2)
    v_mfma_f32_32x32x16_bf16 v[112:127], v[40:43], a[24:27], v[112:127]
    ds_read_b128 v[40:43], v2 offset:34816
    v_mfma_f32_32x32x16_bf16 v[112:127], v[44:47], a[28:31], v[112:127]
    ds_read_b128 v[44:47], v2 offset:35840
    buffer_load_dwordx4 v1, s[8:11], s49 offen offset:1024 sc1 lds
    s_waitcnt lgkmcnt(2)
    v_mfma_f32_32x32x16_bf16 v[112:127], v[32:35], a[32:35], v[112:127]
    ds_read_b128 v[32:35], v2 offset:36864
    v_mfma_f32_32x32x16_bf16 v[112:127], v[36:39], a[36:39], v[112:127]
    ds_read_b128 v[36:39], v2 offset:37888
    s_waitcnt lgkmcnt(2)
    v_mfma_f32_32x32x16_bf16 v[112:127], v[40:43], a[40:43], v[112:127]
    ds_read_b128 v[40:43], v2 offset:38912
    buffer_load_dwordx4 v1, s[8:11], s49 offen offset:2048 sc1 lds
    v_mfma_f32_32x32x16_bf16 v[112:127], v[44:47], a[44:47], v[112:127]
    ds_read_b128 v[44:47], v2 offset:39936
    s_waitcnt lgkmcnt(2)
    v_mfma_f32_32x32x16_bf16 v[112:127], v[32:35], a[48:51], v[112:127]
    ds_read_b128 v[32:35], v2 offset:40960
    buffer_load_dwordx4 v1, s[8:11], s49 offen offset:3072 sc1 lds
    v_mfma_f32_32x32x16_bf16 v[112:127], v[36:39], a[52:55], v[112:127]
    ds_read_b128 v[36:39], v2 offset:41984
    s_waitcnt lgkmcnt(2)
    v_mfma_f32_32x32x16_bf16 v[112:127], v[40:43], a[56:59], v[112:127]
    ds_read_b128 v[40:43], v2 offset:43008
    v_mfma_f32_32x32x16_bf16 v[112:127], v[44:47], a[60:63], v[112:127]
    ds_read_b128 v[44:47], v2 offset:44032
    s_waitcnt lgkmcnt(2)
    v_mfma_f32_32x32x16_bf16 v[112:127], v[32:35], a[64:67], v[112:127]
    ds_read_b128 v[32:35], v2 offset:45056
    v_mfma_f32_32x32x16_bf16 v[112:127], v[36:39], a[68:71], v[112:127]
    ds_read_b128 v[36:39], v2 offset:46080
    s_waitcnt lgkmcnt(2)
    v_mfma_f32_32x32x16_bf16 v[112:127], v[40:43], a[72:75], v[112:127]
    ds_read_b128 v[40:43], v2 offset:47104
    v_mfma_f32_32x32x16_bf16 v[112:127], v[44:47], a[76:79], v[112:127]
    ds_read_b128 v[44:47], v2 offset:48128
    s_waitcnt lgkmcnt(2)
    v_mfma_f32_32x32x16_bf16 v[112:127], v[32:35], a[80:83], v[112:127]
    s_waitcnt vmcnt(27)
    s_barrier
    ds_read_b128 v[32:35], v2 offset:49152
    s_add_u32 m0, s39, 81920
    s_add_u32 s49, s49, 16384
    buffer_load_dwordx4 v1, s[8:11], s49 offen offset:0 sc1 lds
    v_mfma_f32_32x32x16_bf16 v[112:127], v[36:39], a[84:87], v[112:127]
    ds_read_b128 v[36:39], v2 offset:50176
    s_waitcnt lgkmcnt(2)
    v_mfma_f32_32x32x16_bf16 v[112:127], v[40:43], a[88:91], v[112:127]
    ds_read_b128 v[40:43], v2 offset:51200
    buffer_load_dwordx4 v1, s[8:11], s49 offen offset:1024 sc1 lds
    v_mfma_f32_32x32x16_bf16 v[112:127], v[44:47], a[92:95], v[112:127]
    ds_read_b128 v[44:47], v2 offset:52224
    s_waitcnt lgkmcnt(2)
    v_mfma_f32_32x32x16_bf16 v[112:127], v[32:35], a[96:99], v[112:127]
    ds_read_b128 v[32:35], v2 offset:53248
    buffer_load_dwordx4 v1, s[8:11], s49 offen offset:2048 sc1 lds
    v_mfma_f32_32x32x16_bf16 v[112:127], v[36:39], a[100:103], v[112:127]
    ds_read_b128 v[36:39], v2 offset:54272
    s_waitcnt lgkmcnt(2)
    v_mfma_f32_32x32x16_bf16 v[112:127], v[40:43], a[104:107], v[112:127]
    ds_read_b128 v[40:43], v2 offset:55296
    buffer_load_dwordx4 v1, s[8:11], s49 offen offset:3072 sc1 lds
    v_mfma_f32_32x32x16_bf16 v[112:127], v[44:47], a[108:111], v[112:127]
    ds_read_b128 v[44:47], v2 offset:56320
    s_waitcnt lgkmcnt(2)
    v_mfma_f32_32x32x16_bf16 v[112:127], v[32:35], a[112:115], v[112:127]
    ds_read_b128 v[32:35], v2 offset:57344
    v_mfma_f32_32x32x16_bf16 v[112:127], v[36:39], a[116:119], v[112:127]
    ds_read_b128 v[36:39], v2 offset:58368
    s_mov_b64 exec, 65535
    v_mov_b32 v21, 0
    buffer_atomic_or v21, v252, s[8:11], s57 offen sc0 sc1
    s_mov_b64 exec, -1
    s_waitcnt lgkmcnt(2)
    v_mfma_f32_32x32x16_bf16 v[112:127], v[40:43], a[120:123], v[112:127]
    ds_read_b128 v[40:43], v2 offset:59392
    v_mfma_f32_32x32x16_bf16 v[112:127], v[44:47], a[124:127], v[112:127]
    ds_read_b128 v[44:47], v2 offset:60416
    s_waitcnt lgkmcnt(2)
    v_mfma_f32_32x32x16_bf16 v[112:127], v[32:35], a[128:131], v[112:127]
    ds_read_b128 v[32:35], v2 offset:61440
    v_mfma_f32_32x32x16_bf16 v[112:127], v[36:39], a[132:135], v[112:127]
    ds_read_b128 v[36:39], v2 offset:62464
    s_waitcnt lgkmcnt(2)
    v_mfma_f32_32x32x16_bf16 v[112:127], v[40:43], a[136:139], v[112:127]
    ds_read_b128 v[40:43], v2 offset:63488
    v_mfma_f32_32x32x16_bf16 v[112:127], v[44:47], a[140:143], v[112:127]
    ds_read_b128 v[44:47], v2 offset:64512
    s_waitcnt lgkmcnt(2)
    v_mfma_f32_32x32x16_bf16 v[112:127], v[32:35], a[144:147], v[112:127]
    s_waitcnt vmcnt(28)
    s_barrier
    ds_read_b128 v[32:35], v3 offset:0
    s_add_u32 m0, s39, 98304
    s_add_u32 s49, s49, 16384
    buffer_load_dwordx4 v1, s[8:11], s49 offen offset:0 sc1 lds
    v_mfma_f32_32x32x16_bf16 v[112:127], v[36:39], a[148:151], v[112:127]
    ds_read_b128 v[36:39], v3 offset:1024
    s_waitcnt lgkmcnt(2)
    v_mfma_f32_32x32x16_bf16 v[112:127], v[40:43], a[152:155], v[112:127]
    ds_read_b128 v[40:43], v3 offset:2048
    buffer_load_dwordx4 v1, s[8:11], s49 offen offset:1024 sc1 lds
    v_mfma_f32_32x32x16_bf16 v[112:127], v[44:47], a[156:159], v[112:127]
    ds_read_b128 v[44:47], v3 offset:3072
    v_mfma_f32_32x32x16_bf16 v[128:143], v[176:179], v[184:187], 0
    v_mfma_f32_32x32x16_bf16 v[144:159], v[180:183], v[184:187], 0
    buffer_load_dwordx4 v1, s[8:11], s49 offen offset:2048 sc1 lds
    buffer_load_dwordx4 v1, s[8:11], s49 offen offset:3072 sc1 lds
    v_pk_mul_f32 v[200:201], v[96:97], v[96:97]
    v_pk_mul_f32 v[202:203], v[98:99], v[98:99]
    v_pk_mul_f32 v[204:205], v[100:101], v[100:101]
    v_pk_mul_f32 v[206:207], v[102:103], v[102:103]
    v_pk_fma_f32 v[200:201], v[200:201], v[192:193], v[190:191] op_sel_hi:[1,0,0]
    v_pk_fma_f32 v[202:203], v[202:203], v[192:193], v[190:191] op_sel_hi:[1,0,0]
    v_pk_fma_f32 v[204:205], v[204:205], v[192:193], v[190:191] op_sel_hi:[1,0,0]
    v_pk_fma_f32 v[206:207], v[206:207], v[192:193], v[190:191] op_sel_hi:[1,0,0]
    v_pk_mul_f32 v[200:201], v[200:201], v[96:97]
    v_pk_mul_f32 v[202:203], v[202:203], v[98:99]
    v_pk_mul_f32 v[204:205], v[204:205], v[100:101]
    v_pk_mul_f32 v[206:207], v[206:207], v[102:103]
    v_exp_f32 v200, v200
    v_exp_f32 v201, v201
    v_exp_f32 v202, v202
    v_exp_f32 v203, v203
    v_exp_f32 v204, v204
    v_exp_f32 v205, v205
    v_exp_f32 v206, v206
    v_exp_f32 v207, v207
    v_pk_mul_f32 v[112:113], v[112:113], v[96:97]
    v_pk_mul_f32 v[114:115], v[114:115], v[98:99]
    v_pk_mul_f32 v[116:117], v[116:117], v[100:101]
    v_pk_mul_f32 v[118:119], v[118:119], v[102:103]
    v_pk_fma_f32 v[200:201], v[200:201], v[194:195], v[194:195] op_sel_hi:[1,0,0]
    v_pk_fma_f32 v[202:203], v[202:203], v[194:195], v[194:195] op_sel_hi:[1,0,0]
    v_pk_fma_f32 v[204:205], v[204:205], v[194:195], v[194:195] op_sel_hi:[1,0,0]
    v_pk_fma_f32 v[206:207], v[206:207], v[194:195], v[194:195] op_sel_hi:[1,0,0]
    v_rcp_f32 v200, v200
    v_rcp_f32 v201, v201
    v_rcp_f32 v202, v202
    v_rcp_f32 v203, v203
    v_rcp_f32 v204, v204
    v_rcp_f32 v205, v205
    v_rcp_f32 v206, v206
    v_rcp_f32 v207, v207
    v_pk_mul_f32 v[112:113], v[112:113], v[200:201]
    v_pk_mul_f32 v[114:115], v[114:115], v[202:203]
    v_pk_mul_f32 v[116:117], v[116:117], v[204:205]
    v_pk_mul_f32 v[118:119], v[118:119], v[206:207]
    v_cvt_pk_bf16_f32 v96, v112, v113
    v_cvt_pk_bf16_f32 v97, v114, v115
    v_cvt_pk_bf16_f32 v98, v116, v117
    v_cvt_pk_bf16_f32 v99, v118, v119
    buffer_store_dwordx4 v[96:99], v8, s[8:11], s53 offen offset:0 sc1
    v_pk_mul_f32 v[208:209], v[104:105], v[104:105]
    v_pk_mul_f32 v[210:211], v[106:107], v[106:107]
    v_pk_mul_f32 v[212:213], v[108:109], v[108:109]
    v_pk_mul_f32 v[214:215], v[110:111], v[110:111]
    v_pk_fma_f32 v[208:209], v[208:209], v[192:193], v[190:191] op_sel_hi:[1,0,0]
    v_pk_fma_f32 v[210:211], v[210:211], v[192:193], v[190:191] op_sel_hi:[1,0,0]
    v_pk_fma_f32 v[212:213], v[212:213], v[192:193], v[190:191] op_sel_hi:[1,0,0]
    v_pk_fma_f32 v[214:215], v[214:215], v[192:193], v[190:191] op_sel_hi:[1,0,0]
    v_pk_mul_f32 v[208:209], v[208:209], v[104:105]
    v_pk_mul_f32 v[210:211], v[210:211], v[106:107]
    v_pk_mul_f32 v[212:213], v[212:213], v[108:109]
    v_pk_mul_f32 v[214:215], v[214:215], v[110:111]
    v_exp_f32 v208, v208
    v_exp_f32 v209, v209
    v_exp_f32 v210, v210
    v_exp_f32 v211, v211
    v_exp_f32 v212, v212
    v_exp_f32 v213, v213
    v_exp_f32 v214, v214
    v_exp_f32 v215, v215
    v_pk_mul_f32 v[120:121], v[120:121], v[104:105]
    v_pk_mul_f32 v[122:123], v[122:123], v[106:107]
    v_pk_mul_f32 v[124:125], v[124:125], v[108:109]
    v_pk_mul_f32 v[126:127], v[126:127], v[110:111]
    s_waitcnt vmcnt(5)
    s_mov_b64 exec, 65535
    v_cmp_ne_u32 vcc, s6, v21
    s_mov_b64 exec, -1
    s_cbranch_vccnz cold_58
coldr_59:
    s_sub_u32 s63, s55, 16384
    s_waitcnt vmcnt(17)
    buffer_atomic_swap v4, v7, s[8:11], s63 offen offset:128 sc1
    v_pk_fma_f32 v[208:209], v[208:209], v[194:195], v[194:195] op_sel_hi:[1,0,0]
    v_pk_fma_f32 v[210:211], v[210:211], v[194:195], v[194:195] op_sel_hi:[1,0,0]
    v_pk_fma_f32 v[212:213], v[212:213], v[194:195], v[194:195] op_sel_hi:[1,0,0]
    v_pk_fma_f32 v[214:215], v[214:215], v[194:195], v[194:195] op_sel_hi:[1,0,0]
    v_rcp_f32 v208, v208
    v_rcp_f32 v209, v209
    v_rcp_f32 v210, v210
    v_rcp_f32 v211, v211
    v_rcp_f32 v212, v212
    v_rcp_f32 v213, v213
    v_rcp_f32 v214, v214
    v_rcp_f32 v215, v215
    v_pk_mul_f32 v[120:121], v[120:121], v[208:209]
    v_pk_mul_f32 v[122:123], v[122:123], v[210:211]
    v_pk_mul_f32 v[124:125], v[124:125], v[212:213]
    v_pk_mul_f32 v[126:127], v[126:127], v[214:215]
    v_cvt_pk_bf16_f32 v104, v120, v121
    v_cvt_pk_bf16_f32 v105, v122, v123
    v_cvt_pk_bf16_f32 v106, v124, v125
    v_cvt_pk_bf16_f32 v107, v126, v127
    buffer_store_dwordx4 v[104:107], v8, s[8:11], s53 offen offset:512 sc1
    s_add_u32 s53, s53, 16384
    s_waitcnt lgkmcnt(2)
    v_mfma_f32_32x32x16_bf16 v[128:143], v[32:35], a[0:3], v[128:143]
    ds_read_b128 v[32:35], v3 offset:4096
    buffer_atomic_swap v4, v7, s[8:11], s55 offen offset:0 sc1
    s_add_u32 s55, s55, 16384
    v_mfma_f32_32x32x16_bf16 v[144:159], v[36:39], a[0:3], v[144:159]
    ds_read_b128 v[36:39], v3 offset:5120
    s_add_u32 s59, s59, 4096
    buffer_load_dwordx4 a[160:163], v10, s[8:11], s59 offen offset:0 sc1
    s_waitcnt lgkmcnt(2)
    v_mfma_f32_32x32x16_bf16 v[128:143], v[40:43], a[4:7], v[128:143]
    ds_read_b128 v[40:43], v3 offset:6144
    v_mfma_f32_32x32x16_bf16 v[144:159], v[44:47], a[4:7], v[144:159]
    ds_read_b128 v[44:47], v3 offset:7168
    buffer_load_dwordx4 a[164:167], v11, s[8:11], s59 offen offset:0 sc1
    s_waitcnt lgkmcnt(2)
    v_mfma_f32_32x32x16_bf16 v[128:143], v[32:35], a[8:11], v[128:143]
    ds_read_b128 v[32:35], v3 offset:8192
    v_mfma_f32_32x32x16_bf16 v[144:159], v[36:39], a[8:11], v[144:159]
    ds_read_b128 v[36:39], v3 offset:9216
    buffer_load_dwordx4 a[168:171], v10, s[8:11], s59 offen offset:2048 sc1
    s_waitcnt lgkmcnt(2)
    v_mfma_f32_32x32x16_bf16 v[128:143], v[40:43], a[12:15], v[128:143]
    ds_read_b128 v[40:43], v3 offset:10240
    v_mfma_f32_32x32x16_bf16 v[144:159], v[44:47], a[12:15], v[144:159]
    ds_read_b128 v[44:47], v3 offset:11264
    buffer_load_dwordx4 a[172:175], v11, s[8:11], s59 offen offset:2048 sc1
    s_waitcnt lgkmcnt(2)
    v_mfma_f32_32x32x16_bf16 v[128:143], v[32:35], a[16:19], v[128:143]
    ds_read_b128 v[32:35], v3 offset:12288
    v_mfma_f32_32x32x16_bf16 v[144:159], v[36:39], a[16:19], v[144:159]
    ds_read_b128 v[36:39], v3 offset:13312
    s_waitcnt lgkmcnt(2)
    v_mfma_f32_32x32x16_bf16 v[128:143], v[40:43], a[20:23], v[128:143]
    ds_read_b128 v[40:43], v3 offset:14336
    s_add_u32 s59, s59, 4096
    buffer_load_dwordx4 a[176:179], v10, s[8:11], s59 offen offset:0 sc1
    v_mfma_f32_32x32x16_bf16 v[144:159], v[44:47], a[20:23], v[144:159]
    ds_read_b128 v[44:47], v3 offset:15360
    s_waitcnt lgkmcnt(2)
    v_mfma_f32_32x32x16_bf16 v[128:143], v[32:35], a[24:27], v[128:143]
    s_waitcnt vmcnt(37)
    s_barrier
    ds_read_b128 v[32:35], v1 offset:0
    buffer_load_dwordx4 a[180:183], v11, s[8:11], s59 offen offset:0 sc1
    v_mfma_f32_32x32x16_bf16 v[144:159], v[36:39], a[24:27], v[144:159]
    ds_read_b128 v[36:39], v1 offset:1024
    s_waitcnt lgkmcnt(2)
    v_mfma_f32_32x32x16_bf16 v[128:143], v[40:43], a[28:31], v[128:143]
    ds_read_b128 v[40:43], v1 offset:2048
    s_add_u32 m0, s39, 114688
    s_add_u32 s49, s49, 16384
    buffer_load_dwordx4 v1, s[8:11], s49 offen offset:0 sc1 lds
    v_mfma_f32_32x32x16_bf16 v[144:159], v[44:47], a[28:31], v[144:159]
    ds_read_b128 v[44:47], v1 offset:3072
    s_waitcnt lgkmcnt(2)
    v_mfma_f32_32x32x16_bf16 v[128:143], v[32:35], a[32:35], v[128:143]
    ds_read_b128 v[32:35], v1 offset:4096
    buffer_load_dwordx4 a[184:187], v10, s[8:11], s59 offen offset:2048 sc1
    v_mfma_f32_32x32x16_bf16 v[144:159], v[36:39], a[32:35], v[144:159]
    ds_read_b128 v[36:39], v1 offset:5120
    s_waitcnt lgkmcnt(2)
    v_mfma_f32_32x32x16_bf16 v[128:143], v[40:43], a[36:39], v[128:143]
    ds_read_b128 v[40:43], v1 offset:6144
    v_mfma_f32_32x32x16_bf16 v[144:159], v[44:47], a[36:39], v[144:159]
    ds_read_b128 v[44:47], v1 offset:7168
    buffer_load_dwordx4 v1, s[8:11], s49 offen offset:1024 sc1 lds
    s_waitcnt lgkmcnt(2)
    v_mfma_f32_32x32x16_bf16 v[128:143], v[32:35], a[40:43], v[128:143]
    ds_read_b128 v[32:35], v1 offset:8192
    v_mfma_f32_32x32x16_bf16 v[144:159], v[36:39], a[40:43], v[144:159]
    ds_read_b128 v[36:39], v1 offset:9216
    buffer_load_dwordx4 a[188:191], v11, s[8:11], s59 offen offset:2048 sc1
    s_waitcnt lgkmcnt(2)
    v_mfma_f32_32x32x16_bf16 v[128:143], v[40:43], a[44:47], v[128:143]
    ds_read_b128 v[40:43], v1 offset:10240
    v_mfma_f32_32x32x16_bf16 v[144:159], v[44:47], a[44:47], v[144:159]
    ds_read_b128 v[44:47], v1 offset:11264
    buffer_load_dwordx4 v1, s[8:11], s49 offen offset:2048 sc1 lds
    s_waitcnt lgkmcnt(2)
    v_mfma_f32_32x32x16_bf16 v[128:143], v[32:35], a[48:51], v[128:143]
    ds_read_b128 v[32:35], v1 offset:12288
    v_mfma_f32_32x32x16_bf16 v[144:159], v[36:39], a[48:51], v[144:159]
    ds_read_b128 v[36:39], v1 offset:13312
    buffer_load_dwordx4 v1, s[8:11], s49 offen offset:3072 sc1 lds
    s_waitcnt lgkmcnt(2)
    v_mfma_f32_32x32x16_bf16 v[128:143], v[40:43], a[52:55], v[128:143]
    ds_read_b128 v[40:43], v1 offset:14336
    v_mfma_f32_32x32x16_bf16 v[144:159], v[44:47], a[52:55], v[144:159]
    ds_read_b128 v[44:47], v1 offset:15360
    s_waitcnt lgkmcnt(2)
    v_mfma_f32_32x32x16_bf16 v[128:143], v[32:35], a[56:59], v[128:143]
    s_waitcnt vmcnt(40)
    s_barrier
    ds_read_b128 v[32:35], v1 offset:16384
    s_add_u32 s59, s59, 4096
    buffer_load_dwordx4 a[192:195], v10, s[8:11], s59 offen offset:0 sc1
    v_mfma_f32_32x32x16_bf16 v[144:159], v[36:39], a[56:59], v[144:159]
    ds_read_b128 v[36:39], v1 offset:17408
    s_add_u32 s57, s57, 16384
    s_mov_b64 exec, 65535
    v_mov_b32 v22, 0
    buffer_atomic_or v22, v252, s[8:11], s57 offen sc0 sc1
    s_mov_b64 exec, -1
    s_waitcnt lgkmcnt(2)
    v_mfma_f32_32x32x16_bf16 v[128:143], v[40:43], a[60:63], v[128:143]
    ds_read_b128 v[40:43], v1 offset:18432
    s_add_u32 m0, s39, 131072
    s_add_u32 s49, s49, 16384
    buffer_load_dwordx4 v1, s[8:11], s49 offen offset:0 sc1 lds
    v_mfma_f32_32x32x16_bf16 v[144:159], v[44:47], a[60:63], v[144:159]
    ds_read_b128 v[44:47], v1 offset:19456
    s_waitcnt lgkmcnt(2)
    v_mfma_f32_32x32x16_bf16 v[128:143], v[32:35], a[64:67], v[128:143]
    ds_read_b128 v[32:35], v1 offset:20480
    buffer_load_dwordx4 a[196:199], v11, s[8:11], s59 offen offset:0 sc1
    v_mfma_f32_32x32x16_bf16 v[144:159], v[36:39], a[64:67], v[144:159]
    ds_read_b128 v[36:39], v1 offset:21504
    s_waitcnt lgkmcnt(2)
    v_mfma_f32_32x32x16_bf16 v[128:143], v[40:43], a[68:71], v[128:143]
    ds_read_b128 v[40:43], v1 offset:22528
    buffer_load_dwordx4 v1, s[8:11], s49 offen offset:1024 sc1 lds
    v_mfma_f32_32x32x16_bf16 v[144:159], v[44:47], a[68:71], v[144:159]
    ds_read_b128 v[44:47], v1 offset:23552
    s_waitcnt lgkmcnt(2)
    v_mfma_f32_32x32x16_bf16 v[128:143], v[32:35], a[72:75], v[128:143]
    ds_read_b128 v[32:35], v1 offset:24576
    v_mfma_f32_32x32x16_bf16 v[144:159], v[36:39], a[72:75], v[144:159]
    ds_read_b128 v[36:39], v1 offset:25600
    buffer_load_dwordx4 a[200:203], v10, s[8:11], s59 offen offset:2048 sc1
    s_waitcnt lgkmcnt(2)
    v_mfma_f32_32x32x16_bf16 v[128:143], v[40:43], a[76:79], v[128:143]
    ds_read_b128 v[40:43], v1 offset:26624
    v_mfma_f32_32x32x16_bf16 v[144:159], v[44:47], a[76:79], v[144:159]
    ds_read_b128 v[44:47], v1 offset:27648
    buffer_load_dwordx4 v1, s[8:11], s49 offen offset:2048 sc1 lds
    s_waitcnt lgkmcnt(2)
    v_mfma_f32_32x32x16_bf16 v[128:143], v[32:35], a[80:83], v[128:143]
    ds_read_b128 v[32:35], v1 offset:28672
    v_mfma_f32_32x32x16_bf16 v[144:159], v[36:39], a[80:83], v[144:159]
    ds_read_b128 v[36:39], v1 offset:29696
    buffer_load_dwordx4 a[204:207], v11, s[8:11], s59 offen offset:2048 sc1
    s_waitcnt lgkmcnt(2)
    v_mfma_f32_32x32x16_bf16 v[128:143], v[40:43], a[84:87], v[128:143]
    ds_read_b128 v[40:43], v1 offset:30720
    v_mfma_f32_32x32x16_bf16 v[144:159], v[44:47], a[84:87], v[144:159]
    ds_read_b128 v[44:47], v1 offset:31744
    buffer_load_dwordx4 v1, s[8:11], s49 offen offset:3072 sc1 lds
    s_waitcnt lgkmcnt(2)
    v_mfma_f32_32x32x16_bf16 v[128:143], v[32:35], a[88:91], v[128:143]
    s_waitcnt vmcnt(44)
    s_barrier
    ds_read_b128 v[32:35], v1 offset:32768
    v_mfma_f32_32x32x16_bf16 v[144:159], v[36:39], a[88:91], v[144:159]
    ds_read_b128 v[36:39], v1 offset:33792
    s_waitcnt lgkmcnt(2)
    v_mfma_f32_32x32x16_bf16 v[128:143], v[40:43], a[92:95], v[128:143]
    ds_read_b128 v[40:43], v1 offset:34816
    s_add_u32 m0, s39, 0
    s_add_u32 s49, s49, 16384
    buffer_load_dwordx4 v1, s[8:11], s49 offen offset:0 sc1 lds
    v_mfma_f32_32x32x16_bf16 v[144:159], v[44:47], a[92:95], v[144:159]
    ds_read_b128 v[44:47], v1 offset:35840
    s_waitcnt lgkmcnt(2)
    v_mfma_f32_32x32x16_bf16 v[128:143], v[32:35], a[96:99], v[128:143]
    ds_read_b128 v[32:35], v1 offset:36864
    s_add_u32 s59, s59, 4096
    buffer_load_dwordx4 a[208:211], v10, s[8:11], s59 offen offset:0 sc1
    v_mfma_f32_32x32x16_bf16 v[144:159], v[36:39], a[96:99], v[144:159]
    ds_read_b128 v[36:39], v1 offset:37888
    s_waitcnt lgkmcnt(2)
    v_mfma_f32_32x32x16_bf16 v[128:143], v[40:43], a[100:103], v[128:143]
    ds_read_b128 v[40:43], v1 offset:38912
    buffer_load_dwordx4 v1, s[8:11], s49 offen offset:1024 sc1 lds
    v_mfma_f32_32x32x16_bf16 v[144:159], v[44:47], a[100:103], v[144:159]
    ds_read_b128 v[44:47], v1 offset:39936
    s_waitcnt lgkmcnt(2)
    v_mfma_f32_32x32x16_bf16 v[128:143], v[32:35], a[104:107], v[128:143]
    ds_read_b128 v[32:35], v1 offset:40960
    buffer_load_dwordx4 a[212:215], v11, s[8:11], s59 offen offset:0 sc1
    v_mfma_f32_32x32x16_bf16 v[144:159], v[36:39], a[104:107], v[144:159]
    ds_read_b128 v[36:39], v1 offset:41984
    s_waitcnt lgkmcnt(2)
    v_mfma_f32_32x32x16_bf16 v[128:143], v[40:43], a[108:111], v[128:143]
    ds_read_b128 v[40:43], v1 offset:43008
    v_mfma_f32_32x32x16_bf16 v[144:159], v[44:47], a[108:111], v[144:159]
    ds_read_b128 v[44:47], v1 offset:44032
    buffer_load_dwordx4 v1, s[8:11], s49 offen offset:2048 sc1 lds
    s_waitcnt lgkmcnt(2)
    v_mfma_f32_32x32x16_bf16 v[128:143], v[32:35], a[112:115], v[128:143]
    ds_read_b128 v[32:35], v1 offset:45056
    v_mfma_f32_32x32x16_bf16 v[144:159], v[36:39], a[112:115], v[144:159]
    ds_read_b128 v[36:39], v1 offset:46080
    buffer_load_dwordx4 a[216:219], v10, s[8:11], s59 offen offset:2048 sc1
    s_waitcnt lgkmcnt(2)
    v_mfma_f32_32x32x16_bf16 v[128:143], v[40:43], a[116:119], v[128:143]
    ds_read_b128 v[40:43], v1 offset:47104
    v_mfma_f32_32x32x16_bf16 v[144:159], v[44:47], a[116:119], v[144:159]
    ds_read_b128 v[44:47], v1 offset:48128
    buffer_load_dwordx4 v1, s[8:11], s49 offen offset:3072 sc1 lds
    s_waitcnt lgkmcnt(2)
    v_mfma_f32_32x32x16_bf16 v[128:143], v[32:35], a[120:123], v[128:143]
    s_waitcnt vmcnt(45)
    s_barrier
    ds_read_b128 v[32:35], v1 offset:49152
    v_mfma_f32_32x32x16_bf16 v[144:159], v[36:39], a[120:123], v[144:159]
    ds_read_b128 v[36:39], v1 offset:50176
    buffer_load_dwordx4 a[220:223], v11, s[8:11], s59 offen offset:2048 sc1
    s_waitcnt lgkmcnt(2)
    v_mfma_f32_32x32x16_bf16 v[128:143], v[40:43], a[124:127], v[128:143]
    ds_read_b128 v[40:43], v1 offset:51200
    s_waitcnt vmcnt(15)
    s_mov_b64 exec, 65535
    v_cmp_ne_u32 vcc, s6, v22
    s_mov_b64 exec, -1
    s_cbranch_vccnz cold_62
coldr_63:
    s_sub_u32 s63, s55, 16384
    s_waitcnt vmcnt(30)
    buffer_atomic_swap v4, v7, s[8:11], s63 offen offset:128 sc1
    v_mfma_f32_32x32x16_bf16 v[144:159], v[44:47], a[124:127], v[144:159]
    ds_read_b128 v[44:47], v1 offset:52224
    s_waitcnt lgkmcnt(2)
    v_mfma_f32_32x32x16_bf16 v[128:143], v[32:35], a[128:131], v[128:143]
    ds_read_b128 v[32:35], v1 offset:53248
    s_add_u32 m0, s39, 16384
    s_add_u32 s49, s49, 16384
    buffer_load_dwordx4 v1, s[8:11], s49 offen offset:0 sc1 lds
    v_mfma_f32_32x32x16_bf16 v[144:159], v[36:39], a[128:131], v[144:159]
    ds_read_b128 v[36:39], v1 offset:54272
    s_waitcnt lgkmcnt(2)
    v_mfma_f32_32x32x16_bf16 v[128:143], v[40:43], a[132:135], v[128:143]
    ds_read_b128 v[40:43], v1 offset:55296
    buffer_load_dwordx4 v1, s[8:11], s49 offen offset:1024 sc1 lds
    v_mfma_f32_32x32x16_bf16 v[144:159], v[44:47], a[132:135], v[144:159]
    ds_read_b128 v[44:47], v1 offset:56320
    s_waitcnt lgkmcnt(2)
    v_mfma_f32_32x32x16_bf16 v[128:143], v[32:35], a[136:139], v[128:143]
    ds_read_b128 v[32:35], v1 offset:57344
    s_add_u32 s59, s59, 4096
    buffer_load_dwordx4 a[224:227], v10, s[8:11], s59 offen offset:0 sc1
    v_mfma_f32_32x32x16_bf16 v[144:159], v[36:39], a[136:139], v[144:159]
    ds_read_b128 v[36:39], v1 offset:58368
    s_waitcnt lgkmcnt(2)
    v_mfma_f32_32x32x16_bf16 v[128:143], v[40:43], a[140:143], v[128:143]
    ds_read_b128 v[40:43], v1 offset:59392
    buffer_load_dwordx4 v1, s[8:11], s49 offen offset:2048 sc1 lds
    v_mfma_f32_32x32x16_bf16 v[144:159], v[44:47], a[140:143], v[144:159]
    ds_read_b128 v[44:47], v1 offset:60416
    s_waitcnt lgkmcnt(2)
    v_mfma_f32_32x32x16_bf16 v[128:143], v[32:35], a[144:147], v[128:143]
    ds_read_b128 v[32:35], v1 offset:61440
    v_mfma_f32_32x32x16_bf16 v[144:159], v[36:39], a[144:147], v[144:159]
    ds_read_b128 v[36:39], v1 offset:62464
    buffer_load_dwordx4 a[228:231], v11, s[8:11], s59 offen offset:0 sc1
    s_waitcnt lgkmcnt(2)
    v_mfma_f32_32x32x16_bf16 v[128:143], v[40:43], a[148:151], v[128:143]
    ds_read_b128 v[40:43], v1 offset:63488
    v_mfma_f32_32x32x16_bf16 v[144:159], v[44:47], a[148:151], v[144:159]
    ds_read_b128 v[44:47], v1 offset:64512
    buffer_load_dwordx4 v1, s[8:11], s49 offen offset:3072 sc1 lds
    s_waitcnt lgkmcnt(2)
    v_mfma_f32_32x32x16_bf16 v[128:143], v[32:35], a[152:155], v[128:143]
    v_mfma_f32_32x32x16_bf16 v[144:159], v[36:39], a[152:155], v[144:159]
    buffer_load_dwordx4 a[232:235], v10, s[8:11], s59 offen offset:2048 sc1
    s_waitcnt lgkmcnt(0)
    v_mfma_f32_32x32x16_bf16 v[128:143], v[40:43], a[156:159], v[128:143]
    v_mfma_f32_32x32x16_bf16 v[144:159], v[44:47], a[156:159], v[144:159]
    buffer_load_dwordx4 a[236:239], v11, s[8:11], s59 offen offset:2048 sc1
    s_waitcnt vmcnt(51)
    s_barrier
    ds_read_b128 v[108:111], v218 offset:3840
    ds_read_b128 v[112:115], v218 offset:3904
    ds_read_b64 v[116:117], v219 offset:3968
    s_add_u32 m0, s39, 32768
    s_add_u32 s49, s49, 16384
    buffer_load_dwordx4 v1, s[8:11], s49 offen offset:0 sc1 lds
    buffer_load_dwordx4 v1, s[8:11], s49 offen offset:1024 sc1 lds
    s_nop 0
    v_pk_mul_f32 v[200:201], v[128:129], v[128:129]
    v_pk_mul_f32 v[202:203], v[130:131], v[130:131]
    v_pk_mul_f32 v[204:205], v[132:133], v[132:133]
    v_pk_mul_f32 v[206:207], v[134:135], v[134:135]
    v_pk_fma_f32 v[200:201], v[200:201], v[192:193], v[190:191] op_sel_hi:[1,0,0]
    v_pk_fma_f32 v[202:203], v[202:203], v[192:193], v[190:191] op_sel_hi:[1,0,0]
    v_pk_fma_f32 v[204:205], v[204:205], v[192:193], v[190:191] op_sel_hi:[1,0,0]
    v_pk_fma_f32 v[206:207], v[206:207], v[192:193], v[190:191] op_sel_hi:[1,0,0]
    v_pk_mul_f32 v[200:201], v[200:201], v[128:129]
    v_pk_mul_f32 v[202:203], v[202:203], v[130:131]
    v_pk_mul_f32 v[204:205], v[204:205], v[132:133]
    v_pk_mul_f32 v[206:207], v[206:207], v[134:135]
    v_exp_f32 v200, v200
    v_exp_f32 v201, v201
    v_exp_f32 v202, v202
    v_exp_f32 v203, v203
    v_exp_f32 v204, v204
    v_exp_f32 v205, v205
    v_exp_f32 v206, v206
    v_exp_f32 v207, v207
    v_pk_mul_f32 v[144:145], v[144:145], v[128:129]
    v_pk_mul_f32 v[146:147], v[146:147], v[130:131]
    v_pk_mul_f32 v[148:149], v[148:149], v[132:133]
    v_pk_mul_f32 v[150:151], v[150:151], v[134:135]
    buffer_load_dwordx4 v1, s[8:11], s49 offen offset:2048 sc1 lds
    v_pk_fma_f32 v[200:201], v[200:201], v[194:195], v[194:195] op_sel_hi:[1,0,0]
    v_pk_fma_f32 v[202:203], v[202:203], v[194:195], v[194:195] op_sel_hi:[1,0,0]
    v_pk_fma_f32 v[204:205], v[204:205], v[194:195], v[194:195] op_sel_hi:[1,0,0]
    v_pk_fma_f32 v[206:207], v[206:207], v[194:195], v[194:195] op_sel_hi:[1,0,0]
    v_rcp_f32 v200, v200
    v_rcp_f32 v201, v201
    v_rcp_f32 v202, v202
    v_rcp_f32 v203, v203
    v_rcp_f32 v204, v204
    v_rcp_f32 v205, v205
    v_rcp_f32 v206, v206
    v_rcp_f32 v207, v207
    v_pk_mul_f32 v[144:145], v[144:145], v[200:201]
    v_pk_mul_f32 v[146:147], v[146:147], v[202:203]
    v_pk_mul_f32 v[148:149], v[148:149], v[204:205]
    v_pk_mul_f32 v[150:151], v[150:151], v[206:207]
    v_cvt_pk_bf16_f32 v128, v144, v145
    v_cvt_pk_bf16_f32 v129, v146, v147
    v_cvt_pk_bf16_f32 v130, v148, v149
    v_cvt_pk_bf16_f32 v131, v150, v151
    buffer_store_dwordx4 v[128:131], v8, s[8:11], s53 offen offset:0 sc1
    s_add_u32 s59, s59, 4096
    buffer_load_dwordx4 a[240:243], v10, s[8:11], s59 offen offset:0 sc1
    buffer_load_dwordx4 v1, s[8:11], s49 offen offset:3072 sc1 lds
    v_pk_mul_f32 v[208:209], v[136:137], v[136:137]
    v_pk_mul_f32 v[210:211], v[138:139], v[138:139]
    v_pk_mul_f32 v[212:213], v[140:141], v[140:141]
    v_pk_mul_f32 v[214:215], v[142:143], v[142:143]
    v_pk_fma_f32 v[208:209], v[208:209], v[192:193], v[190:191] op_sel_hi:[1,0,0]
    v_pk_fma_f32 v[210:211], v[210:211], v[192:193], v[190:191] op_sel_hi:[1,0,0]
    v_pk_fma_f32 v[212:213], v[212:213], v[192:193], v[190:191] op_sel_hi:[1,0,0]
    v_pk_fma_f32 v[214:215], v[214:215], v[192:193], v[190:191] op_sel_hi:[1,0,0]
    v_pk_mul_f32 v[208:209], v[208:209], v[136:137]
    v_pk_mul_f32 v[210:211], v[210:211], v[138:139]
    v_pk_mul_f32 v[212:213], v[212:213], v[140:141]
    v_pk_mul_f32 v[214:215], v[214:215], v[142:143]
    v_exp_f32 v208, v208
    v_exp_f32 v209, v209
    v_exp_f32 v210, v210
    v_exp_f32 v211, v211
    v_exp_f32 v212, v212
    v_exp_f32 v213, v213
    v_exp_f32 v214, v214
    v_exp_f32 v215, v215
    v_pk_mul_f32 v[152:153], v[152:153], v[136:137]
    v_pk_mul_f32 v[154:155], v[154:155], v[138:139]
    v_pk_mul_f32 v[156:157], v[156:157], v[140:141]
    v_pk_mul_f32 v[158:159], v[158:159], v[142:143]
    buffer_load_dwordx4 a[244:247], v11, s[8:11], s59 offen offset:0 sc1
    v_pk_fma_f32 v[208:209], v[208:209], v[194:195], v[194:195] op_sel_hi:[1,0,0]
    v_pk_fma_f32 v[210:211], v[210:211], v[194:195], v[194:195] op_sel_hi:[1,0,0]
    v_pk_fma_f32 v[212:213], v[212:213], v[194:195], v[194:195] op_sel_hi:[1,0,0]
    v_pk_fma_f32 v[214:215], v[214:215], v[194:195], v[194:195] op_sel_hi:[1,0,0]
    v_rcp_f32 v208, v208
    v_rcp_f32 v209, v209
    v_rcp_f32 v210, v210
    v_rcp_f32 v211, v211
L_pg2_0:
    s_cbranch_execz L_wr2
    v_rcp_f32 v212, v212
    v_rcp_f32 v213, v213
    v_rcp_f32 v214, v214
    v_rcp_f32 v215, v215
    v_pk_mul_f32 v[152:153], v[152:153], v[208:209]
    v_pk_mul_f32 v[154:155], v[154:155], v[210:211]
    v_pk_mul_f32 v[156:157], v[156:157], v[212:213]
    v_pk_mul_f32 v[158:159], v[158:159], v[214:215]
    v_cvt_pk_bf16_f32 v136, v152, v153
    v_cvt_pk_bf16_f32 v137, v154, v155
    v_cvt_pk_bf16_f32 v138, v156, v157
    v_cvt_pk_bf16_f32 v139, v158, v159
    buffer_store_dwordx4 v[136:139], v8, s[8:11], s53 offen offset:512 sc1
    s_add_u32 s53, s53, 16384
    ds_read_b128 v[24:27], v13 offset:0
    ds_read_b128 v[28:31], v13 offset:2048
    ds_read_b128 v[32:35], v13 offset:4096
    ds_read_b128 v[36:39], v13 offset:6144
    ds_read_b128 v[40:43], v13 offset:8192
    ds_read_b128 v[44:47], v13 offset:10240
    s_waitcnt lgkmcnt(6)
    v_lshlrev_b32 v160, 16, v108
    v_and_b32 v161, 0xffff0000, v108
    v_lshlrev_b32 v162, 16, v109
    v_and_b32 v163, 0xffff0000, v109
    v_lshlrev_b32 v164, 16, v110
    v_and_b32 v165, 0xffff0000, v110
    v_lshlrev_b32 v166, 16, v111
    v_and_b32 v167, 0xffff0000, v111
    v_lshlrev_b32 v168, 16, v112
    v_and_b32 v169, 0xffff0000, v112
    v_lshlrev_b32 v170, 16, v113
    v_and_b32 v171, 0xffff0000, v113
    v_lshlrev_b32 v172, 16, v114
    v_and_b32 v173, 0xffff0000, v114
    v_lshlrev_b32 v174, 16, v115
    v_and_b32 v175, 0xffff0000, v115
    v_lshlrev_b32 v176, 16, v116
    v_and_b32 v177, 0xffff0000, v116
    v_lshlrev_b32 v178, 16, v117
    v_and_b32 v179, 0xffff0000, v117
    s_waitcnt vmcnt(44) lgkmcnt(4)
    v_mfma_f32_16x16x32_bf16 v[64:67], v[24:27], a[160:163], 0
    buffer_atomic_swap v4, v7, s[8:11], s55 offen offset:0 sc1
    s_add_u32 s55, s55, 16384
    v_mfma_f32_16x16x32_bf16 v[84:87], v[24:27], a[164:167], 0
    ds_read_b128 v[24:27], v13 offset:12288
    v_mfma_f32_16x16x32_bf16 v[68:71], v[28:31], a[160:163], 0
    s_add_u32 m0, s39, 49152
    s_add_u32 s49, s49, 16384
    buffer_load_dwordx4 v1, s[8:11], s49 offen offset:0 sc1 lds
    v_mfma_f32_16x16x32_bf16 v[88:91], v[28:31], a[164:167], 0
    ds_read_b128 v[28:31], v13 offset:14336
    s_waitcnt lgkmcnt(3)
    v_mfma_f32_16x16x32_bf16 v[72:75], v[32:35], a[160:163], 0
    v_mfma_f32_16x16x32_bf16 v[92:95], v[32:35], a[164:167], 0
    s_waitcnt vmcnt(57)
    s_barrier
    ds_read_b128 v[32:35], v13 offset:16384
    v_mfma_f32_16x16x32_bf16 v[76:79], v[36:39], a[160:163], 0
    buffer_load_dwordx4 a[248:251], v10, s[8:11], s59 offen offset:2048 sc1
    v_mfma_f32_16x16x32_bf16 v[96:99], v[36:39], a[164:167], 0
    ds_read_b128 v[36:39], v13 offset:18432
    v_mfma_f32_16x16x32_bf16 v[80:83], v[40:43], a[160:163], 0
    v_mfma_f32_16x16x32_bf16 v[100:103], v[40:43], a[164:167], 0
    ds_read_b128 v[40:43], v13 offset:20480
    s_waitcnt vmcnt(45) lgkmcnt(4)
    v_mfma_f32_16x16x32_bf16 v[64:67], v[44:47], a[168:171], v[64:67]
    buffer_load_dwordx4 v1, s[8:11], s49 offen offset:1024 sc1 lds
    v_mfma_f32_16x16x32_bf16 v[84:87], v[44:47], a[172:175], v[84:87]
    ds_read_b128 v[44:47], v13 offset:22528
    v_mfma_f32_16x16x32_bf16 v[68:71], v[24:27], a[168:171], v[68:71]
    v_mfma_f32_16x16x32_bf16 v[88:91], v[24:27], a[172:175], v[88:91]
    ds_read_b128 v[24:27], v13 offset:24576
    s_waitcnt lgkmcnt(3)
    v_mfma_f32_16x16x32_bf16 v[72:75], v[28:31], a[168:171], v[72:75]
    buffer_load_dwordx4 a[252:255], v11, s[8:11], s59 offen offset:2048 sc1
    v_mfma_f32_16x16x32_bf16 v[92:95], v[28:31], a[172:175], v[92:95]
    ds_read_b128 v[28:31], v13 offset:26624
    v_mfma_f32_16x16x32_bf16 v[76:79], v[32:35], a[168:171], v[76:79]
    v_mfma_f32_16x16x32_bf16 v[96:99], v[32:35], a[172:175], v[96:99]
    ds_read_b128 v[32:35], v13 offset:28672
    v_mfma_f32_16x16x32_bf16 v[80:83], v[36:39], a[168:171], v[80:83]
    buffer_load_dwordx4 v1, s[8:11], s49 offen offset:2048 sc1 lds
    v_mfma_f32_16x16x32_bf16 v[100:103], v[36:39], a[172:175], v[100:103]
    ds_read_b128 v[36:39], v13 offset:30720
    s_waitcnt vmcnt(46) lgkmcnt(4)
    v_mfma_f32_16x16x32_bf16 v[64:67], v[40:43], a[176:179], v[64:67]
    v_mfma_f32_16x16x32_bf16 v[84:87], v[40:43], a[180:183], v[84:87]
    s_waitcnt vmcnt(56)
    s_barrier
    ds_read_b128 v[40:43], v13 offset:32768
    v_mfma_f32_16x16x32_bf16 v[68:71], v[44:47], a[176:179], v[68:71]
    buffer_load_dwordx4 v1, s[8:11], s49 offen offset:3072 sc1 lds
    v_mfma_f32_16x16x32_bf16 v[88:91], v[44:47], a[180:183], v[88:91]
    ds_read_b128 v[44:47], v13 offset:34816
    s_waitcnt lgkmcnt(3)
    v_mfma_f32_16x16x32_bf16 v[72:75], v[24:27], a[176:179], v[72:75]
    v_mfma_f32_16x16x32_bf16 v[92:95], v[24:27], a[180:183], v[92:95]
    ds_read_b128 v[24:27], v13 offset:36864
    v_mfma_f32_16x16x32_bf16 v[76:79], v[28:31], a[176:179], v[76:79]
    s_add_u32 s59, s59, 4096
    buffer_load_dwordx4 a[0:3], v10, s[8:11], s59 offen offset:0 sc1
    v_mfma_f32_16x16x32_bf16 v[96:99], v[28:31], a[180:183], v[96:99]
    ds_read_b128 v[28:31], v13 offset:38912
    v_mfma_f32_16x16x32_bf16 v[80:83], v[32:35], a[176:179], v[80:83]
    v_mfma_f32_16x16x32_bf16 v[100:103], v[32:35], a[180:183], v[100:103]
    ds_read_b128 v[32:35], v13 offset:40960
    s_waitcnt vmcnt(44) lgkmcnt(4)
    v_mfma_f32_16x16x32_bf16 v[64:67], v[36:39], a[184:187], v[64:67]
    s_add_u32 m0, s39, 65536
    s_add_u32 s49, s49, 16384
    buffer_load_dwordx4 v1, s[8:11], s49 offen offset:0 sc1 lds
    v_mfma_f32_16x16x32_bf16 v[84:87], v[36:39], a[188:191], v[84:87]
    ds_read_b128 v[36:39], v13 offset:43008
    v_mfma_f32_16x16x32_bf16 v[68:71], v[40:43], a[184:187], v[68:71]
    v_mfma_f32_16x16x32_bf16 v[88:91], v[40:43], a[188:191], v[88:91]
    ds_read_b128 v[40:43], v13 offset:45056
    s_waitcnt lgkmcnt(3)
    v_mfma_f32_16x16x32_bf16 v[72:75], v[44:47], a[184:187], v[72:75]
    buffer_load_dwordx4 a[4:7], v11, s[8:11], s59 offen offset:0 sc1
    v_mfma_f32_16x16x32_bf16 v[92:95], v[44:47], a[188:191], v[92:95]
    ds_read_b128 v[44:47], v13 offset:47104
    v_mfma_f32_16x16x32_bf16 v[76:79], v[24:27], a[184:187], v[76:79]
    v_mfma_f32_16x16x32_bf16 v[96:99], v[24:27], a[188:191], v[96:99]
    s_waitcnt vmcnt(44)
    s_barrier
    ds_read_b128 v[24:27], v13 offset:49152
    v_mfma_f32_16x16x32_bf16 v[80:83], v[28:31], a[184:187], v[80:83]
    buffer_load_dwordx4 v1, s[8:11], s49 offen offset:1024 sc1 lds
    v_mfma_f32_16x16x32_bf16 v[100:103], v[28:31], a[188:191], v[100:103]
    ds_read_b128 v[28:31], v13 offset:51200
    s_waitcnt vmcnt(41) lgkmcnt(4)
    v_mfma_f32_16x16x32_bf16 v[64:67], v[32:35], a[192:195], v[64:67]
    v_mfma_f32_16x16x32_bf16 v[84:87], v[32:35], a[196:199], v[84:87]
    ds_read_b128 v[32:35], v13 offset:53248
    v_mfma_f32_16x16x32_bf16 v[68:71], v[36:39], a[192:195], v[68:71]
    buffer_load_dwordx4 a[8:11], v10, s[8:11], s59 offen offset:2048 sc1
    v_mfma_f32_16x16x32_bf16 v[88:91], v[36:39], a[196:199], v[88:91]
    ds_read_b128 v[36:39], v13 offset:55296
    s_waitcnt lgkmcnt(3)
    v_mfma_f32_16x16x32_bf16 v[72:75], v[40:43], a[192:195], v[72:75]
    v_mfma_f32_16x16x32_bf16 v[92:95], v[40:43], a[196:199], v[92:95]
    ds_read_b128 v[40:43], v13 offset:57344
    v_mfma_f32_16x16x32_bf16 v[76:79], v[44:47], a[192:195], v[76:79]
    buffer_load_dwordx4 v1, s[8:11], s49 offen offset:2048 sc1 lds
    v_mfma_f32_16x16x32_bf16 v[96:99], v[44:47], a[196:199], v[96:99]
    ds_read_b128 v[44:47], v13 offset:59392
    v_mfma_f32_16x16x32_bf16 v[80:83], v[24:27], a[192:195], v[80:83]
    v_mfma_f32_16x16x32_bf16 v[100:103], v[24:27], a[196:199], v[100:103]
    ds_read_b128 v[24:27], v13 offset:61440
    s_waitcnt vmcnt(39) lgkmcnt(4)
    v_mfma_f32_16x16x32_bf16 v[64:67], v[28:31], a[200:203], v[64:67]
    s_add_u32 s57, s57, 16384
    s_mov_b64 exec, 65535
    v_mov_b32 v23, 0
    buffer_atomic_or v23, v252, s[8:11], s57 offen sc0 sc1
    s_mov_b64 exec, -1
    v_mfma_f32_16x16x32_bf16 v[84:87], v[28:31], a[204:207], v[84:87]
    ds_read_b128 v[28:31], v13 offset:63488
    v_mfma_f32_16x16x32_bf16 v[68:71], v[32:35], a[200:203], v[68:71]
    buffer_load_dwordx4 a[12:15], v11, s[8:11], s59 offen offset:2048 sc1
    v_mfma_f32_16x16x32_bf16 v[88:91], v[32:35], a[204:207], v[88:91]
    s_waitcnt vmcnt(40)
    s_barrier
    ds_read_b128 v[32:35], v14 offset:0
    s_waitcnt lgkmcnt(3)
    v_mfma_f32_16x16x32_bf16 v[72:75], v[36:39], a[200:203], v[72:75]
    v_mfma_f32_16x16x32_bf16 v[92:95], v[36:39], a[204:207], v[92:95]
    ds_read_b128 v[36:39], v14 offset:2048
    v_mfma_f32_16x16x32_bf16 v[76:79], v[40:43], a[200:203], v[76:79]
    buffer_load_dwordx4 v1, s[8:11], s49 offen offset:3072 sc1 lds
    v_mfma_f32_16x16x32_bf16 v[96:99], v[40:43], a[204:207], v[96:99]
    ds_read_b128 v[40:43], v14 offset:4096
    v_mfma_f32_16x16x32_bf16 v[80:83], v[44:47], a[200:203], v[80:83]
    v_mfma_f32_16x16x32_bf16 v[100:103], v[44:47], a[204:207], v[100:103]
    ds_read_b128 v[44:47], v14 offset:6144
    s_waitcnt vmcnt(37) lgkmcnt(4)
    v_mfma_f32_16x16x32_bf16 v[64:67], v[24:27], a[208:211], v[64:67]
    s_add_u32 m0, s39, 81920
    s_add_u32 s49, s49, 16384
    buffer_load_dwordx4 v1, s[8:11], s49 offen offset:0 sc1 lds
    v_mfma_f32_16x16x32_bf16 v[84:87], v[24:27], a[212:215], v[84:87]
    ds_read_b128 v[24:27], v14 offset:8192
    v_mfma_f32_16x16x32_bf16 v[68:71], v[28:31], a[208:211], v[68:71]
    v_mfma_f32_16x16x32_bf16 v[88:91], v[28:31], a[212:215], v[88:91]
    ds_read_b128 v[28:31], v14 offset:10240
    s_waitcnt lgkmcnt(3)
    v_mfma_f32_16x16x32_bf16 v[72:75], v[32:35], a[208:211], v[72:75]
    s_add_u32 s59, s59, 4096
    buffer_load_dwordx4 a[16:19], v10, s[8:11], s59 offen offset:0 sc1
    v_mfma_f32_16x16x32_bf16 v[92:95], v[32:35], a[212:215], v[92:95]
    ds_read_b128 v[32:35], v14 offset:12288
    v_mfma_f32_16x16x32_bf16 v[76:79], v[36:39], a[208:211], v[76:79]
    v_mfma_f32_16x16x32_bf16 v[96:99], v[36:39], a[212:215], v[96:99]
    ds_read_b128 v[36:39], v14 offset:14336
    v_mfma_f32_16x16x32_bf16 v[80:83], v[40:43], a[208:211], v[80:83]
    buffer_load_dwordx4 v1, s[8:11], s49 offen offset:1024 sc1 lds
    v_mfma_f32_16x16x32_bf16 v[100:103], v[40:43], a[212:215], v[100:103]
    s_waitcnt vmcnt(37)
    s_barrier
    ds_read_b128 v[40:43], v12 offset:0
    s_waitcnt vmcnt(36) lgkmcnt(4)
    v_mfma_f32_16x16x32_bf16 v[64:67], v[44:47], a[216:219], v[64:67]
    v_mfma_f32_16x16x32_bf16 v[84:87], v[44:47], a[220:223], v[84:87]
    ds_read_b128 v[44:47], v12 offset:2048
    v_mfma_f32_16x16x32_bf16 v[68:71], v[24:27], a[216:219], v[68:71]
    buffer_load_dwordx4 a[20:23], v11, s[8:11], s59 offen offset:0 sc1
    v_mfma_f32_16x16x32_bf16 v[88:91], v[24:27], a[220:223], v[88:91]
    ds_read_b128 v[24:27], v12 offset:4096
    s_waitcnt lgkmcnt(3)
    v_mfma_f32_16x16x32_bf16 v[72:75], v[28:31], a[216:219], v[72:75]
    v_mfma_f32_16x16x32_bf16 v[92:95], v[28:31], a[220:223], v[92:95]
    ds_read_b128 v[28:31], v12 offset:6144
    v_mfma_f32_16x16x32_bf16 v[76:79], v[32:35], a[216:219], v[76:79]
    buffer_load_dwordx4 v1, s[8:11], s49 offen offset:2048 sc1 lds
    v_mfma_f32_16x16x32_bf16 v[96:99], v[32:35], a[220:223], v[96:99]
    ds_read_b128 v[32:35], v12 offset:8192
    v_mfma_f32_16x16x32_bf16 v[80:83], v[36:39], a[216:219], v[80:83]
    v_mfma_f32_16x16x32_bf16 v[100:103], v[36:39], a[220:223], v[100:103]
    ds_read_b128 v[36:39], v12 offset:10240
    s_waitcnt vmcnt(32) lgkmcnt(4)
    v_mfma_f32_16x16x32_bf16 v[64:67], v[40:43], a[224:227], v[64:67]
    buffer_load_dwordx4 a[24:27], v10, s[8:11], s59 offen offset:2048 sc1
    v_mfma_f32_16x16x32_bf16 v[84:87], v[40:43], a[228:231], v[84:87]
    ds_read_b128 v[40:43], v12 offset:12288
    v_mfma_f32_16x16x32_bf16 v[68:71], v[44:47], a[224:227], v[68:71]
    v_mfma_f32_16x16x32_bf16 v[88:91], v[44:47], a[228:231], v[88:91]
    ds_read_b128 v[44:47], v12 offset:14336
    s_waitcnt lgkmcnt(3)
    v_mfma_f32_16x16x32_bf16 v[72:75], v[24:27], a[224:227], v[72:75]
    buffer_load_dwordx4 v1, s[8:11], s49 offen offset:3072 sc1 lds
    v_mfma_f32_16x16x32_bf16 v[92:95], v[24:27], a[228:231], v[92:95]
    s_waitcnt vmcnt(33)
    s_barrier
    ds_read_b128 v[24:27], v12 offset:16384
    v_mfma_f32_16x16x32_bf16 v[76:79], v[28:31], a[224:227], v[76:79]
    v_mfma_f32_16x16x32_bf16 v[96:99], v[28:31], a[228:231], v[96:99]
    ds_read_b128 v[28:31], v12 offset:18432
    v_mfma_f32_16x16x32_bf16 v[80:83], v[32:35], a[224:227], v[80:83]
    buffer_load_dwordx4 a[28:31], v11, s[8:11], s59 offen offset:2048 sc1
    v_mfma_f32_16x16x32_bf16 v[100:103], v[32:35], a[228:231], v[100:103]
    ds_read_b128 v[32:35], v12 offset:20480
    s_waitcnt vmcnt(32) lgkmcnt(4)
    v_mfma_f32_16x16x32_bf16 v[64:67], v[36:39], a[232:235], v[64:67]
    v_mfma_f32_16x16x32_bf16 v[84:87], v[36:39], a[236:239], v[84:87]
    ds_read_b128 v[36:39], v12 offset:22528
    v_mfma_f32_16x16x32_bf16 v[68:71], v[40:43], a[232:235], v[68:71]
    s_add_u32 m0, s39, 98304
    s_add_u32 s49, s49, 16384
    buffer_load_dwordx4 v1, s[8:11], s49 offen offset:0 sc1 lds
    v_mfma_f32_16x16x32_bf16 v[88:91], v[40:43], a[236:239], v[88:91]
    ds_read_b128 v[40:43], v12 offset:24576
    s_waitcnt lgkmcnt(3)
    v_mfma_f32_16x16x32_bf16 v[72:75], v[44:47], a[232:235], v[72:75]
    s_waitcnt vmcnt(11)
    s_mov_b64 exec, 65535
    v_cmp_ne_u32 vcc, s6, v23
    s_mov_b64 exec, -1
    s_cbranch_vccnz cold_66
coldr_67:
    s_sub_u32 s63, s55, 16384
    s_waitcnt vmcnt(25)
    buffer_atomic_swap v4, v7, s[8:11], s63 offen offset:128 sc1
    v_mfma_f32_16x16x32_bf16 v[92:95], v[44:47], a[236:239], v[92:95]
    ds_read_b128 v[44:47], v12 offset:26624
    v_mfma_f32_16x16x32_bf16 v[76:79], v[24:27], a[232:235], v[76:79]
    buffer_load_dwordx4 v1, s[8:11], s49 offen offset:1024 sc1 lds
    v_mfma_f32_16x16x32_bf16 v[96:99], v[24:27], a[236:239], v[96:99]
    ds_read_b128 v[24:27], v12 offset:28672
    v_mfma_f32_16x16x32_bf16 v[80:83], v[28:31], a[232:235], v[80:83]
    v_mfma_f32_16x16x32_bf16 v[100:103], v[28:31], a[236:239], v[100:103]
    ds_read_b128 v[28:31], v12 offset:30720
    s_waitcnt vmcnt(28) lgkmcnt(4)
    v_mfma_f32_16x16x32_bf16 v[64:67], v[32:35], a[240:243], v[64:67]
    s_add_u32 s59, s59, 4096
    buffer_load_dwordx4 a[32:35], v10, s[8:11], s59 offen offset:0 sc1
    v_mfma_f32_16x16x32_bf16 v[84:87], v[32:35], a[244:247], v[84:87]
    s_waitcnt vmcnt(30)
    s_barrier
    ds_read_b128 v[32:35], v12 offset:32768
    v_mfma_f32_16x16x32_bf16 v[68:71], v[36:39], a[240:243], v[68:71]
    v_mfma_f32_16x16x32_bf16 v[88:91], v[36:39], a[244:247], v[88:91]
    ds_read_b128 v[36:39], v12 offset:34816
    s_waitcnt lgkmcnt(3)
    v_mfma_f32_16x16x32_bf16 v[72:75], v[40:43], a[240:243], v[72:75]
    buffer_load_dwordx4 v1, s[8:11], s49 offen offset:2048 sc1 lds
    v_mfma_f32_16x16x32_bf16 v[92:95], v[40:43], a[244:247], v[92:95]
    ds_read_b128 v[40:43], v12 offset:36864
    v_mfma_f32_16x16x32_bf16 v[76:79], v[44:47], a[240:243], v[76:79]
    v_mfma_f32_16x16x32_bf16 v[96:99], v[44:47], a[244:247], v[96:99]
    ds_read_b128 v[44:47], v12 offset:38912
    v_mfma_f32_16x16x32_bf16 v[80:83], v[24:27], a[240:243], v[80:83]
    buffer_load_dwordx4 a[36:39], v11, s[8:11], s59 offen offset:0 sc1
    v_mfma_f32_16x16x32_bf16 v[100:103], v[24:27], a[244:247], v[100:103]
    ds_read_b128 v[24:27], v12 offset:40960
    s_waitcnt vmcnt(25) lgkmcnt(4)
    v_mfma_f32_16x16x32_bf16 v[64:67], v[28:31], a[248:251], v[64:67]
    v_mfma_f32_16x16x32_bf16 v[84:87], v[28:31], a[252:255], v[84:87]
    ds_read_b128 v[28:31], v12 offset:43008
    v_mfma_f32_16x16x32_bf16 v[68:71], v[32:35], a[248:251], v[68:71]
    buffer_load_dwordx4 v1, s[8:11], s49 offen offset:3072 sc1 lds
    v_mfma_f32_16x16x32_bf16 v[88:91], v[32:35], a[252:255], v[88:91]
    ds_read_b128 v[32:35], v12 offset:45056
    s_waitcnt lgkmcnt(3)
    v_mfma_f32_16x16x32_bf16 v[72:75], v[36:39], a[248:251], v[72:75]
    v_mfma_f32_16x16x32_bf16 v[92:95], v[36:39], a[252:255], v[92:95]
    ds_read_b128 v[36:39], v12 offset:47104
    v_mfma_f32_16x16x32_bf16 v[76:79], v[40:43], a[248:251], v[76:79]
    buffer_load_dwordx4 a[40:43], v10, s[8:11], s59 offen offset:2048 sc1
    v_mfma_f32_16x16x32_bf16 v[96:99], v[40:43], a[252:255], v[96:99]
    s_waitcnt vmcnt(25)
    s_barrier
    ds_read_b128 v[40:43], v12 offset:49152
    v_mfma_f32_16x16x32_bf16 v[80:83], v[44:47], a[248:251], v[80:83]
    v_mfma_f32_16x16x32_bf16 v[100:103], v[44:47], a[252:255], v[100:103]
    ds_read_b128 v[44:47], v12 offset:51200
    s_waitcnt vmcnt(22) lgkmcnt(4)
    v_mfma_f32_16x16x32_bf16 v[64:67], v[24:27], a[0:3], v[64:67]
    s_add_u32 m0, s39, 114688
    s_add_u32 s49, s49, 16384
    buffer_load_dwordx4 v1, s[8:11], s49 offen offset:0 sc1 lds
    v_mfma_f32_16x16x32_bf16 v[84:87], v[24:27], a[4:7], v[84:87]
    ds_read_b128 v[24:27], v12 offset:53248
    v_mfma_f32_16x16x32_bf16 v[68:71], v[28:31], a[0:3], v[68:71]
    v_mfma_f32_16x16x32_bf16 v[88:91], v[28:31], a[4:7], v[88:91]
    ds_read_b128 v[28:31], v12 offset:55296
    s_waitcnt lgkmcnt(3)
    v_mfma_f32_16x16x32_bf16 v[72:75], v[32:35], a[0:3], v[72:75]
    buffer_load_dwordx4 a[44:47], v11, s[8:11], s59 offen offset:2048 sc1
    v_mfma_f32_16x16x32_bf16 v[92:95], v[32:35], a[4:7], v[92:95]
    ds_read_b128 v[32:35], v12 offset:57344
    v_mfma_f32_16x16x32_bf16 v[76:79], v[36:39], a[0:3], v[76:79]
    v_mfma_f32_16x16x32_bf16 v[96:99], v[36:39], a[4:7], v[96:99]
    ds_read_b128 v[36:39], v12 offset:59392
    v_mfma_f32_16x16x32_bf16 v[80:83], v[40:43], a[0:3], v[80:83]
    buffer_load_dwordx4 v1, s[8:11], s49 offen offset:1024 sc1 lds
    v_mfma_f32_16x16x32_bf16 v[100:103], v[40:43], a[4:7], v[100:103]
    ds_read_b128 v[40:43], v12 offset:61440
    s_waitcnt vmcnt(20) lgkmcnt(4)
    v_mfma_f32_16x16x32_bf16 v[64:67], v[44:47], a[8:11], v[64:67]
    v_mfma_f32_16x16x32_bf16 v[84:87], v[44:47], a[12:15], v[84:87]
    ds_read_b128 v[44:47], v12 offset:63488
    v_mfma_f32_16x16x32_bf16 v[68:71], v[24:27], a[8:11], v[68:71]
    buffer_load_dwordx4 v1, s[8:11], s49 offen offset:2048 sc1 lds
    v_mfma_f32_16x16x32_bf16 v[88:91], v[24:27], a[12:15], v[88:91]
    s_waitcnt vmcnt(20)
    s_barrier
    ds_read_b128 v[24:27], v13 offset:0
    s_waitcnt lgkmcnt(3)
    v_mfma_f32_16x16x32_bf16 v[72:75], v[28:31], a[8:11], v[72:75]
    s_add_u32 s59, s59, 4096
    buffer_load_dwordx4 a[48:51], v10, s[8:11], s59 offen offset:0 sc1
    v_mfma_f32_16x16x32_bf16 v[92:95], v[28:31], a[12:15], v[92:95]
    ds_read_b128 v[28:31], v13 offset:2048
    v_mfma_f32_16x16x32_bf16 v[76:79], v[32:35], a[8:11], v[76:79]
    v_mfma_f32_16x16x32_bf16 v[96:99], v[32:35], a[12:15], v[96:99]
    ds_read_b128 v[32:35], v13 offset:4096
    v_mfma_f32_16x16x32_bf16 v[80:83], v[36:39], a[8:11], v[80:83]
    buffer_load_dwordx4 v1, s[8:11], s49 offen offset:3072 sc1 lds
    v_mfma_f32_16x16x32_bf16 v[100:103], v[36:39], a[12:15], v[100:103]
    ds_read_b128 v[36:39], v13 offset:6144
    s_waitcnt vmcnt(18) lgkmcnt(4)
    v_mfma_f32_16x16x32_bf16 v[64:67], v[40:43], a[16:19], v[64:67]
    buffer_load_dwordx4 a[52:55], v11, s[8:11], s59 offen offset:0 sc1
    v_mfma_f32_16x16x32_bf16 v[84:87], v[40:43], a[20:23], v[84:87]
    ds_read_b128 v[40:43], v13 offset:8192
    v_mfma_f32_16x16x32_bf16 v[68:71], v[44:47], a[16:19], v[68:71]
    s_add_u32 m0, s39, 131072
    s_add_u32 s49, s49, 16384
    buffer_load_dwordx4 v1, s[8:11], s49 offen offset:0 sc1 lds
    v_mfma_f32_16x16x32_bf16 v[88:91], v[44:47], a[20:23], v[88:91]
    ds_read_b128 v[44:47], v13 offset:10240
    s_waitcnt lgkmcnt(3)
    v_mfma_f32_16x16x32_bf16 v[72:75], v[24:27], a[16:19], v[72:75]
    buffer_load_dwordx4 a[56:59], v10, s[8:11], s59 offen offset:2048 sc1
    v_mfma_f32_16x16x32_bf16 v[92:95], v[24:27], a[20:23], v[92:95]
    ds_read_b128 v[24:27], v13 offset:12288
    v_mfma_f32_16x16x32_bf16 v[76:79], v[28:31], a[16:19], v[76:79]
    buffer_load_dwordx4 v1, s[8:11], s49 offen offset:1024 sc1 lds
    v_mfma_f32_16x16x32_bf16 v[96:99], v[28:31], a[20:23], v[96:99]
    ds_read_b128 v[28:31], v13 offset:14336
    v_mfma_f32_16x16x32_bf16 v[80:83], v[32:35], a[16:19], v[80:83]
    buffer_load_dwordx4 a[60:63], v11, s[8:11], s59 offen offset:2048 sc1
    v_mfma_f32_16x16x32_bf16 v[100:103], v[32:35], a[20:23], v[100:103]
    s_waitcnt vmcnt(20)
    s_barrier
    ds_read_b128 v[32:35], v13 offset:16384
    s_waitcnt vmcnt(19) lgkmcnt(4)
    v_mfma_f32_16x16x32_bf16 v[64:67], v[36:39], a[24:27], v[64:67]
    buffer_load_dwordx4 v1, s[8:11], s49 offen offset:2048 sc1 lds
    v_mfma_f32_16x16x32_bf16 v[84:87], v[36:39], a[28:31], v[84:87]
    ds_read_b128 v[36:39], v13 offset:18432
    v_mfma_f32_16x16x32_bf16 v[68:71], v[40:43], a[24:27], v[68:71]
    v_mfma_f32_16x16x32_bf16 v[88:91], v[40:43], a[28:31], v[88:91]
    ds_read_b128 v[40:43], v13 offset:20480
    s_waitcnt lgkmcnt(3)
    v_mfma_f32_16x16x32_bf16 v[72:75], v[44:47], a[24:27], v[72:75]
    buffer_load_dwordx4 v1, s[8:11], s49 offen offset:3072 sc1 lds
    v_mfma_f32_16x16x32_bf16 v[92:95], v[44:47], a[28:31], v[92:95]
    ds_read_b128 v[44:47], v13 offset:22528
    v_mfma_f32_16x16x32_bf16 v[76:79], v[24:27], a[24:27], v[76:79]
    s_add_u32 s59, s59, 4096
    buffer_load_dwordx4 a[64:67], v10, s[8:11], s59 offen offset:0 sc1
    v_mfma_f32_16x16x32_bf16 v[96:99], v[24:27], a[28:31], v[96:99]
    ds_read_b128 v[24:27], v13 offset:24576
    v_mfma_f32_16x16x32_bf16 v[80:83], v[28:31], a[24:27], v[80:83]
    s_add_u32 m0, s39, 0
    s_add_u32 s49, s49, 16384
    buffer_load_dwordx4 v1, s[8:11], s49 offen offset:0 sc1 lds
    v_mfma_f32_16x16x32_bf16 v[100:103], v[28:31], a[28:31], v[100:103]
    ds_read_b128 v[28:31], v13 offset:26624
    s_waitcnt vmcnt(17) lgkmcnt(4)
    v_mfma_f32_16x16x32_bf16 v[64:67], v[32:35], a[32:35], v[64:67]
    buffer_load_dwordx4 a[68:71], v11, s[8:11], s59 offen offset:0 sc1
    v_mfma_f32_16x16x32_bf16 v[84:87], v[32:35], a[36:39], v[84:87]
    ds_read_b128 v[32:35], v13 offset:28672
    v_mfma_f32_16x16x32_bf16 v[68:71], v[36:39], a[32:35], v[68:71]
    buffer_load_dwordx4 v1, s[8:11], s49 offen offset:1024 sc1 lds
    v_mfma_f32_16x16x32_bf16 v[88:91], v[36:39], a[36:39], v[88:91]
    ds_read_b128 v[36:39], v13 offset:30720
    s_waitcnt lgkmcnt(3)
    v_mfma_f32_16x16x32_bf16 v[72:75], v[40:43], a[32:35], v[72:75]
    buffer_load_dwordx4 a[72:75], v10, s[8:11], s59 offen offset:2048 sc1
    v_mfma_f32_16x16x32_bf16 v[92:95], v[40:43], a[36:39], v[92:95]
    s_waitcnt vmcnt(19)
    s_barrier
    ds_read_b128 v[40:43], v13 offset:32768
    v_mfma_f32_16x16x32_bf16 v[76:79], v[44:47], a[32:35], v[76:79]
    buffer_load_dwordx4 v1, s[8:11], s49 offen offset:2048 sc1 lds
    v_mfma_f32_16x16x32_bf16 v[96:99], v[44:47], a[36:39], v[96:99]
    ds_read_b128 v[44:47], v13 offset:34816
    v_mfma_f32_16x16x32_bf16 v[80:83], v[24:27], a[32:35], v[80:83]
    buffer_load_dwordx4 a[76:79], v11, s[8:11], s59 offen offset:2048 sc1
    v_mfma_f32_16x16x32_bf16 v[100:103], v[24:27], a[36:39], v[100:103]
    ds_read_b128 v[24:27], v13 offset:36864
    s_waitcnt vmcnt(18) lgkmcnt(4)
    v_mfma_f32_16x16x32_bf16 v[64:67], v[28:31], a[40:43], v[64:67]
    buffer_load_dwordx4 v1, s[8:11], s49 offen offset:3072 sc1 lds
    v_mfma_f32_16x16x32_bf16 v[84:87], v[28:31], a[44:47], v[84:87]
    ds_read_b128 v[28:31], v13 offset:38912
    v_mfma_f32_16x16x32_bf16 v[68:71], v[32:35], a[40:43], v[68:71]
    v_mfma_f32_16x16x32_bf16 v[88:91], v[32:35], a[44:47], v[88:91]
    ds_read_b128 v[32:35], v13 offset:40960
    s_waitcnt lgkmcnt(3)
    v_mfma_f32_16x16x32_bf16 v[72:75], v[36:39], a[40:43], v[72:75]
    s_add_u32 s59, s59, 4096
    buffer_load_dwordx4 a[80:83], v10, s[8:11], s59 offen offset:0 sc1
    v_mfma_f32_16x16x32_bf16 v[92:95], v[36:39], a[44:47], v[92:95]
    ds_read_b128 v[36:39], v13 offset:43008
    v_mfma_f32_16x16x32_bf16 v[76:79], v[40:43], a[40:43], v[76:79]
    v_mfma_f32_16x16x32_bf16 v[96:99], v[40:43], a[44:47], v[96:99]
    ds_read_b128 v[40:43], v13 offset:45056
    v_mfma_f32_16x16x32_bf16 v[80:83], v[44:47], a[40:43], v[80:83]
    buffer_load_dwordx4 a[84:87], v11, s[8:11], s59 offen offset:0 sc1
    v_mfma_f32_16x16x32_bf16 v[100:103], v[44:47], a[44:47], v[100:103]
    ds_read_b128 v[44:47], v13 offset:47104
    s_waitcnt vmcnt(16) lgkmcnt(4)
    v_mfma_f32_16x16x32_bf16 v[64:67], v[24:27], a[48:51], v[64:67]
    v_mfma_f32_16x16x32_bf16 v[84:87], v[24:27], a[52:55], v[84:87]
    s_waitcnt vmcnt(17)
    s_barrier
    ds_read_b128 v[24:27], v13 offset:49152
    v_mfma_f32_16x16x32_bf16 v[68:71], v[28:31], a[48:51], v[68:71]
    buffer_load_dwordx4 a[88:91], v10, s[8:11], s59 offen offset:2048 sc1
    v_mfma_f32_16x16x32_bf16 v[88:91], v[28:31], a[52:55], v[88:91]
    ds_read_b128 v[28:31], v13 offset:51200
    s_waitcnt lgkmcnt(3)
    v_mfma_f32_16x16x32_bf16 v[72:75], v[32:35], a[48:51], v[72:75]
    v_mfma_f32_16x16x32_bf16 v[92:95], v[32:35], a[52:55], v[92:95]
    ds_read_b128 v[32:35], v13 offset:53248
    v_mfma_f32_16x16x32_bf16 v[76:79], v[36:39], a[48:51], v[76:79]
    buffer_load_dwordx4 a[92:95], v11, s[8:11], s59 offen offset:2048 sc1
    v_mfma_f32_16x16x32_bf16 v[96:99], v[36:39], a[52:55], v[96:99]
    ds_read_b128 v[36:39], v13 offset:55296
    v_mfma_f32_16x16x32_bf16 v[80:83], v[40:43], a[48:51], v[80:83]
    v_mfma_f32_16x16x32_bf16 v[100:103], v[40:43], a[52:55], v[100:103]
    ds_read_b128 v[40:43], v13 offset:57344
    s_waitcnt vmcnt(14) lgkmcnt(4)
    v_mfma_f32_16x16x32_bf16 v[64:67], v[44:47], a[56:59], v[64:67]
    v_mfma_f32_16x16x32_bf16 v[84:87], v[44:47], a[60:63], v[84:87]
    ds_read_b128 v[44:47], v13 offset:59392
    v_mfma_f32_16x16x32_bf16 v[68:71], v[24:27], a[56:59], v[68:71]
    v_mfma_f32_16x16x32_bf16 v[88:91], v[24:27], a[60:63], v[88:91]
    ds_read_b128 v[24:27], v13 offset:61440
    s_waitcnt lgkmcnt(3)
    v_mfma_f32_16x16x32_bf16 v[72:75], v[28:31], a[56:59], v[72:75]
    v_mfma_f32_16x16x32_bf16 v[92:95], v[28:31], a[60:63], v[92:95]
    ds_read_b128 v[28:31], v13 offset:63488
    v_mfma_f32_16x16x32_bf16 v[76:79], v[32:35], a[56:59], v[76:79]
    v_mfma_f32_16x16x32_bf16 v[96:99], v[32:35], a[60:63], v[96:99]
    s_waitcnt vmcnt(12)
    s_barrier
    ds_read_b128 v[32:35], v14 offset:0
    v_mfma_f32_16x16x32_bf16 v[80:83], v[36:39], a[56:59], v[80:83]
    v_mfma_f32_16x16x32_bf16 v[100:103], v[36:39], a[60:63], v[100:103]
    ds_read_b128 v[36:39], v14 offset:2048
    s_waitcnt vmcnt(9) lgkmcnt(4)
    v_mfma_f32_16x16x32_bf16 v[64:67], v[40:43], a[64:67], v[64:67]
    v_mfma_f32_16x16x32_bf16 v[84:87], v[40:43], a[68:71], v[84:87]
    ds_read_b128 v[40:43], v14 offset:4096
    v_mfma_f32_16x16x32_bf16 v[68:71], v[44:47], a[64:67], v[68:71]
    v_mfma_f32_16x16x32_bf16 v[88:91], v[44:47], a[68:71], v[88:91]
    ds_read_b128 v[44:47], v14 offset:6144
    s_waitcnt lgkmcnt(3)
    v_mfma_f32_16x16x32_bf16 v[72:75], v[24:27], a[64:67], v[72:75]
    v_mfma_f32_16x16x32_bf16 v[92:95], v[24:27], a[68:71], v[92:95]
    ds_read_b128 v[24:27], v14 offset:8192
    v_mfma_f32_16x16x32_bf16 v[76:79], v[28:31], a[64:67], v[76:79]
    v_mfma_f32_16x16x32_bf16 v[96:99], v[28:31], a[68:71], v[96:99]
    ds_read_b128 v[28:31], v14 offset:10240
    v_mfma_f32_16x16x32_bf16 v[80:83], v[32:35], a[64:67], v[80:83]
    v_mfma_f32_16x16x32_bf16 v[100:103], v[32:35], a[68:71], v[100:103]
    ds_read_b128 v[32:35], v14 offset:12288
    s_waitcnt vmcnt(5) lgkmcnt(4)
    v_mfma_f32_16x16x32_bf16 v[64:67], v[36:39], a[72:75], v[64:67]
    v_mfma_f32_16x16x32_bf16 v[84:87], v[36:39], a[76:79], v[84:87]
    ds_read_b128 v[36:39], v14 offset:14336
    v_mfma_f32_16x16x32_bf16 v[68:71], v[40:43], a[72:75], v[68:71]
    v_mfma_f32_16x16x32_bf16 v[88:91], v[40:43], a[76:79], v[88:91]
    s_waitcnt vmcnt(4)
    s_barrier
    ds_read_b128 v[40:43], v12 offset:0
    s_waitcnt lgkmcnt(3)
    v_mfma_f32_16x16x32_bf16 v[72:75], v[44:47], a[72:75], v[72:75]
    v_mfma_f32_16x16x32_bf16 v[92:95], v[44:47], a[76:79], v[92:95]
    ds_read_b128 v[44:47], v12 offset:2048
    v_mfma_f32_16x16x32_bf16 v[76:79], v[24:27], a[72:75], v[76:79]
    v_mfma_f32_16x16x32_bf16 v[96:99], v[24:27], a[76:79], v[96:99]
    ds_read_b128 v[24:27], v12 offset:4096
    v_mfma_f32_16x16x32_bf16 v[80:83], v[28:31], a[72:75], v[80:83]
    v_mfma_f32_16x16x32_bf16 v[100:103], v[28:31], a[76:79], v[100:103]
    ds_read_b128 v[28:31], v12 offset:6144
    s_waitcnt vmcnt(2) lgkmcnt(4)
    v_mfma_f32_16x16x32_bf16 v[64:67], v[32:35], a[80:83], v[64:67]
    v_mfma_f32_16x16x32_bf16 v[84:87], v[32:35], a[84:87], v[84:87]
    ds_read_b128 v[32:35], v12 offset:8192
    v_mfma_f32_16x16x32_bf16 v[68:71], v[36:39], a[80:83], v[68:71]
    v_mfma_f32_16x16x32_bf16 v[88:91], v[36:39], a[84:87], v[88:91]
    ds_read_b128 v[36:39], v12 offset:10240
    s_waitcnt lgkmcnt(3)
    v_mfma_f32_16x16x32_bf16 v[72:75], v[40:43], a[80:83], v[72:75]
    v_mfma_f32_16x16x32_bf16 v[92:95], v[40:43], a[84:87], v[92:95]
    ds_read_b128 v[40:43], v12 offset:12288
    v_mfma_f32_16x16x32_bf16 v[76:79], v[44:47], a[80:83], v[76:79]
    v_mfma_f32_16x16x32_bf16 v[96:99], v[44:47], a[84:87], v[96:99]
    ds_read_b128 v[44:47], v12 offset:14336
    v_mfma_f32_16x16x32_bf16 v[80:83], v[24:27], a[80:83], v[80:83]
    v_mfma_f32_16x16x32_bf16 v[100:103], v[24:27], a[84:87], v[100:103]
    s_waitcnt vmcnt(0) lgkmcnt(3)
    v_mfma_f32_16x16x32_bf16 v[64:67], v[28:31], a[88:91], v[64:67]
    v_mfma_f32_16x16x32_bf16 v[84:87], v[28:31], a[92:95], v[84:87]
    v_mfma_f32_16x16x32_bf16 v[68:71], v[32:35], a[88:91], v[68:71]
    v_mfma_f32_16x16x32_bf16 v[88:91], v[32:35], a[92:95], v[88:91]
    s_waitcnt lgkmcnt(0)
    v_mfma_f32_16x16x32_bf16 v[72:75], v[36:39], a[88:91], v[72:75]
    v_mfma_f32_16x16x32_bf16 v[92:95], v[36:39], a[92:95], v[92:95]
    v_mfma_f32_16x16x32_bf16 v[76:79], v[40:43], a[88:91], v[76:79]
    v_mfma_f32_16x16x32_bf16 v[96:99], v[40:43], a[92:95], v[96:99]
    v_mfma_f32_16x16x32_bf16 v[80:83], v[44:47], a[88:91], v[80:83]
    v_mfma_f32_16x16x32_bf16 v[100:103], v[44:47], a[92:95], v[100:103]
    v_cmp_u_f32 vcc, v64, v84
    s_cbranch_vccnz cold_70
coldr_71:
L_pg2_1:
    s_cbranch_execz L_wr2
    ds_write_b128 v15, v[84:87] offset:0
    ds_write_b128 v15, v[88:91] offset:1024
    ds_write_b128 v15, v[92:95] offset:2048
    s_nop 0
    ds_write_b128 v15, v[96:99] offset:3072
    s_nop 0
    ds_write_b128 v15, v[100:103] offset:4096
    v_pk_fma_f32 v[232:233], v[64:65], v[160:161], v[232:233]
    v_pk_fma_f32 v[234:235], v[66:67], v[162:163], v[234:235]
    v_pk_fma_f32 v[236:237], v[68:69], v[164:165], v[236:237]
    v_pk_fma_f32 v[238:239], v[70:71], v[166:167], v[238:239]
    v_pk_fma_f32 v[240:241], v[72:73], v[168:169], v[240:241]
    v_pk_fma_f32 v[242:243], v[74:75], v[170:171], v[242:243]
    v_pk_fma_f32 v[244:245], v[76:77], v[172:173], v[244:245]
    v_pk_fma_f32 v[246:247], v[78:79], v[174:175], v[246:247]
    v_pk_fma_f32 v[248:249], v[80:81], v[176:177], v[248:249]
    v_pk_fma_f32 v[250:251], v[82:83], v[178:179], v[250:251]
    s_waitcnt lgkmcnt(0)
    s_barrier
    ds_read_b128 v[64:67], v16 offset:0
    ds_read_b128 v[68:71], v16 offset:1024
    ds_read_b128 v[72:75], v16 offset:2048
    ds_read_b128 v[76:79], v16 offset:3072
    ds_read_b128 v[80:83], v16 offset:4096
    s_waitcnt lgkmcnt(4)
    v_pk_fma_f32 v[232:233], v[64:65], v[160:161], v[232:233]
    v_pk_fma_f32 v[234:235], v[66:67], v[162:163], v[234:235]
    s_waitcnt lgkmcnt(3)
    v_pk_fma_f32 v[236:237], v[68:69], v[164:165], v[236:237]
    v_pk_fma_f32 v[238:239], v[70:71], v[166:167], v[238:239]
    s_waitcnt lgkmcnt(2)
    v_pk_fma_f32 v[240:241], v[72:73], v[168:169], v[240:241]
    v_pk_fma_f32 v[242:243], v[74:75], v[170:171], v[242:243]
    s_waitcnt lgkmcnt(1)
    v_pk_fma_f32 v[244:245], v[76:77], v[172:173], v[244:245]
    v_pk_fma_f32 v[246:247], v[78:79], v[174:175], v[246:247]
    s_waitcnt lgkmcnt(0)
    v_pk_fma_f32 v[248:249], v[80:81], v[176:177], v[248:249]
    v_pk_fma_f32 v[250:251], v[82:83], v[178:179], v[250:251]
    v_cvt_pk_bf16_f32 v100, v232, v233
    v_cvt_pk_bf16_f32 v101, v234, v235
    v_cvt_pk_bf16_f32 v102, v236, v237
    v_cvt_pk_bf16_f32 v103, v238, v239
    ds_write_b128 v19, v[100:103]
    v_cvt_pk_bf16_f32 v104, v240, v241
    v_cvt_pk_bf16_f32 v105, v242, v243
    v_cvt_pk_bf16_f32 v106, v244, v245
    v_cvt_pk_bf16_f32 v107, v246, v247
    ds_write_b128 v19, v[104:107] offset:64
    v_cvt_pk_bf16_f32 v108, v248, v249
    v_cvt_pk_bf16_f32 v109, v250, v251
    ds_write_b64 v20, v[108:109] offset:128
    s_waitcnt lgkmcnt(0)
    ds_read_b128 v[112:115], v17 offset:32768
    ds_read_b128 v[116:119], v17 offset:33792
    ds_read_b128 v[120:123], v17 offset:34816
    s_waitcnt lgkmcnt(2)
    buffer_store_dwordx4 v[112:115], v48, s[16:19], s82 offen
    s_waitcnt lgkmcnt(1)
    buffer_store_dwordx4 v[116:119], v49, s[16:19], s82 offen
    s_waitcnt lgkmcnt(0)
    buffer_store_dwordx4 v[120:123], v50, s[16:19], s82 offen
    s_or_b32 s50, s2, s3
    s_cmp_eq_u32 s50, 0
    s_cbranch_scc1 cold_80
coldr_81:
L_end:
    s_endpgm
cold_6:
    s_mov_b64 exec, 1048575
    s_mov_b32 s62, 0x20000
pm_8:
    v_mov_b32 v48, 0
    buffer_atomic_or v48, v252, s[8:11], s47 offen sc0 sc1
    s_sub_u32 s62, s62, 1
    s_cbranch_scc1 pme_9
    s_waitcnt vmcnt(0)
    v_cmp_ne_u32 vcc, s6, v48
    s_cbranch_vccnz pm_8
pme_9:
    s_waitcnt vmcnt(0)
    s_mov_b64 exec, -1
    s_branch coldr_7
cold_12:
    s_mov_b32 s62, 0x20000
mg_14:
    s_mov_b32 s63, 524288
    buffer_load_dwordx4 v[88:91], v164, s[8:11], s63 offen sc1
    s_mov_b32 s63, 555008
    buffer_load_dwordx4 v[92:95], v164, s[8:11], s63 offen sc1
    s_mov_b32 s63, 524288
    buffer_load_dwordx4 v[96:99], v165, s[8:11], s63 offen sc1
    s_mov_b32 s63, 555008
    buffer_load_dwordx4 v[100:103], v165, s[8:11], s63 offen sc1
    s_mov_b32 s63, 524288
    buffer_load_dwordx4 v[104:107], v166, s[8:11], s63 offen sc1
    s_mov_b32 s63, 555008
    buffer_load_dwordx4 v[108:111], v166, s[8:11], s63 offen sc1
    s_sub_u32 s62, s62, 1
    s_cbranch_scc1 mge_15
    s_waitcnt vmcnt(0)
    v_max_u32 v112, v89, v91
    v_min_u32 v89, v89, v91
    v_max3_u32 v112, v112, v93, v95
    v_min3_u32 v89, v89, v93, v95
    v_max3_u32 v112, v112, v97, v99
    v_min3_u32 v89, v89, v97, v99
    v_max3_u32 v112, v112, v101, v103
    v_min3_u32 v89, v89, v101, v103
    v_max3_u32 v112, v112, v105, v107
    v_min3_u32 v89, v89, v105, v107
    v_max3_u32 v112, v112, v109, v111
    v_min3_u32 v89, v89, v109, v111
    v_cmp_ne_u32 vcc, s6, v112
    v_cmp_ne_u32 s[60:61], s6, v89
    s_or_b64 vcc, vcc, s[60:61]
    s_cbranch_vccnz mg_14
mge_15:
    s_waitcnt vmcnt(0)
    s_branch coldr_13
cold_16:
    s_mov_b64 exec, 1073741823
    s_mov_b32 s62, 0x20000
pwq_18:
    v_mov_b32 v50, 0
    buffer_atomic_or v50, v252, s[8:11], s48 offen sc0 sc1
    s_sub_u32 s62, s62, 1
    s_cbranch_scc1 pwqe_19
    s_waitcnt vmcnt(0)
    v_cmp_ne_u32 vcc, s6, v50
    s_cbranch_vccnz pwq_18
pwqe_19:
    s_waitcnt vmcnt(0)
    s_mov_b64 exec, -1
    s_branch coldr_17
cold_21:
    s_cmp_ge_u32 s2, 216
    s_cselect_b32 s32, s68, s76
    s_cselect_b32 s33, s69, s77
    s_cselect_b32 s54, 96, 0
    s_cselect_b32 s57, 20, 48
    s_mov_b32 s58, 4718592
    s_cselect_b32 s58, 3670016, s58
    s_mov_b32 s59, 152576
    s_cselect_b32 s59, 151552, s59
    s_cselect_b32 s63, 7, 8
    s_mul_i32 s34, s57, 40960
    s_sub_u32 s54, s2, s54
    s_sub_u32 s54, s54, 120
    s_and_b32 s55, s54, 1
    s_lshr_b32 s54, s54, 1
    s_lshl_b32 s55, s55, 2
    s_add_u32 s55, s55, s3
    s_mul_i32 s64, s54, 40960
    s_mul_i32 s56, s55, 160
    s_add_u32 s64, s64, s56
    s_mov_b32 s66, 20480
    s_mov_b32 s67, 4294946880
    s_lshl_b32 s79, s55, s63
    s_add_u32 s79, s79, s59
    s_lshl_b32 s56, s54, 2
    s_add_u32 s79, s79, s56
    s_mul_hi_u32 s56, s54, 1431655766
    s_mul_i32 s59, s56, 3
    s_sub_u32 s59, s54, s59
    s_lshl_b32 s63, s59, 4
    s_add_u32 s63, s63, s56
    s_and_b32 s56, s63, 1
    s_lshl_b32 s56, s56, 12
    s_cmp_eq_u32 s57, 20
    s_cselect_b32 s63, s54, s63
    s_cselect_b32 s56, 0, s56
    s_cselect_b32 s71, 1, 2
    s_lshl_b32 s71, s71, 10
    s_mul_i32 s55, s55, s57
    s_add_u32 s55, s55, s63
    s_mul_i32 s55, s55, 5120
    s_sub_u32 s55, s55, s56
    s_add_u32 s70, s55, s58
    s_mov_b32 s78, 0
    v_mov_b32 v210, 0x80000000
    v_mul_u32_u24 v43, 1280, v43
    v_lshl_add_u32 v224, v42, 4, v43
    v_lshrrev_b32 v43, 4, v5
    v_lshl_add_u32 v41, v43, 3, v41
    v_lshl_add_u32 v41, v41, 6, s65
    v_lshl_add_u32 v225, v42, 4, v41
    v_add_u32 v211, 8, v225
    v_lshl_add_u32 v212, v42, 3, v41
    v_mov_b32 v226, 147456
    s_branch ssJ_20
cold_22:
    s_mov_b64 exec, 65535
    s_mov_b32 s62, 0x20000
ph_24:
    v_mov_b32 v16, 0
    buffer_atomic_or v16, v252, s[8:11], s91 offen sc0 sc1
    s_sub_u32 s62, s62, 1
    s_cbranch_scc1 phe_25
    s_waitcnt vmcnt(0)
    v_cmp_ne_u32 vcc, s6, v16
    s_cbranch_vccnz ph_24
phe_25:
    s_waitcnt vmcnt(0)
    s_mov_b64 exec, -1
    s_branch coldr_23
cold_28:
    s_mov_b32 s62, 0x20000
mg_30:
    s_mov_b32 s63, 534528
    buffer_load_dwordx4 v[232:235], v241, s[8:11], s63 offen sc1
    s_mov_b32 s63, 565248
    buffer_load_dwordx4 v[236:239], v241, s[8:11], s63 offen sc1
    s_sub_u32 s62, s62, 1
    s_cbranch_scc1 mge_31
    s_waitcnt vmcnt(0)
    v_max_u32 v240, v233, v235
    v_min_u32 v233, v233, v235
    v_max3_u32 v240, v240, v237, v239
    v_min3_u32 v233, v233, v237, v239
    v_cmp_ne_u32 vcc, s6, v240
    v_cmp_ne_u32 s[60:61], s6, v233
    s_or_b64 vcc, vcc, s[60:61]
    s_cbranch_vccnz mg_30
mge_31:
    s_waitcnt vmcnt(0)
    s_branch coldr_29
cold_32:
    s_mov_b32 exec_hi, 0
    s_mov_b32 s62, 0x20000
pkv_34:
    v_mov_b32 v215, 0
    buffer_atomic_or v215, v252, s[8:11], s86 offen sc0 sc1
    s_sub_u32 s62, s62, 1
    s_cbranch_scc1 pkve_35
    s_waitcnt vmcnt(0)
    v_cmp_ne_u32 vcc, s6, v215
    s_cbranch_vccnz pkv_34
pkve_35:
    s_waitcnt vmcnt(0)
    s_mov_b64 exec, -1
    s_branch coldr_33
cold_36:
    s_mov_b32 s62, 0x20000
pside_38:
    s_sleep 24
    buffer_load_dword v10, v213, s[8:11], 0 offen offset:0 sc1
    buffer_load_dword v11, v214, s[8:11], 0 offen offset:0 sc1
    s_sub_u32 s62, s62, 1
    s_cbranch_scc1 psidee_39
    s_waitcnt vmcnt(0)
    v_cmp_ne_u32 vcc, s6, v10
    v_cmp_ne_u32 s[60:61], s6, v11
    s_or_b64 vcc, vcc, s[60:61]
    s_cbranch_vccnz pside_38
psidee_39:
    s_waitcnt vmcnt(0)
    s_branch coldr_37
cold_40:
    s_mov_b32 exec_hi, 0
    s_mov_b32 s62, 0x20000
po_42:
    v_mov_b32 v88, 0
    buffer_atomic_or v88, v252, s[8:11], s77 offen sc0 sc1
    s_sub_u32 s62, s62, 1
    s_cbranch_scc1 poe_43
    s_waitcnt vmcnt(0)
    v_cmp_ne_u32 vcc, s6, v88
    s_cbranch_vccnz po_42
poe_43:
    s_waitcnt vmcnt(0)
    s_mov_b64 exec, -1
    s_branch coldr_41
cold_44:
    s_add_u32 s57, s77, 128
    s_mov_b32 exec_hi, 0
    s_mov_b32 s62, 0x20000
r3p_47:
    v_mov_b32 v23, 0
    buffer_atomic_or v23, v252, s[8:11], s57 offen sc0 sc1
    s_sub_u32 s62, s62, 1
    s_cbranch_scc1 r3pe_48
    s_waitcnt vmcnt(0)
    v_cmp_ne_u32 vcc, s6, v23
    s_cbranch_vccnz r3p_47
r3pe_48:
    s_waitcnt vmcnt(0)
    s_mov_b64 exec, -1
    s_mul_i32 s57, s40, 20480
    s_add_u32 s57, s57, 19398656
    s_mul_i32 s58, s41, 102400
    s_add_u32 s58, s58, 3670016
    s_mov_b32 s56, 4
    v_mov_b32 v64, 0
    v_mov_b32 v65, 0
    v_mov_b32 v66, 0
    v_mov_b32 v67, 0
    v_mov_b32 v68, 0
    v_mov_b32 v69, 0
    v_mov_b32 v70, 0
    v_mov_b32 v71, 0
    v_mov_b32 v72, 0
    v_mov_b32 v73, 0
    v_mov_b32 v74, 0
    v_mov_b32 v75, 0
    v_mov_b32 v76, 0
    v_mov_b32 v77, 0
    v_mov_b32 v78, 0
    v_mov_b32 v79, 0
    v_mov_b32 v80, 0
    v_mov_b32 v81, 0
    v_mov_b32 v82, 0
    v_mov_b32 v83, 0
r3_46:
    s_add_u32 s59, s58, 4096
    buffer_load_dwordx4 a[0:3], v1, s[8:11], s57 offen sc1
    buffer_load_dwordx4 a[4:7], v1, s[8:11], s58 offen offset:0 sc1
    buffer_load_dwordx4 a[8:11], v1, s[8:11], s58 offen offset:1024 sc1
    buffer_load_dwordx4 a[12:15], v1, s[8:11], s58 offen offset:2048 sc1
    buffer_load_dwordx4 a[16:19], v1, s[8:11], s58 offen offset:3072 sc1
    buffer_load_dwordx4 a[20:23], v1, s[8:11], s59 offen offset:0 sc1
    s_add_u32 s57, s57, 1024
    s_add_u32 s58, s58, 5120
    s_add_u32 s59, s58, 4096
    buffer_load_dwordx4 a[24:27], v1, s[8:11], s57 offen sc1
    buffer_load_dwordx4 a[28:31], v1, s[8:11], s58 offen offset:0 sc1
    buffer_load_dwordx4 a[32:35], v1, s[8:11], s58 offen offset:1024 sc1
    buffer_load_dwordx4 a[36:39], v1, s[8:11], s58 offen offset:2048 sc1
    buffer_load_dwordx4 a[40:43], v1, s[8:11], s58 offen offset:3072 sc1
    buffer_load_dwordx4 a[44:47], v1, s[8:11], s59 offen offset:0 sc1
    s_add_u32 s57, s57, 1024
    s_add_u32 s58, s58, 5120
    s_add_u32 s59, s58, 4096
    buffer_load_dwordx4 a[48:51], v1, s[8:11], s57 offen sc1
    buffer_load_dwordx4 a[52:55], v1, s[8:11], s58 offen offset:0 sc1
    buffer_load_dwordx4 a[56:59], v1, s[8:11], s58 offen offset:1024 sc1
    buffer_load_dwordx4 a[60:63], v1, s[8:11], s58 offen offset:2048 sc1
    buffer_load_dwordx4 a[64:67], v1, s[8:11], s58 offen offset:3072 sc1
    buffer_load_dwordx4 a[68:71], v1, s[8:11], s59 offen offset:0 sc1
    s_add_u32 s57, s57, 1024
    s_add_u32 s58, s58, 5120
    s_add_u32 s59, s58, 4096
    buffer_load_dwordx4 a[72:75], v1, s[8:11], s57 offen sc1
    buffer_load_dwordx4 a[76:79], v1, s[8:11], s58 offen offset:0 sc1
    buffer_load_dwordx4 a[80:83], v1, s[8:11], s58 offen offset:1024 sc1
    buffer_load_dwordx4 a[84:87], v1, s[8:11], s58 offen offset:2048 sc1
    buffer_load_dwordx4 a[88:91], v1, s[8:11], s58 offen offset:3072 sc1
    buffer_load_dwordx4 a[92:95], v1, s[8:11], s59 offen offset:0 sc1
    s_add_u32 s57, s57, 1024
    s_add_u32 s58, s58, 5120
    s_add_u32 s59, s58, 4096
    buffer_load_dwordx4 a[96:99], v1, s[8:11], s57 offen sc1
    buffer_load_dwordx4 a[100:103], v1, s[8:11], s58 offen offset:0 sc1
    buffer_load_dwordx4 a[104:107], v1, s[8:11], s58 offen offset:1024 sc1
    buffer_load_dwordx4 a[108:111], v1, s[8:11], s58 offen offset:2048 sc1
    buffer_load_dwordx4 a[112:115], v1, s[8:11], s58 offen offset:3072 sc1
    buffer_load_dwordx4 a[116:119], v1, s[8:11], s59 offen offset:0 sc1
    s_add_u32 s57, s57, 1024
    s_add_u32 s58, s58, 5120
    s_waitcnt vmcnt(24)
    v_mfma_f32_16x16x32_bf16 v[64:67], a[4:7], a[0:3], v[64:67]
    v_mfma_f32_16x16x32_bf16 v[68:71], a[8:11], a[0:3], v[68:71]
    v_mfma_f32_16x16x32_bf16 v[72:75], a[12:15], a[0:3], v[72:75]
    v_mfma_f32_16x16x32_bf16 v[76:79], a[16:19], a[0:3], v[76:79]
    v_mfma_f32_16x16x32_bf16 v[80:83], a[20:23], a[0:3], v[80:83]
    s_waitcnt vmcnt(18)
    v_mfma_f32_16x16x32_bf16 v[64:67], a[28:31], a[24:27], v[64:67]
    v_mfma_f32_16x16x32_bf16 v[68:71], a[32:35], a[24:27], v[68:71]
    v_mfma_f32_16x16x32_bf16 v[72:75], a[36:39], a[24:27], v[72:75]
    v_mfma_f32_16x16x32_bf16 v[76:79], a[40:43], a[24:27], v[76:79]
    v_mfma_f32_16x16x32_bf16 v[80:83], a[44:47], a[24:27], v[80:83]
    s_waitcnt vmcnt(12)
    v_mfma_f32_16x16x32_bf16 v[64:67], a[52:55], a[48:51], v[64:67]
    v_mfma_f32_16x16x32_bf16 v[68:71], a[56:59], a[48:51], v[68:71]
    v_mfma_f32_16x16x32_bf16 v[72:75], a[60:63], a[48:51], v[72:75]
    v_mfma_f32_16x16x32_bf16 v[76:79], a[64:67], a[48:51], v[76:79]
    v_mfma_f32_16x16x32_bf16 v[80:83], a[68:71], a[48:51], v[80:83]
    s_waitcnt vmcnt(6)
    v_mfma_f32_16x16x32_bf16 v[64:67], a[76:79], a[72:75], v[64:67]
    v_mfma_f32_16x16x32_bf16 v[68:71], a[80:83], a[72:75], v[68:71]
    v_mfma_f32_16x16x32_bf16 v[72:75], a[84:87], a[72:75], v[72:75]
    v_mfma_f32_16x16x32_bf16 v[76:79], a[88:91], a[72:75], v[76:79]
    v_mfma_f32_16x16x32_bf16 v[80:83], a[92:95], a[72:75], v[80:83]
    s_waitcnt vmcnt(0)
    v_mfma_f32_16x16x32_bf16 v[64:67], a[100:103], a[96:99], v[64:67]
    v_mfma_f32_16x16x32_bf16 v[68:71], a[104:107], a[96:99], v[68:71]
    v_mfma_f32_16x16x32_bf16 v[72:75], a[108:111], a[96:99], v[72:75]
    v_mfma_f32_16x16x32_bf16 v[76:79], a[112:115], a[96:99], v[76:79]
    v_mfma_f32_16x16x32_bf16 v[80:83], a[116:119], a[96:99], v[80:83]
    s_sub_u32 s56, s56, 1
    s_cmp_lg_u32 s56, 0
    s_cbranch_scc1 r3_46
    s_nop 7
    s_branch coldr_45
cold_49:
    s_mov_b64 exec, 65535
    s_mov_b32 s62, 0x20000
px1_51:
    v_mov_b32 v23, 0
    buffer_atomic_or v23, v252, s[8:11], s50 offen sc0 sc1
    s_sub_u32 s62, s62, 1
    s_cbranch_scc1 px1e_52
    s_waitcnt vmcnt(0)
    v_cmp_ne_u32 vcc, s6, v23
    s_cbranch_vccnz px1_51
px1e_52:
    s_waitcnt vmcnt(0)
    s_mov_b64 exec, -1
    s_branch coldr_50
cold_53:
    s_add_u32 s54, s50, 128
    s_mov_b64 exec, 65535
    s_mov_b32 s62, 0x20000
r4p_56:
    v_mov_b32 v23, 0
    buffer_atomic_or v23, v252, s[8:11], s54 offen sc0 sc1
    s_sub_u32 s62, s62, 1
    s_cbranch_scc1 r4pe_57
    s_waitcnt vmcnt(0)
    v_cmp_ne_u32 vcc, s6, v23
    s_cbranch_vccnz r4p_56
r4pe_57:
    s_waitcnt vmcnt(0)
    s_mov_b64 exec, -1
    s_mul_i32 s52, s7, 40960
    s_add_u32 s52, s52, 22020096
    s_mul_i32 s54, s5, 245760
    s_add_u32 s54, s54, 6815744
    buffer_load_dwordx4 v[200:203], v222, s[8:11], s51 offen offset:0 sc1
    buffer_load_dwordx4 v[204:207], v222, s[8:11], s51 offen offset:16 sc1
    buffer_load_dwordx4 a[0:3], v1, s[8:11], s52 offen sc1
    buffer_load_dwordx4 a[160:163], v1, s[8:11], s54 offen offset:0 sc1
    buffer_load_dwordx4 a[164:167], v1, s[8:11], s54 offen offset:1024 sc1
    buffer_load_dwordx4 a[168:171], v1, s[8:11], s54 offen offset:2048 sc1
    s_add_u32 s52, s52, 1024
    s_add_u32 s54, s54, 3072
    buffer_load_dwordx4 a[4:7], v1, s[8:11], s52 offen sc1
    buffer_load_dwordx4 a[172:175], v1, s[8:11], s54 offen offset:0 sc1
    buffer_load_dwordx4 a[176:179], v1, s[8:11], s54 offen offset:1024 sc1
    buffer_load_dwordx4 a[180:183], v1, s[8:11], s54 offen offset:2048 sc1
    s_add_u32 s52, s52, 1024
    s_add_u32 s54, s54, 3072
    buffer_load_dwordx4 a[8:11], v1, s[8:11], s52 offen sc1
    buffer_load_dwordx4 a[184:187], v1, s[8:11], s54 offen offset:0 sc1
    buffer_load_dwordx4 a[188:191], v1, s[8:11], s54 offen offset:1024 sc1
    buffer_load_dwordx4 a[192:195], v1, s[8:11], s54 offen offset:2048 sc1
    s_add_u32 s52, s52, 1024
    s_add_u32 s54, s54, 3072
    buffer_load_dwordx4 a[12:15], v1, s[8:11], s52 offen sc1
    buffer_load_dwordx4 a[196:199], v1, s[8:11], s54 offen offset:0 sc1
    buffer_load_dwordx4 a[200:203], v1, s[8:11], s54 offen offset:1024 sc1
    buffer_load_dwordx4 a[204:207], v1, s[8:11], s54 offen offset:2048 sc1
    s_add_u32 s52, s52, 1024
    s_add_u32 s54, s54, 3072
    buffer_load_dwordx4 a[16:19], v1, s[8:11], s52 offen sc1
    buffer_load_dwordx4 a[208:211], v1, s[8:11], s54 offen offset:0 sc1
    buffer_load_dwordx4 a[212:215], v1, s[8:11], s54 offen offset:1024 sc1
    buffer_load_dwordx4 a[216:219], v1, s[8:11], s54 offen offset:2048 sc1
    s_add_u32 s52, s52, 1024
    s_add_u32 s54, s54, 3072
    buffer_load_dwordx4 a[20:23], v1, s[8:11], s52 offen sc1
    buffer_load_dwordx4 a[220:223], v1, s[8:11], s54 offen offset:0 sc1
    buffer_load_dwordx4 a[224:227], v1, s[8:11], s54 offen offset:1024 sc1
    buffer_load_dwordx4 a[228:231], v1, s[8:11], s54 offen offset:2048 sc1
    s_add_u32 s52, s52, 1024
    s_add_u32 s54, s54, 3072
    buffer_load_dwordx4 a[24:27], v1, s[8:11], s52 offen sc1
    buffer_load_dwordx4 a[232:235], v1, s[8:11], s54 offen offset:0 sc1
    buffer_load_dwordx4 a[236:239], v1, s[8:11], s54 offen offset:1024 sc1
    buffer_load_dwordx4 a[240:243], v1, s[8:11], s54 offen offset:2048 sc1
    s_add_u32 s52, s52, 1024
    s_add_u32 s54, s54, 3072
    buffer_load_dwordx4 a[28:31], v1, s[8:11], s52 offen sc1
    buffer_load_dwordx4 a[244:247], v1, s[8:11], s54 offen offset:0 sc1
    buffer_load_dwordx4 a[248:251], v1, s[8:11], s54 offen offset:1024 sc1
    buffer_load_dwordx4 a[252:255], v1, s[8:11], s54 offen offset:2048 sc1
    s_add_u32 s52, s52, 1024
    s_add_u32 s54, s54, 3072
    s_waitcnt vmcnt(32)
    v_add_f32 v200, v200, v202
    v_add_f32 v201, v201, v203
    v_add_f32 v204, v204, v206
    v_add_f32 v205, v205, v207
    v_add_f32 v200, v200, v204
    v_add_f32 v201, v201, v205
    v_mov_b32 v202, v200
    v_mov_b32 v203, v201
    v_mov_b32 v187, 0
    v_permlane32_swap_b32 v200, v202
    v_permlane32_swap_b32 v201, v203
    v_add_f32 v200, v200, v202
    v_add_f32 v201, v201, v203
    v_mul_f32 v200, 0xbacccccd, v200
    v_mul_f32 v201, 0x3acccccd, v201
    v_fma_f32 v201, -v200, v200, v201
    v_fma_f32 v200, v201, 0, v200
    v_max_f32 v201, 0, v201
    v_add_f32 v194, 0x3727c5ac, v201
    v_rsq_f32 v202, v194
    s_nop 0
    v_mul_f32 v201, v194, v202
    v_cvt_pk_bf16_f32 v185, v200, v201
    v_lshlrev_b32 v204, 16, v185
    v_and_b32 v205, 0xffff0000, v185
    v_sub_f32 v204, v200, v204
    v_sub_f32 v205, v201, v205
    v_cvt_pk_bf16_f32 v184, v200, v204
    v_cvt_pk_bf16_f32 v186, v205, v201
    v_mul_f32 v190, 0xc0135761, v202
    v_mul_f32 v203, v202, v202
    v_mul_f32 v192, 0x3d372713, v203
    v_mul_f32 v192, v192, v190
    s_waitcnt vmcnt(28)
    v_mfma_f32_32x32x16_bf16 v[64:79], a[160:163], a[0:3], 0
    v_mfma_f32_32x32x16_bf16 v[80:95], a[164:167], a[0:3], 0
    v_mfma_f32_32x32x16_bf16 v[96:111], a[168:171], a[0:3], 0
    buffer_load_dwordx4 a[32:35], v1, s[8:11], s52 offen sc1
    buffer_load_dwordx4 a[160:163], v1, s[8:11], s54 offen offset:0 sc1
    buffer_load_dwordx4 a[164:167], v1, s[8:11], s54 offen offset:1024 sc1
    buffer_load_dwordx4 a[168:171], v1, s[8:11], s54 offen offset:2048 sc1
    s_add_u32 s52, s52, 1024
    s_add_u32 s54, s54, 3072
    s_waitcnt vmcnt(28)
    v_mfma_f32_32x32x16_bf16 v[64:79], a[172:175], a[4:7], v[64:79]
    v_mfma_f32_32x32x16_bf16 v[80:95], a[176:179], a[4:7], v[80:95]
    v_mfma_f32_32x32x16_bf16 v[96:111], a[180:183], a[4:7], v[96:111]
    buffer_load_dwordx4 a[36:39], v1, s[8:11], s52 offen sc1
    buffer_load_dwordx4 a[172:175], v1, s[8:11], s54 offen offset:0 sc1
    buffer_load_dwordx4 a[176:179], v1, s[8:11], s54 offen offset:1024 sc1
    buffer_load_dwordx4 a[180:183], v1, s[8:11], s54 offen offset:2048 sc1
    s_add_u32 s52, s52, 1024
    s_add_u32 s54, s54, 3072
    s_waitcnt vmcnt(28)
    v_mfma_f32_32x32x16_bf16 v[64:79], a[184:187], a[8:11], v[64:79]
    v_mfma_f32_32x32x16_bf16 v[80:95], a[188:191], a[8:11], v[80:95]
    v_mfma_f32_32x32x16_bf16 v[96:111], a[192:195], a[8:11], v[96:111]
    buffer_load_dwordx4 a[40:43], v1, s[8:11], s52 offen sc1
    buffer_load_dwordx4 a[184:187], v1, s[8:11], s54 offen offset:0 sc1
    buffer_load_dwordx4 a[188:191], v1, s[8:11], s54 offen offset:1024 sc1
    buffer_load_dwordx4 a[192:195], v1, s[8:11], s54 offen offset:2048 sc1
    s_add_u32 s52, s52, 1024
    s_add_u32 s54, s54, 3072
    s_waitcnt vmcnt(28)
    v_mfma_f32_32x32x16_bf16 v[64:79], a[196:199], a[12:15], v[64:79]
    v_mfma_f32_32x32x16_bf16 v[80:95], a[200:203], a[12:15], v[80:95]
    v_mfma_f32_32x32x16_bf16 v[96:111], a[204:207], a[12:15], v[96:111]
    buffer_load_dwordx4 a[44:47], v1, s[8:11], s52 offen sc1
    buffer_load_dwordx4 a[196:199], v1, s[8:11], s54 offen offset:0 sc1
    buffer_load_dwordx4 a[200:203], v1, s[8:11], s54 offen offset:1024 sc1
    buffer_load_dwordx4 a[204:207], v1, s[8:11], s54 offen offset:2048 sc1
    s_add_u32 s52, s52, 1024
    s_add_u32 s54, s54, 3072
    s_waitcnt vmcnt(28)
    v_mfma_f32_32x32x16_bf16 v[64:79], a[208:211], a[16:19], v[64:79]
    v_mfma_f32_32x32x16_bf16 v[80:95], a[212:215], a[16:19], v[80:95]
    v_mfma_f32_32x32x16_bf16 v[96:111], a[216:219], a[16:19], v[96:111]
    buffer_load_dwordx4 a[48:51], v1, s[8:11], s52 offen sc1
    buffer_load_dwordx4 a[208:211], v1, s[8:11], s54 offen offset:0 sc1
    buffer_load_dwordx4 a[212:215], v1, s[8:11], s54 offen offset:1024 sc1
    buffer_load_dwordx4 a[216:219], v1, s[8:11], s54 offen offset:2048 sc1
    s_add_u32 s52, s52, 1024
    s_add_u32 s54, s54, 3072
    s_waitcnt vmcnt(28)
    v_mfma_f32_32x32x16_bf16 v[64:79], a[220:223], a[20:23], v[64:79]
    v_mfma_f32_32x32x16_bf16 v[80:95], a[224:227], a[20:23], v[80:95]
    v_mfma_f32_32x32x16_bf16 v[96:111], a[228:231], a[20:23], v[96:111]
    buffer_load_dwordx4 a[52:55], v1, s[8:11], s52 offen sc1
    buffer_load_dwordx4 a[220:223], v1, s[8:11], s54 offen offset:0 sc1
    buffer_load_dwordx4 a[224:227], v1, s[8:11], s54 offen offset:1024 sc1
    buffer_load_dwordx4 a[228:231], v1, s[8:11], s54 offen offset:2048 sc1
    s_add_u32 s52, s52, 1024
    s_add_u32 s54, s54, 3072
    s_waitcnt vmcnt(28)
    v_mfma_f32_32x32x16_bf16 v[64:79], a[232:235], a[24:27], v[64:79]
    v_mfma_f32_32x32x16_bf16 v[80:95], a[236:239], a[24:27], v[80:95]
    v_mfma_f32_32x32x16_bf16 v[96:111], a[240:243], a[24:27], v[96:111]
    buffer_load_dwordx4 a[56:59], v1, s[8:11], s52 offen sc1
    buffer_load_dwordx4 a[232:235], v1, s[8:11], s54 offen offset:0 sc1
    buffer_load_dwordx4 a[236:239], v1, s[8:11], s54 offen offset:1024 sc1
    buffer_load_dwordx4 a[240:243], v1, s[8:11], s54 offen offset:2048 sc1
    s_add_u32 s52, s52, 1024
    s_add_u32 s54, s54, 3072
    s_waitcnt vmcnt(28)
    v_mfma_f32_32x32x16_bf16 v[64:79], a[244:247], a[28:31], v[64:79]
    v_mfma_f32_32x32x16_bf16 v[80:95], a[248:251], a[28:31], v[80:95]
    v_mfma_f32_32x32x16_bf16 v[96:111], a[252:255], a[28:31], v[96:111]
    buffer_load_dwordx4 a[60:63], v1, s[8:11], s52 offen sc1
    buffer_load_dwordx4 a[244:247], v1, s[8:11], s54 offen offset:0 sc1
    buffer_load_dwordx4 a[248:251], v1, s[8:11], s54 offen offset:1024 sc1
    buffer_load_dwordx4 a[252:255], v1, s[8:11], s54 offen offset:2048 sc1
    s_add_u32 s52, s52, 1024
    s_add_u32 s54, s54, 3072
    s_waitcnt vmcnt(28)
    v_mfma_f32_32x32x16_bf16 v[64:79], a[160:163], a[32:35], v[64:79]
    v_mfma_f32_32x32x16_bf16 v[80:95], a[164:167], a[32:35], v[80:95]
    v_mfma_f32_32x32x16_bf16 v[96:111], a[168:171], a[32:35], v[96:111]
    buffer_load_dwordx4 a[64:67], v1, s[8:11], s52 offen sc1
    buffer_load_dwordx4 a[160:163], v1, s[8:11], s54 offen offset:0 sc1
    buffer_load_dwordx4 a[164:167], v1, s[8:11], s54 offen offset:1024 sc1
    buffer_load_dwordx4 a[168:171], v1, s[8:11], s54 offen offset:2048 sc1
    s_add_u32 s52, s52, 1024
    s_add_u32 s54, s54, 3072
    s_waitcnt vmcnt(28)
    v_mfma_f32_32x32x16_bf16 v[64:79], a[172:175], a[36:39], v[64:79]
    v_mfma_f32_32x32x16_bf16 v[80:95], a[176:179], a[36:39], v[80:95]
    v_mfma_f32_32x32x16_bf16 v[96:111], a[180:183], a[36:39], v[96:111]
    buffer_load_dwordx4 a[68:71], v1, s[8:11], s52 offen sc1
    buffer_load_dwordx4 a[172:175], v1, s[8:11], s54 offen offset:0 sc1
    buffer_load_dwordx4 a[176:179], v1, s[8:11], s54 offen offset:1024 sc1
    buffer_load_dwordx4 a[180:183], v1, s[8:11], s54 offen offset:2048 sc1
    s_add_u32 s52, s52, 1024
    s_add_u32 s54, s54, 3072
    s_waitcnt vmcnt(28)
    v_mfma_f32_32x32x16_bf16 v[64:79], a[184:187], a[40:43], v[64:79]
    v_mfma_f32_32x32x16_bf16 v[80:95], a[188:191], a[40:43], v[80:95]
    v_mfma_f32_32x32x16_bf16 v[96:111], a[192:195], a[40:43], v[96:111]
    buffer_load_dwordx4 a[72:75], v1, s[8:11], s52 offen sc1
    buffer_load_dwordx4 a[184:187], v1, s[8:11], s54 offen offset:0 sc1
    buffer_load_dwordx4 a[188:191], v1, s[8:11], s54 offen offset:1024 sc1
    buffer_load_dwordx4 a[192:195], v1, s[8:11], s54 offen offset:2048 sc1
    s_add_u32 s52, s52, 1024
    s_add_u32 s54, s54, 3072
    s_waitcnt vmcnt(28)
    v_mfma_f32_32x32x16_bf16 v[64:79], a[196:199], a[44:47], v[64:79]
    v_mfma_f32_32x32x16_bf16 v[80:95], a[200:203], a[44:47], v[80:95]
    v_mfma_f32_32x32x16_bf16 v[96:111], a[204:207], a[44:47], v[96:111]
    buffer_load_dwordx4 a[76:79], v1, s[8:11], s52 offen sc1
    buffer_load_dwordx4 a[196:199], v1, s[8:11], s54 offen offset:0 sc1
    buffer_load_dwordx4 a[200:203], v1, s[8:11], s54 offen offset:1024 sc1
    buffer_load_dwordx4 a[204:207], v1, s[8:11], s54 offen offset:2048 sc1
    s_add_u32 s52, s52, 1024
    s_add_u32 s54, s54, 3072
    s_waitcnt vmcnt(28)
    v_mfma_f32_32x32x16_bf16 v[64:79], a[208:211], a[48:51], v[64:79]
    v_mfma_f32_32x32x16_bf16 v[80:95], a[212:215], a[48:51], v[80:95]
    v_mfma_f32_32x32x16_bf16 v[96:111], a[216:219], a[48:51], v[96:111]
    buffer_load_dwordx4 a[80:83], v1, s[8:11], s52 offen sc1
    buffer_load_dwordx4 a[208:211], v1, s[8:11], s54 offen offset:0 sc1
    buffer_load_dwordx4 a[212:215], v1, s[8:11], s54 offen offset:1024 sc1
    buffer_load_dwordx4 a[216:219], v1, s[8:11], s54 offen offset:2048 sc1
    s_add_u32 s52, s52, 1024
    s_add_u32 s54, s54, 3072
    s_waitcnt vmcnt(28)
    v_mfma_f32_32x32x16_bf16 v[64:79], a[220:223], a[52:55], v[64:79]
    v_mfma_f32_32x32x16_bf16 v[80:95], a[224:227], a[52:55], v[80:95]
    v_mfma_f32_32x32x16_bf16 v[96:111], a[228:231], a[52:55], v[96:111]
    buffer_load_dwordx4 a[84:87], v1, s[8:11], s52 offen sc1
    buffer_load_dwordx4 a[220:223], v1, s[8:11], s54 offen offset:0 sc1
    buffer_load_dwordx4 a[224:227], v1, s[8:11], s54 offen offset:1024 sc1
    buffer_load_dwordx4 a[228:231], v1, s[8:11], s54 offen offset:2048 sc1
    s_add_u32 s52, s52, 1024
    s_add_u32 s54, s54, 3072
    s_waitcnt vmcnt(28)
    v_mfma_f32_32x32x16_bf16 v[64:79], a[232:235], a[56:59], v[64:79]
    v_mfma_f32_32x32x16_bf16 v[80:95], a[236:239], a[56:59], v[80:95]
    v_mfma_f32_32x32x16_bf16 v[96:111], a[240:243], a[56:59], v[96:111]
    buffer_load_dwordx4 a[88:91], v1, s[8:11], s52 offen sc1
    buffer_load_dwordx4 a[232:235], v1, s[8:11], s54 offen offset:0 sc1
    buffer_load_dwordx4 a[236:239], v1, s[8:11], s54 offen offset:1024 sc1
    buffer_load_dwordx4 a[240:243], v1, s[8:11], s54 offen offset:2048 sc1
    s_add_u32 s52, s52, 1024
    s_add_u32 s54, s54, 3072
    s_waitcnt vmcnt(28)
    v_mfma_f32_32x32x16_bf16 v[64:79], a[244:247], a[60:63], v[64:79]
    v_mfma_f32_32x32x16_bf16 v[80:95], a[248:251], a[60:63], v[80:95]
    v_mfma_f32_32x32x16_bf16 v[96:111], a[252:255], a[60:63], v[96:111]
    buffer_load_dwordx4 a[92:95], v1, s[8:11], s52 offen sc1
    buffer_load_dwordx4 a[244:247], v1, s[8:11], s54 offen offset:0 sc1
    buffer_load_dwordx4 a[248:251], v1, s[8:11], s54 offen offset:1024 sc1
    buffer_load_dwordx4 a[252:255], v1, s[8:11], s54 offen offset:2048 sc1
    s_add_u32 s52, s52, 1024
    s_add_u32 s54, s54, 3072
    s_waitcnt vmcnt(28)
    v_mfma_f32_32x32x16_bf16 v[64:79], a[160:163], a[64:67], v[64:79]
    v_mfma_f32_32x32x16_bf16 v[80:95], a[164:167], a[64:67], v[80:95]
    v_mfma_f32_32x32x16_bf16 v[96:111], a[168:171], a[64:67], v[96:111]
    buffer_load_dwordx4 a[96:99], v1, s[8:11], s52 offen sc1
    buffer_load_dwordx4 a[160:163], v1, s[8:11], s54 offen offset:0 sc1
    buffer_load_dwordx4 a[164:167], v1, s[8:11], s54 offen offset:1024 sc1
    buffer_load_dwordx4 a[168:171], v1, s[8:11], s54 offen offset:2048 sc1
    s_add_u32 s52, s52, 1024
    s_add_u32 s54, s54, 3072
    s_waitcnt vmcnt(28)
    v_mfma_f32_32x32x16_bf16 v[64:79], a[172:175], a[68:71], v[64:79]
    v_mfma_f32_32x32x16_bf16 v[80:95], a[176:179], a[68:71], v[80:95]
    v_mfma_f32_32x32x16_bf16 v[96:111], a[180:183], a[68:71], v[96:111]
    buffer_load_dwordx4 a[100:103], v1, s[8:11], s52 offen sc1
    buffer_load_dwordx4 a[172:175], v1, s[8:11], s54 offen offset:0 sc1
    buffer_load_dwordx4 a[176:179], v1, s[8:11], s54 offen offset:1024 sc1
    buffer_load_dwordx4 a[180:183], v1, s[8:11], s54 offen offset:2048 sc1
    s_add_u32 s52, s52, 1024
    s_add_u32 s54, s54, 3072
    s_waitcnt vmcnt(28)
    v_mfma_f32_32x32x16_bf16 v[64:79], a[184:187], a[72:75], v[64:79]
    v_mfma_f32_32x32x16_bf16 v[80:95], a[188:191], a[72:75], v[80:95]
    v_mfma_f32_32x32x16_bf16 v[96:111], a[192:195], a[72:75], v[96:111]
    buffer_load_dwordx4 a[104:107], v1, s[8:11], s52 offen sc1
    buffer_load_dwordx4 a[184:187], v1, s[8:11], s54 offen offset:0 sc1
    buffer_load_dwordx4 a[188:191], v1, s[8:11], s54 offen offset:1024 sc1
    buffer_load_dwordx4 a[192:195], v1, s[8:11], s54 offen offset:2048 sc1
    s_add_u32 s52, s52, 1024
    s_add_u32 s54, s54, 3072
    s_waitcnt vmcnt(28)
    v_mfma_f32_32x32x16_bf16 v[64:79], a[196:199], a[76:79], v[64:79]
    v_mfma_f32_32x32x16_bf16 v[80:95], a[200:203], a[76:79], v[80:95]
    v_mfma_f32_32x32x16_bf16 v[96:111], a[204:207], a[76:79], v[96:111]
    buffer_load_dwordx4 a[108:111], v1, s[8:11], s52 offen sc1
    buffer_load_dwordx4 a[196:199], v1, s[8:11], s54 offen offset:0 sc1
    buffer_load_dwordx4 a[200:203], v1, s[8:11], s54 offen offset:1024 sc1
    buffer_load_dwordx4 a[204:207], v1, s[8:11], s54 offen offset:2048 sc1
    s_add_u32 s52, s52, 1024
    s_add_u32 s54, s54, 3072
    s_waitcnt vmcnt(28)
    v_mfma_f32_32x32x16_bf16 v[64:79], a[208:211], a[80:83], v[64:79]
    v_mfma_f32_32x32x16_bf16 v[80:95], a[212:215], a[80:83], v[80:95]
    v_mfma_f32_32x32x16_bf16 v[96:111], a[216:219], a[80:83], v[96:111]
    buffer_load_dwordx4 a[112:115], v1, s[8:11], s52 offen sc1
    buffer_load_dwordx4 a[208:211], v1, s[8:11], s54 offen offset:0 sc1
    buffer_load_dwordx4 a[212:215], v1, s[8:11], s54 offen offset:1024 sc1
    buffer_load_dwordx4 a[216:219], v1, s[8:11], s54 offen offset:2048 sc1
    s_add_u32 s52, s52, 1024
    s_add_u32 s54, s54, 3072
    s_waitcnt vmcnt(28)
    v_mfma_f32_32x32x16_bf16 v[64:79], a[220:223], a[84:87], v[64:79]
    v_mfma_f32_32x32x16_bf16 v[80:95], a[224:227], a[84:87], v[80:95]
    v_mfma_f32_32x32x16_bf16 v[96:111], a[228:231], a[84:87], v[96:111]
    buffer_load_dwordx4 a[116:119], v1, s[8:11], s52 offen sc1
    buffer_load_dwordx4 a[220:223], v1, s[8:11], s54 offen offset:0 sc1
    buffer_load_dwordx4 a[224:227], v1, s[8:11], s54 offen offset:1024 sc1
    buffer_load_dwordx4 a[228:231], v1, s[8:11], s54 offen offset:2048 sc1
    s_add_u32 s52, s52, 1024
    s_add_u32 s54, s54, 3072
    s_waitcnt vmcnt(28)
    v_mfma_f32_32x32x16_bf16 v[64:79], a[232:235], a[88:91], v[64:79]
    v_mfma_f32_32x32x16_bf16 v[80:95], a[236:239], a[88:91], v[80:95]
    v_mfma_f32_32x32x16_bf16 v[96:111], a[240:243], a[88:91], v[96:111]
    buffer_load_dwordx4 a[120:123], v1, s[8:11], s52 offen sc1
    buffer_load_dwordx4 a[232:235], v1, s[8:11], s54 offen offset:0 sc1
    buffer_load_dwordx4 a[236:239], v1, s[8:11], s54 offen offset:1024 sc1
    buffer_load_dwordx4 a[240:243], v1, s[8:11], s54 offen offset:2048 sc1
    s_add_u32 s52, s52, 1024
    s_add_u32 s54, s54, 3072
    s_waitcnt vmcnt(28)
    v_mfma_f32_32x32x16_bf16 v[64:79], a[244:247], a[92:95], v[64:79]
    v_mfma_f32_32x32x16_bf16 v[80:95], a[248:251], a[92:95], v[80:95]
    v_mfma_f32_32x32x16_bf16 v[96:111], a[252:255], a[92:95], v[96:111]
    buffer_load_dwordx4 a[124:127], v1, s[8:11], s52 offen sc1
    buffer_load_dwordx4 a[244:247], v1, s[8:11], s54 offen offset:0 sc1
    buffer_load_dwordx4 a[248:251], v1, s[8:11], s54 offen offset:1024 sc1
    buffer_load_dwordx4 a[252:255], v1, s[8:11], s54 offen offset:2048 sc1
    s_add_u32 s52, s52, 1024
    s_add_u32 s54, s54, 3072
    s_waitcnt vmcnt(28)
    v_mfma_f32_32x32x16_bf16 v[64:79], a[160:163], a[96:99], v[64:79]
    v_mfma_f32_32x32x16_bf16 v[80:95], a[164:167], a[96:99], v[80:95]
    v_mfma_f32_32x32x16_bf16 v[96:111], a[168:171], a[96:99], v[96:111]
    buffer_load_dwordx4 a[128:131], v1, s[8:11], s52 offen sc1
    buffer_load_dwordx4 a[160:163], v1, s[8:11], s54 offen offset:0 sc1
    buffer_load_dwordx4 a[164:167], v1, s[8:11], s54 offen offset:1024 sc1
    buffer_load_dwordx4 a[168:171], v1, s[8:11], s54 offen offset:2048 sc1
    s_add_u32 s52, s52, 1024
    s_add_u32 s54, s54, 3072
    s_waitcnt vmcnt(28)
    v_mfma_f32_32x32x16_bf16 v[64:79], a[172:175], a[100:103], v[64:79]
    v_mfma_f32_32x32x16_bf16 v[80:95], a[176:179], a[100:103], v[80:95]
    v_mfma_f32_32x32x16_bf16 v[96:111], a[180:183], a[100:103], v[96:111]
    buffer_load_dwordx4 a[132:135], v1, s[8:11], s52 offen sc1
    buffer_load_dwordx4 a[172:175], v1, s[8:11], s54 offen offset:0 sc1
    buffer_load_dwordx4 a[176:179], v1, s[8:11], s54 offen offset:1024 sc1
    buffer_load_dwordx4 a[180:183], v1, s[8:11], s54 offen offset:2048 sc1
    s_add_u32 s52, s52, 1024
    s_add_u32 s54, s54, 3072
    s_waitcnt vmcnt(28)
    v_mfma_f32_32x32x16_bf16 v[64:79], a[184:187], a[104:107], v[64:79]
    v_mfma_f32_32x32x16_bf16 v[80:95], a[188:191], a[104:107], v[80:95]
    v_mfma_f32_32x32x16_bf16 v[96:111], a[192:195], a[104:107], v[96:111]
    buffer_load_dwordx4 a[136:139], v1, s[8:11], s52 offen sc1
    buffer_load_dwordx4 a[184:187], v1, s[8:11], s54 offen offset:0 sc1
    buffer_load_dwordx4 a[188:191], v1, s[8:11], s54 offen offset:1024 sc1
    buffer_load_dwordx4 a[192:195], v1, s[8:11], s54 offen offset:2048 sc1
    s_add_u32 s52, s52, 1024
    s_add_u32 s54, s54, 3072
    s_waitcnt vmcnt(28)
    v_mfma_f32_32x32x16_bf16 v[64:79], a[196:199], a[108:111], v[64:79]
    v_mfma_f32_32x32x16_bf16 v[80:95], a[200:203], a[108:111], v[80:95]
    v_mfma_f32_32x32x16_bf16 v[96:111], a[204:207], a[108:111], v[96:111]
    buffer_load_dwordx4 a[140:143], v1, s[8:11], s52 offen sc1
    buffer_load_dwordx4 a[196:199], v1, s[8:11], s54 offen offset:0 sc1
    buffer_load_dwordx4 a[200:203], v1, s[8:11], s54 offen offset:1024 sc1
    buffer_load_dwordx4 a[204:207], v1, s[8:11], s54 offen offset:2048 sc1
    s_add_u32 s52, s52, 1024
    s_add_u32 s54, s54, 3072
    s_waitcnt vmcnt(28)
    v_mfma_f32_32x32x16_bf16 v[64:79], a[208:211], a[112:115], v[64:79]
    v_mfma_f32_32x32x16_bf16 v[80:95], a[212:215], a[112:115], v[80:95]
    v_mfma_f32_32x32x16_bf16 v[96:111], a[216:219], a[112:115], v[96:111]
    buffer_load_dwordx4 a[144:147], v1, s[8:11], s52 offen sc1
    buffer_load_dwordx4 a[208:211], v1, s[8:11], s54 offen offset:0 sc1
    buffer_load_dwordx4 a[212:215], v1, s[8:11], s54 offen offset:1024 sc1
    buffer_load_dwordx4 a[216:219], v1, s[8:11], s54 offen offset:2048 sc1
    s_add_u32 s52, s52, 1024
    s_add_u32 s54, s54, 3072
    s_waitcnt vmcnt(28)
    v_mfma_f32_32x32x16_bf16 v[64:79], a[220:223], a[116:119], v[64:79]
    v_mfma_f32_32x32x16_bf16 v[80:95], a[224:227], a[116:119], v[80:95]
    v_mfma_f32_32x32x16_bf16 v[96:111], a[228:231], a[116:119], v[96:111]
    buffer_load_dwordx4 a[148:151], v1, s[8:11], s52 offen sc1
    buffer_load_dwordx4 a[220:223], v1, s[8:11], s54 offen offset:0 sc1
    buffer_load_dwordx4 a[224:227], v1, s[8:11], s54 offen offset:1024 sc1
    buffer_load_dwordx4 a[228:231], v1, s[8:11], s54 offen offset:2048 sc1
    s_add_u32 s52, s52, 1024
    s_add_u32 s54, s54, 3072
    s_waitcnt vmcnt(28)
    v_mfma_f32_32x32x16_bf16 v[64:79], a[232:235], a[120:123], v[64:79]
    v_mfma_f32_32x32x16_bf16 v[80:95], a[236:239], a[120:123], v[80:95]
    v_mfma_f32_32x32x16_bf16 v[96:111], a[240:243], a[120:123], v[96:111]
    buffer_load_dwordx4 a[152:155], v1, s[8:11], s52 offen sc1
    buffer_load_dwordx4 a[232:235], v1, s[8:11], s54 offen offset:0 sc1
    buffer_load_dwordx4 a[236:239], v1, s[8:11], s54 offen offset:1024 sc1
    buffer_load_dwordx4 a[240:243], v1, s[8:11], s54 offen offset:2048 sc1
    s_add_u32 s52, s52, 1024
    s_add_u32 s54, s54, 3072
    s_waitcnt vmcnt(28)
    v_mfma_f32_32x32x16_bf16 v[64:79], a[244:247], a[124:127], v[64:79]
    v_mfma_f32_32x32x16_bf16 v[80:95], a[248:251], a[124:127], v[80:95]
    v_mfma_f32_32x32x16_bf16 v[96:111], a[252:255], a[124:127], v[96:111]
    buffer_load_dwordx4 a[156:159], v1, s[8:11], s52 offen sc1
    buffer_load_dwordx4 a[244:247], v1, s[8:11], s54 offen offset:0 sc1
    buffer_load_dwordx4 a[248:251], v1, s[8:11], s54 offen offset:1024 sc1
    buffer_load_dwordx4 a[252:255], v1, s[8:11], s54 offen offset:2048 sc1
    s_add_u32 s52, s52, 1024
    s_add_u32 s54, s54, 3072
    s_waitcnt vmcnt(28)
    v_mfma_f32_32x32x16_bf16 v[64:79], a[160:163], a[128:131], v[64:79]
    v_mfma_f32_32x32x16_bf16 v[80:95], a[164:167], a[128:131], v[80:95]
    v_mfma_f32_32x32x16_bf16 v[96:111], a[168:171], a[128:131], v[96:111]
    s_waitcnt vmcnt(24)
    v_mfma_f32_32x32x16_bf16 v[64:79], a[172:175], a[132:135], v[64:79]
    v_mfma_f32_32x32x16_bf16 v[80:95], a[176:179], a[132:135], v[80:95]
    v_mfma_f32_32x32x16_bf16 v[96:111], a[180:183], a[132:135], v[96:111]
    s_waitcnt vmcnt(20)
    v_mfma_f32_32x32x16_bf16 v[64:79], a[184:187], a[136:139], v[64:79]
    v_mfma_f32_32x32x16_bf16 v[80:95], a[188:191], a[136:139], v[80:95]
    v_mfma_f32_32x32x16_bf16 v[96:111], a[192:195], a[136:139], v[96:111]
    s_waitcnt vmcnt(16)
    v_mfma_f32_32x32x16_bf16 v[64:79], a[196:199], a[140:143], v[64:79]
    v_mfma_f32_32x32x16_bf16 v[80:95], a[200:203], a[140:143], v[80:95]
    v_mfma_f32_32x32x16_bf16 v[96:111], a[204:207], a[140:143], v[96:111]
    s_waitcnt vmcnt(12)
    v_mfma_f32_32x32x16_bf16 v[64:79], a[208:211], a[144:147], v[64:79]
    v_mfma_f32_32x32x16_bf16 v[80:95], a[212:215], a[144:147], v[80:95]
    v_mfma_f32_32x32x16_bf16 v[96:111], a[216:219], a[144:147], v[96:111]
    s_waitcnt vmcnt(8)
    v_mfma_f32_32x32x16_bf16 v[64:79], a[220:223], a[148:151], v[64:79]
    v_mfma_f32_32x32x16_bf16 v[80:95], a[224:227], a[148:151], v[80:95]
    v_mfma_f32_32x32x16_bf16 v[96:111], a[228:231], a[148:151], v[96:111]
    s_waitcnt vmcnt(4)
    v_mfma_f32_32x32x16_bf16 v[64:79], v[160:163], v[184:187], v[64:79]
    v_mfma_f32_32x32x16_bf16 v[80:95], v[164:167], v[184:187], v[80:95]
    v_mfma_f32_32x32x16_bf16 v[96:111], v[168:171], v[184:187], v[96:111]
    v_mfma_f32_32x32x16_bf16 v[64:79], a[232:235], a[152:155], v[64:79]
    v_mfma_f32_32x32x16_bf16 v[80:95], a[236:239], a[152:155], v[80:95]
    v_mfma_f32_32x32x16_bf16 v[96:111], a[240:243], a[152:155], v[96:111]
    s_waitcnt vmcnt(0)
    v_mfma_f32_32x32x16_bf16 v[64:79], a[244:247], a[156:159], v[64:79]
    v_mfma_f32_32x32x16_bf16 v[80:95], a[248:251], a[156:159], v[80:95]
    v_mfma_f32_32x32x16_bf16 v[96:111], a[252:255], a[156:159], v[96:111]
    s_nop 11
    s_branch coldr_54
cold_58:
    s_mov_b64 exec, 65535
    s_mov_b32 s62, 0x20000
phh_60:
    v_mov_b32 v21, 0
    buffer_atomic_or v21, v252, s[8:11], s57 offen sc0 sc1
    s_sub_u32 s62, s62, 1
    s_cbranch_scc1 phhe_61
    s_waitcnt vmcnt(0)
    v_cmp_ne_u32 vcc, s6, v21
    s_cbranch_vccnz phh_60
phhe_61:
    s_waitcnt vmcnt(0)
    s_mov_b64 exec, -1
    s_branch coldr_59
cold_62:
    s_mov_b64 exec, 65535
    s_mov_b32 s62, 0x20000
phh_64:
    v_mov_b32 v22, 0
    buffer_atomic_or v22, v252, s[8:11], s57 offen sc0 sc1
    s_sub_u32 s62, s62, 1
    s_cbranch_scc1 phhe_65
    s_waitcnt vmcnt(0)
    v_cmp_ne_u32 vcc, s6, v22
    s_cbranch_vccnz phh_64
phhe_65:
    s_waitcnt vmcnt(0)
    s_mov_b64 exec, -1
    s_branch coldr_63
cold_66:
    s_mov_b64 exec, 65535
    s_mov_b32 s62, 0x20000
phh_68:
    v_mov_b32 v23, 0
    buffer_atomic_or v23, v252, s[8:11], s57 offen sc0 sc1
    s_sub_u32 s62, s62, 1
    s_cbranch_scc1 phhe_69
    s_waitcnt vmcnt(0)
    v_cmp_ne_u32 vcc, s6, v23
    s_cbranch_vccnz phh_68
phhe_69:
    s_waitcnt vmcnt(0)
    s_mov_b64 exec, -1
    s_branch coldr_67
cold_70:
    s_sub_u32 s54, s57, 4294967168
    s_mov_b64 exec, 65535
    s_mov_b32 s62, 0x20000
r5p_73:
    v_mov_b32 v23, 0
    buffer_atomic_or v23, v252, s[8:11], s54 offen sc0 sc1
    s_sub_u32 s62, s62, 1
    s_cbranch_scc1 r5pe_74
    s_waitcnt vmcnt(0)
    v_cmp_ne_u32 vcc, s6, v23
    s_cbranch_vccnz r5p_73
r5pe_74:
    s_waitcnt vmcnt(0)
    s_mov_b64 exec, -1
    s_sub_u32 s54, s57, 16256
    s_mov_b64 exec, 65535
    s_mov_b32 s62, 0x20000
r5p_75:
    v_mov_b32 v23, 0
    buffer_atomic_or v23, v252, s[8:11], s54 offen sc0 sc1
    s_sub_u32 s62, s62, 1
    s_cbranch_scc1 r5pe_76
    s_waitcnt vmcnt(0)
    v_cmp_ne_u32 vcc, s6, v23
    s_cbranch_vccnz r5p_75
r5pe_76:
    s_waitcnt vmcnt(0)
    s_mov_b64 exec, -1
    s_sub_u32 s54, s57, 32640
    s_mov_b64 exec, 65535
    s_mov_b32 s62, 0x20000
r5p_77:
    v_mov_b32 v23, 0
    buffer_atomic_or v23, v252, s[8:11], s54 offen sc0 sc1
    s_sub_u32 s62, s62, 1
    s_cbranch_scc1 r5pe_78
    s_waitcnt vmcnt(0)
    v_cmp_ne_u32 vcc, s6, v23
    s_cbranch_vccnz r5p_77
r5pe_78:
    s_waitcnt vmcnt(0)
    s_mov_b64 exec, -1
    s_sub_u32 s59, s59, 45056
    s_mul_i32 s52, s41, 245760
    s_add_u32 s52, s52, 4718592
    s_mov_b32 s56, 4
    v_mov_b32 v64, 0
    v_mov_b32 v65, 0
    v_mov_b32 v66, 0
    v_mov_b32 v67, 0
    v_mov_b32 v68, 0
    v_mov_b32 v69, 0
    v_mov_b32 v70, 0
    v_mov_b32 v71, 0
    v_mov_b32 v72, 0
    v_mov_b32 v73, 0
    v_mov_b32 v74, 0
    v_mov_b32 v75, 0
    v_mov_b32 v76, 0
    v_mov_b32 v77, 0
    v_mov_b32 v78, 0
    v_mov_b32 v79, 0
    v_mov_b32 v80, 0
    v_mov_b32 v81, 0
    v_mov_b32 v82, 0
    v_mov_b32 v83, 0
    v_mov_b32 v84, 0
    v_mov_b32 v85, 0
    v_mov_b32 v86, 0
    v_mov_b32 v87, 0
    v_mov_b32 v88, 0
    v_mov_b32 v89, 0
    v_mov_b32 v90, 0
    v_mov_b32 v91, 0
    v_mov_b32 v92, 0
    v_mov_b32 v93, 0
    v_mov_b32 v94, 0
    v_mov_b32 v95, 0
    v_mov_b32 v96, 0
    v_mov_b32 v97, 0
    v_mov_b32 v98, 0
    v_mov_b32 v99, 0
    v_mov_b32 v100, 0
    v_mov_b32 v101, 0
    v_mov_b32 v102, 0
    v_mov_b32 v103, 0
r5_72:
    buffer_load_dwordx4 a[0:3], v10, s[8:11], s59 offen sc1
    buffer_load_dwordx4 a[4:7], v11, s[8:11], s59 offen sc1
    buffer_load_dwordx4 a[8:11], v12, s[8:11], s52 offen sc1
    s_add_u32 s52, s52, 2048
    buffer_load_dwordx4 a[12:15], v12, s[8:11], s52 offen sc1
    s_add_u32 s52, s52, 2048
    buffer_load_dwordx4 a[16:19], v12, s[8:11], s52 offen sc1
    s_add_u32 s52, s52, 2048
    buffer_load_dwordx4 a[20:23], v12, s[8:11], s52 offen sc1
    s_add_u32 s52, s52, 2048
    buffer_load_dwordx4 a[24:27], v12, s[8:11], s52 offen sc1
    s_add_u32 s52, s52, 2048
    s_add_u32 s59, s59, 2048
    buffer_load_dwordx4 a[28:31], v10, s[8:11], s59 offen sc1
    buffer_load_dwordx4 a[32:35], v11, s[8:11], s59 offen sc1
    buffer_load_dwordx4 a[36:39], v12, s[8:11], s52 offen sc1
    s_add_u32 s52, s52, 2048
    buffer_load_dwordx4 a[40:43], v12, s[8:11], s52 offen sc1
    s_add_u32 s52, s52, 2048
    buffer_load_dwordx4 a[44:47], v12, s[8:11], s52 offen sc1
    s_add_u32 s52, s52, 2048
    buffer_load_dwordx4 a[48:51], v12, s[8:11], s52 offen sc1
    s_add_u32 s52, s52, 2048
    buffer_load_dwordx4 a[52:55], v12, s[8:11], s52 offen sc1
    s_add_u32 s52, s52, 2048
    s_add_u32 s59, s59, 2048
    buffer_load_dwordx4 a[56:59], v10, s[8:11], s59 offen sc1
    buffer_load_dwordx4 a[60:63], v11, s[8:11], s59 offen sc1
    buffer_load_dwordx4 a[64:67], v12, s[8:11], s52 offen sc1
    s_add_u32 s52, s52, 2048
    buffer_load_dwordx4 a[68:71], v12, s[8:11], s52 offen sc1
    s_add_u32 s52, s52, 2048
    buffer_load_dwordx4 a[72:75], v12, s[8:11], s52 offen sc1
    s_add_u32 s52, s52, 2048
    buffer_load_dwordx4 a[76:79], v12, s[8:11], s52 offen sc1
    s_add_u32 s52, s52, 2048
    buffer_load_dwordx4 a[80:83], v12, s[8:11], s52 offen sc1
    s_add_u32 s52, s52, 2048
    s_add_u32 s59, s59, 2048
    buffer_load_dwordx4 a[84:87], v10, s[8:11], s59 offen sc1
    buffer_load_dwordx4 a[88:91], v11, s[8:11], s59 offen sc1
    buffer_load_dwordx4 a[92:95], v12, s[8:11], s52 offen sc1
    s_add_u32 s52, s52, 2048
    buffer_load_dwordx4 a[96:99], v12, s[8:11], s52 offen sc1
    s_add_u32 s52, s52, 2048
    buffer_load_dwordx4 a[100:103], v12, s[8:11], s52 offen sc1
    s_add_u32 s52, s52, 2048
    buffer_load_dwordx4 a[104:107], v12, s[8:11], s52 offen sc1
    s_add_u32 s52, s52, 2048
    buffer_load_dwordx4 a[108:111], v12, s[8:11], s52 offen sc1
    s_add_u32 s52, s52, 2048
    s_add_u32 s59, s59, 2048
    buffer_load_dwordx4 a[112:115], v10, s[8:11], s59 offen sc1
    buffer_load_dwordx4 a[116:119], v11, s[8:11], s59 offen sc1
    buffer_load_dwordx4 a[120:123], v12, s[8:11], s52 offen sc1
    s_add_u32 s52, s52, 2048
    buffer_load_dwordx4 a[124:127], v12, s[8:11], s52 offen sc1
    s_add_u32 s52, s52, 2048
    buffer_load_dwordx4 a[128:131], v12, s[8:11], s52 offen sc1
    s_add_u32 s52, s52, 2048
    buffer_load_dwordx4 a[132:135], v12, s[8:11], s52 offen sc1
    s_add_u32 s52, s52, 2048
    buffer_load_dwordx4 a[136:139], v12, s[8:11], s52 offen sc1
    s_add_u32 s52, s52, 2048
    s_add_u32 s59, s59, 2048
    buffer_load_dwordx4 a[140:143], v10, s[8:11], s59 offen sc1
    buffer_load_dwordx4 a[144:147], v11, s[8:11], s59 offen sc1
    buffer_load_dwordx4 a[148:151], v12, s[8:11], s52 offen sc1
    s_add_u32 s52, s52, 2048
    buffer_load_dwordx4 a[152:155], v12, s[8:11], s52 offen sc1
    s_add_u32 s52, s52, 2048
    buffer_load_dwordx4 a[156:159], v12, s[8:11], s52 offen sc1
    s_add_u32 s52, s52, 2048
    buffer_load_dwordx4 a[160:163], v12, s[8:11], s52 offen sc1
    s_add_u32 s52, s52, 2048
    buffer_load_dwordx4 a[164:167], v12, s[8:11], s52 offen sc1
    s_add_u32 s52, s52, 2048
    s_add_u32 s59, s59, 2048
    s_waitcnt vmcnt(35)
    v_mfma_f32_16x16x32_bf16 v[64:67], a[8:11], a[0:3], v[64:67]
    v_mfma_f32_16x16x32_bf16 v[84:87], a[8:11], a[4:7], v[84:87]
    v_mfma_f32_16x16x32_bf16 v[68:71], a[12:15], a[0:3], v[68:71]
    v_mfma_f32_16x16x32_bf16 v[88:91], a[12:15], a[4:7], v[88:91]
    v_mfma_f32_16x16x32_bf16 v[72:75], a[16:19], a[0:3], v[72:75]
    v_mfma_f32_16x16x32_bf16 v[92:95], a[16:19], a[4:7], v[92:95]
    v_mfma_f32_16x16x32_bf16 v[76:79], a[20:23], a[0:3], v[76:79]
    v_mfma_f32_16x16x32_bf16 v[96:99], a[20:23], a[4:7], v[96:99]
    v_mfma_f32_16x16x32_bf16 v[80:83], a[24:27], a[0:3], v[80:83]
    v_mfma_f32_16x16x32_bf16 v[100:103], a[24:27], a[4:7], v[100:103]
    s_waitcnt vmcnt(28)
    v_mfma_f32_16x16x32_bf16 v[64:67], a[36:39], a[28:31], v[64:67]
    v_mfma_f32_16x16x32_bf16 v[84:87], a[36:39], a[32:35], v[84:87]
    v_mfma_f32_16x16x32_bf16 v[68:71], a[40:43], a[28:31], v[68:71]
    v_mfma_f32_16x16x32_bf16 v[88:91], a[40:43], a[32:35], v[88:91]
    v_mfma_f32_16x16x32_bf16 v[72:75], a[44:47], a[28:31], v[72:75]
    v_mfma_f32_16x16x32_bf16 v[92:95], a[44:47], a[32:35], v[92:95]
    v_mfma_f32_16x16x32_bf16 v[76:79], a[48:51], a[28:31], v[76:79]
    v_mfma_f32_16x16x32_bf16 v[96:99], a[48:51], a[32:35], v[96:99]
    v_mfma_f32_16x16x32_bf16 v[80:83], a[52:55], a[28:31], v[80:83]
    v_mfma_f32_16x16x32_bf16 v[100:103], a[52:55], a[32:35], v[100:103]
    s_waitcnt vmcnt(21)
    v_mfma_f32_16x16x32_bf16 v[64:67], a[64:67], a[56:59], v[64:67]
    v_mfma_f32_16x16x32_bf16 v[84:87], a[64:67], a[60:63], v[84:87]
    v_mfma_f32_16x16x32_bf16 v[68:71], a[68:71], a[56:59], v[68:71]
    v_mfma_f32_16x16x32_bf16 v[88:91], a[68:71], a[60:63], v[88:91]
    v_mfma_f32_16x16x32_bf16 v[72:75], a[72:75], a[56:59], v[72:75]
    v_mfma_f32_16x16x32_bf16 v[92:95], a[72:75], a[60:63], v[92:95]
    v_mfma_f32_16x16x32_bf16 v[76:79], a[76:79], a[56:59], v[76:79]
    v_mfma_f32_16x16x32_bf16 v[96:99], a[76:79], a[60:63], v[96:99]
    v_mfma_f32_16x16x32_bf16 v[80:83], a[80:83], a[56:59], v[80:83]
    v_mfma_f32_16x16x32_bf16 v[100:103], a[80:83], a[60:63], v[100:103]
    s_waitcnt vmcnt(14)
    v_mfma_f32_16x16x32_bf16 v[64:67], a[92:95], a[84:87], v[64:67]
    v_mfma_f32_16x16x32_bf16 v[84:87], a[92:95], a[88:91], v[84:87]
    v_mfma_f32_16x16x32_bf16 v[68:71], a[96:99], a[84:87], v[68:71]
    v_mfma_f32_16x16x32_bf16 v[88:91], a[96:99], a[88:91], v[88:91]
    v_mfma_f32_16x16x32_bf16 v[72:75], a[100:103], a[84:87], v[72:75]
    v_mfma_f32_16x16x32_bf16 v[92:95], a[100:103], a[88:91], v[92:95]
    v_mfma_f32_16x16x32_bf16 v[76:79], a[104:107], a[84:87], v[76:79]
    v_mfma_f32_16x16x32_bf16 v[96:99], a[104:107], a[88:91], v[96:99]
    v_mfma_f32_16x16x32_bf16 v[80:83], a[108:111], a[84:87], v[80:83]
    v_mfma_f32_16x16x32_bf16 v[100:103], a[108:111], a[88:91], v[100:103]
    s_waitcnt vmcnt(7)
    v_mfma_f32_16x16x32_bf16 v[64:67], a[120:123], a[112:115], v[64:67]
    v_mfma_f32_16x16x32_bf16 v[84:87], a[120:123], a[116:119], v[84:87]
    v_mfma_f32_16x16x32_bf16 v[68:71], a[124:127], a[112:115], v[68:71]
    v_mfma_f32_16x16x32_bf16 v[88:91], a[124:127], a[116:119], v[88:91]
    v_mfma_f32_16x16x32_bf16 v[72:75], a[128:131], a[112:115], v[72:75]
    v_mfma_f32_16x16x32_bf16 v[92:95], a[128:131], a[116:119], v[92:95]
    v_mfma_f32_16x16x32_bf16 v[76:79], a[132:135], a[112:115], v[76:79]
    v_mfma_f32_16x16x32_bf16 v[96:99], a[132:135], a[116:119], v[96:99]
    v_mfma_f32_16x16x32_bf16 v[80:83], a[136:139], a[112:115], v[80:83]
    v_mfma_f32_16x16x32_bf16 v[100:103], a[136:139], a[116:119], v[100:103]
    s_waitcnt vmcnt(0)
    v_mfma_f32_16x16x32_bf16 v[64:67], a[148:151], a[140:143], v[64:67]
    v_mfma_f32_16x16x32_bf16 v[84:87], a[148:151], a[144:147], v[84:87]
    v_mfma_f32_16x16x32_bf16 v[68:71], a[152:155], a[140:143], v[68:71]
    v_mfma_f32_16x16x32_bf16 v[88:91], a[152:155], a[144:147], v[88:91]
    v_mfma_f32_16x16x32_bf16 v[72:75], a[156:159], a[140:143], v[72:75]
    v_mfma_f32_16x16x32_bf16 v[92:95], a[156:159], a[144:147], v[92:95]
    v_mfma_f32_16x16x32_bf16 v[76:79], a[160:163], a[140:143], v[76:79]
    v_mfma_f32_16x16x32_bf16 v[96:99], a[160:163], a[144:147], v[96:99]
    v_mfma_f32_16x16x32_bf16 v[80:83], a[164:167], a[140:143], v[80:83]
    v_mfma_f32_16x16x32_bf16 v[100:103], a[164:167], a[144:147], v[100:103]
    s_sub_u32 s56, s56, 1
    s_cmp_lg_u32 s56, 0
    s_cbranch_scc1 r5_72
    s_nop 7
    s_branch coldr_71
cold_80:
    buffer_atomic_swap v4, v7, s[8:11], 0 offen offset:0 sc1
    s_branch coldr_81
attfb_27:
    s_waitcnt vmcnt(0) lgkmcnt(0)
    s_mov_b64 s[68:69], -1
    s_mov_b32 s48, 16
    s_mov_b32 s44, 0
    v_mov_b32 v48, 0xff800000
    v_mov_b32 v49, 0xff800000
    v_mov_b32 v50, 0xff800000
    v_mov_b32 v51, 0xff800000
attmax_83:
    buffer_load_dwordx2 a[92:93], v8, s[8:11], s44 offen offset:1024 sc1
    buffer_load_dwordx4 a[84:87], v0, s[8:11], s44 offen sc1
    buffer_load_dwordx4 a[88:91], v254, s[8:11], s44 offen sc1
    s_add_u32 s44, s44, 10752
    s_waitcnt vmcnt(0)
    v_mfma_f32_32x32x4bf16_1k v[64:95], a[92:93], a[80:81], 0 cbsz:1 abid:0
    v_mfma_f32_32x32x4bf16_1k v[96:127], a[92:93], a[82:83], 0 cbsz:1 abid:0
    s_nop 15
    s_nop 1
    v_mfma_f32_32x32x16_bf16 v[64:79], a[84:87], a[64:67], v[64:79]
    v_mfma_f32_32x32x16_bf16 v[80:95], a[84:87], a[68:71], v[80:95]
    v_mfma_f32_32x32x16_bf16 v[96:111], a[84:87], a[72:75], v[96:111]
    v_mfma_f32_32x32x16_bf16 v[112:127], a[84:87], a[76:79], v[112:127]
    s_nop 11
    v_max3_f32 v48, v64, v65, v48
    v_max3_f32 v48, v66, v67, v48
    v_max3_f32 v48, v68, v69, v48
    v_max3_f32 v48, v70, v71, v48
    v_max3_f32 v48, v72, v73, v48
    v_max3_f32 v48, v74, v75, v48
    v_max3_f32 v48, v76, v77, v48
    v_max3_f32 v48, v78, v79, v48
    v_max3_f32 v49, v80, v81, v49
    v_max3_f32 v49, v82, v83, v49
    v_max3_f32 v49, v84, v85, v49
    v_max3_f32 v49, v86, v87, v49
    v_max3_f32 v49, v88, v89, v49
    v_max3_f32 v49, v90, v91, v49
    v_max3_f32 v49, v92, v93, v49
    v_max3_f32 v49, v94, v95, v49
    v_max3_f32 v50, v96, v97, v50
    v_max3_f32 v50, v98, v99, v50
    v_max3_f32 v50, v100, v101, v50
    v_max3_f32 v50, v102, v103, v50
    v_max3_f32 v50, v104, v105, v50
    v_max3_f32 v50, v106, v107, v50
    v_max3_f32 v50, v108, v109, v50
    v_max3_f32 v50, v110, v111, v50
    v_max3_f32 v51, v112, v113, v51
    v_max3_f32 v51, v114, v115, v51
    v_max3_f32 v51, v116, v117, v51
    v_max3_f32 v51, v118, v119, v51
    v_max3_f32 v51, v120, v121, v51
    v_max3_f32 v51, v122, v123, v51
    v_max3_f32 v51, v124, v125, v51
    v_max3_f32 v51, v126, v127, v51
    v_mfma_f32_32x32x4bf16_1k v[64:95], a[92:93], a[80:81], 0 cbsz:1 abid:1
    v_mfma_f32_32x32x4bf16_1k v[96:127], a[92:93], a[82:83], 0 cbsz:1 abid:1
    s_nop 15
    s_nop 1
    v_mfma_f32_32x32x16_bf16 v[64:79], a[88:91], a[64:67], v[64:79]
    v_mfma_f32_32x32x16_bf16 v[80:95], a[88:91], a[68:71], v[80:95]
    v_mfma_f32_32x32x16_bf16 v[96:111], a[88:91], a[72:75], v[96:111]
    v_mfma_f32_32x32x16_bf16 v[112:127], a[88:91], a[76:79], v[112:127]
    s_nop 11
    v_max3_f32 v48, v64, v65, v48
    v_max3_f32 v48, v66, v67, v48
    v_max3_f32 v48, v68, v69, v48
    v_max3_f32 v48, v70, v71, v48
    v_max3_f32 v48, v72, v73, v48
    v_max3_f32 v48, v74, v75, v48
    v_max3_f32 v48, v76, v77, v48
    v_max3_f32 v48, v78, v79, v48
    v_max3_f32 v49, v80, v81, v49
    v_max3_f32 v49, v82, v83, v49
    v_max3_f32 v49, v84, v85, v49
    v_max3_f32 v49, v86, v87, v49
    v_max3_f32 v49, v88, v89, v49
    v_max3_f32 v49, v90, v91, v49
    v_max3_f32 v49, v92, v93, v49
    v_max3_f32 v49, v94, v95, v49
    v_max3_f32 v50, v96, v97, v50
    v_max3_f32 v50, v98, v99, v50
    v_max3_f32 v50, v100, v101, v50
    v_max3_f32 v50, v102, v103, v50
    v_max3_f32 v50, v104, v105, v50
    v_max3_f32 v50, v106, v107, v50
    v_max3_f32 v50, v108, v109, v50
    v_max3_f32 v50, v110, v111, v50
    v_max3_f32 v51, v112, v113, v51
    v_max3_f32 v51, v114, v115, v51
    v_max3_f32 v51, v116, v117, v51
    v_max3_f32 v51, v118, v119, v51
    v_max3_f32 v51, v120, v121, v51
    v_max3_f32 v51, v122, v123, v51
    v_max3_f32 v51, v124, v125, v51
    v_max3_f32 v51, v126, v127, v51
    s_sub_u32 s48, s48, 1
    s_cmp_lg_u32 s48, 0
    s_cbranch_scc1 attmax_83
    v_mov_b32 v56, v48
    v_mov_b32 v57, v49
    v_mov_b32 v58, v50
    v_mov_b32 v59, v51
    s_nop 1
    v_permlane32_swap_b32 v48, v56
    v_permlane32_swap_b32 v49, v57
    v_permlane32_swap_b32 v50, v58
    v_permlane32_swap_b32 v51, v59
    v_max_f32 v48, v48, v56
    v_max_f32 v49, v49, v57
    v_max_f32 v50, v50, v58
    v_max_f32 v51, v51, v59
    s_barrier
    ds_write_b128 v202, v[48:51]
    s_waitcnt lgkmcnt(0)
    s_barrier
    ds_read_b128 v[56:59], v203
    s_mov_b32 s44, 0
    buffer_load_dwordx2 a[92:93], v8, s[8:11], s44 offen offset:1024 sc1
    buffer_load_dwordx4 a[84:87], v0, s[8:11], s44 offen sc1
    buffer_load_dwordx4 a[94:97], v9, s[8:11], s44 offen offset:1280 sc1
    buffer_load_dwordx4 a[98:101], v9, s[8:11], s44 offen offset:1984 sc1
    buffer_load_dwordx4 a[88:91], v254, s[8:11], s44 offen sc1
    buffer_load_dwordx4 a[102:105], v255, s[8:11], s44 offen offset:1280 sc1
    buffer_load_dwordx4 a[106:109], v255, s[8:11], s44 offen offset:1984 sc1
    s_add_u32 s44, s44, 10752
    s_waitcnt vmcnt(0) lgkmcnt(0)
    s_barrier
    v_max_f32 v48, v48, v58
    v_max_f32 v49, v49, v59
    v_max_f32 v50, v50, v56
    v_max_f32 v51, v51, v57
    v_sub_f32 v128, 0, v48
    v_sub_f32 v129, 0, v48
    v_sub_f32 v130, 0, v48
    v_sub_f32 v131, 0, v48
    v_sub_f32 v132, 0, v48
    v_sub_f32 v133, 0, v48
    v_sub_f32 v134, 0, v48
    v_sub_f32 v135, 0, v48
    v_sub_f32 v136, 0, v48
    v_sub_f32 v137, 0, v48
    v_sub_f32 v138, 0, v48
    v_sub_f32 v139, 0, v48
    v_sub_f32 v140, 0, v48
    v_sub_f32 v141, 0, v48
    v_sub_f32 v142, 0, v48
    v_sub_f32 v143, 0, v48
    v_sub_f32 v144, 0, v49
    v_sub_f32 v145, 0, v49
    v_sub_f32 v146, 0, v49
    v_sub_f32 v147, 0, v49
    v_sub_f32 v148, 0, v49
    v_sub_f32 v149, 0, v49
    v_sub_f32 v150, 0, v49
    v_sub_f32 v151, 0, v49
    v_sub_f32 v152, 0, v49
    v_sub_f32 v153, 0, v49
    v_sub_f32 v154, 0, v49
    v_sub_f32 v155, 0, v49
    v_sub_f32 v156, 0, v49
    v_sub_f32 v157, 0, v49
    v_sub_f32 v158, 0, v49
    v_sub_f32 v159, 0, v49
    v_sub_f32 v160, 0, v50
    v_sub_f32 v161, 0, v50
    v_sub_f32 v162, 0, v50
    v_sub_f32 v163, 0, v50
    v_sub_f32 v164, 0, v50
    v_sub_f32 v165, 0, v50
    v_sub_f32 v166, 0, v50
    v_sub_f32 v167, 0, v50
    v_sub_f32 v168, 0, v50
    v_sub_f32 v169, 0, v50
    v_sub_f32 v170, 0, v50
    v_sub_f32 v171, 0, v50
    v_sub_f32 v172, 0, v50
    v_sub_f32 v173, 0, v50
    v_sub_f32 v174, 0, v50
    v_sub_f32 v175, 0, v50
    v_sub_f32 v176, 0, v51
    v_sub_f32 v177, 0, v51
    v_sub_f32 v178, 0, v51
    v_sub_f32 v179, 0, v51
    v_sub_f32 v180, 0, v51
    v_sub_f32 v181, 0, v51
    v_sub_f32 v182, 0, v51
    v_sub_f32 v183, 0, v51
    v_sub_f32 v184, 0, v51
    v_sub_f32 v185, 0, v51
    v_sub_f32 v186, 0, v51
    v_sub_f32 v187, 0, v51
    v_sub_f32 v188, 0, v51
    v_sub_f32 v189, 0, v51
    v_sub_f32 v190, 0, v51
    v_sub_f32 v191, 0, v51
    v_mov_b32 v60, 0
    v_mov_b32 v61, 0
    v_mov_b32 v62, 0
    v_mov_b32 v63, 0
    v_mov_b32 v120, 0
    v_mov_b32 v121, 0
    v_mov_b32 v122, 0
    v_mov_b32 v123, 0
    v_mov_b32 v124, 0
    v_mov_b32 v125, 0
    v_mov_b32 v126, 0
    v_mov_b32 v127, 0
    v_accvgpr_write_b32 a132, 0
    v_accvgpr_write_b32 a133, 0
    v_accvgpr_write_b32 a134, 0
    v_accvgpr_write_b32 a135, 0
    s_mov_b32 s48, 8
    s_nop 0
    v_mfma_f32_32x32x16_bf16 a[0:15], v[60:63], v[60:63], 0
    v_mfma_f32_32x32x16_bf16 a[16:31], v[60:63], v[60:63], 0
    v_mfma_f32_32x32x16_bf16 v[16:31], v[60:63], v[60:63], 0
    v_mfma_f32_32x32x16_bf16 v[32:47], v[60:63], v[60:63], 0
    v_mfma_f32_32x32x4bf16_1k v[64:95], a[92:93], a[80:81], v[128:159] cbsz:1 abid:0
    s_nop 15
    s_nop 1
    v_mfma_f32_32x32x16_bf16 v[64:79], a[84:87], a[64:67], v[64:79]
    v_mfma_f32_32x32x16_bf16 v[80:95], a[84:87], a[68:71], v[80:95]
    s_nop 10
attloop_82:
    v_exp_f32 v64, v64
    v_exp_f32 v65, v65
    v_smfmac_f32_32x32x32_bf16 v[32:47], a[132:135], v[120:127], v54
    buffer_load_dwordx2 a[118:119], v8, s[8:11], s44 offen offset:1024 sc1
    buffer_load_dwordx4 a[110:113], v0, s[8:11], s44 offen sc1
    buffer_load_dwordx4 a[120:123], v9, s[8:11], s44 offen offset:1280 sc1
    buffer_load_dwordx4 a[124:127], v9, s[8:11], s44 offen offset:1984 sc1
    buffer_load_dwordx4 a[114:117], v254, s[8:11], s44 offen sc1
    buffer_load_dwordx4 a[128:131], v255, s[8:11], s44 offen offset:1280 sc1
    buffer_load_dwordx4 a[132:135], v255, s[8:11], s44 offen offset:1984 sc1
    s_add_u32 s44, s44, 10752
    v_exp_f32 v66, v66
    v_exp_f32 v67, v67
    v_exp_f32 v68, v68
    v_mfma_f32_32x32x4bf16_1k v[96:127], a[92:93], a[82:83], v[160:191] cbsz:1 abid:0
    v_exp_f32 v69, v69
    v_exp_f32 v70, v70
    v_exp_f32 v71, v71
    v_exp_f32 v72, v72
    v_exp_f32 v73, v73
    v_exp_f32 v74, v74
    v_exp_f32 v75, v75
    v_exp_f32 v76, v76
    v_smfmac_f32_32x32x32_bf16 a[0:15], a[94:97], v[64:71], v54
    v_exp_f32 v77, v77
    v_exp_f32 v78, v78
    v_exp_f32 v79, v79
    v_exp_f32 v80, v80
    v_exp_f32 v81, v81
    v_smfmac_f32_32x32x32_bf16 a[0:15], a[98:101], v[72:79], v54
    v_exp_f32 v82, v82
    v_exp_f32 v83, v83
    v_exp_f32 v84, v84
    v_mfma_f32_32x32x16_bf16 v[96:111], a[84:87], a[72:75], v[96:111]
    v_exp_f32 v85, v85
    v_exp_f32 v86, v86
    v_exp_f32 v87, v87
    v_mfma_f32_32x32x16_bf16 v[112:127], a[84:87], a[76:79], v[112:127]
    v_exp_f32 v88, v88
    v_exp_f32 v89, v89
    v_exp_f32 v90, v90
    v_smfmac_f32_32x32x32_bf16 a[16:31], a[94:97], v[80:87], v54
    v_exp_f32 v91, v91
    v_exp_f32 v92, v92
    v_exp_f32 v93, v93
    v_exp_f32 v94, v94
    v_exp_f32 v95, v95
    v_exp_f32 v96, v96
    v_exp_f32 v97, v97
    v_smfmac_f32_32x32x32_bf16 a[16:31], a[98:101], v[88:95], v54
    v_exp_f32 v98, v98
    v_exp_f32 v99, v99
    v_exp_f32 v100, v100
    v_mfma_f32_32x32x4bf16_1k v[64:95], a[92:93], a[80:81], v[128:159] cbsz:1 abid:1
    v_exp_f32 v101, v101
    v_exp_f32 v102, v102
    v_exp_f32 v103, v103
    v_exp_f32 v104, v104
    v_exp_f32 v105, v105
    v_exp_f32 v106, v106
    v_exp_f32 v107, v107
    v_exp_f32 v108, v108
    v_smfmac_f32_32x32x32_bf16 v[16:31], a[94:97], v[96:103], v54
    v_exp_f32 v109, v109
    v_exp_f32 v110, v110
    v_exp_f32 v111, v111
    v_exp_f32 v112, v112
    v_exp_f32 v113, v113
    v_smfmac_f32_32x32x32_bf16 v[16:31], a[98:101], v[104:111], v54
    v_exp_f32 v114, v114
    v_exp_f32 v115, v115
    v_exp_f32 v116, v116
    v_mfma_f32_32x32x16_bf16 v[64:79], a[88:91], a[64:67], v[64:79]
    v_exp_f32 v117, v117
    v_exp_f32 v118, v118
    v_exp_f32 v119, v119
    v_mfma_f32_32x32x16_bf16 v[80:95], a[88:91], a[68:71], v[80:95]
    v_exp_f32 v120, v120
    v_exp_f32 v121, v121
    v_exp_f32 v122, v122
    v_smfmac_f32_32x32x32_bf16 v[32:47], a[94:97], v[112:119], v54
    v_exp_f32 v123, v123
    v_exp_f32 v124, v124
    v_exp_f32 v125, v125
    v_exp_f32 v126, v126
    v_exp_f32 v127, v127
    v_exp_f32 v64, v64
    v_exp_f32 v65, v65
    v_smfmac_f32_32x32x32_bf16 v[32:47], a[98:101], v[120:127], v54
    v_exp_f32 v66, v66
    v_exp_f32 v67, v67
    v_exp_f32 v68, v68
    v_mfma_f32_32x32x4bf16_1k v[96:127], a[92:93], a[82:83], v[160:191] cbsz:1 abid:1
    v_exp_f32 v69, v69
    v_exp_f32 v70, v70
    v_exp_f32 v71, v71
    v_exp_f32 v72, v72
    v_exp_f32 v73, v73
    v_exp_f32 v74, v74
    v_exp_f32 v75, v75
    v_exp_f32 v76, v76
    v_smfmac_f32_32x32x32_bf16 a[0:15], a[102:105], v[64:71], v54
    v_exp_f32 v77, v77
    v_exp_f32 v78, v78
    v_exp_f32 v79, v79
    v_exp_f32 v80, v80
    v_exp_f32 v81, v81
    v_smfmac_f32_32x32x32_bf16 a[0:15], a[106:109], v[72:79], v54
    v_exp_f32 v82, v82
    v_exp_f32 v83, v83
    v_exp_f32 v84, v84
    v_mfma_f32_32x32x16_bf16 v[96:111], a[88:91], a[72:75], v[96:111]
    v_exp_f32 v85, v85
    v_exp_f32 v86, v86
    v_exp_f32 v87, v87
    v_mfma_f32_32x32x16_bf16 v[112:127], a[88:91], a[76:79], v[112:127]
    v_exp_f32 v88, v88
    v_exp_f32 v89, v89
    v_exp_f32 v90, v90
    v_smfmac_f32_32x32x32_bf16 a[16:31], a[102:105], v[80:87], v54
    v_exp_f32 v91, v91
    v_exp_f32 v92, v92
    v_exp_f32 v93, v93
    v_exp_f32 v94, v94
    v_exp_f32 v95, v95
    v_exp_f32 v96, v96
    v_exp_f32 v97, v97
    v_smfmac_f32_32x32x32_bf16 a[16:31], a[106:109], v[88:95], v54
    s_waitcnt vmcnt(0)
    v_exp_f32 v98, v98
    v_exp_f32 v99, v99
    v_exp_f32 v100, v100
    v_mfma_f32_32x32x4bf16_1k v[64:95], a[118:119], a[80:81], v[128:159] cbsz:1 abid:0
    v_exp_f32 v101, v101
    v_exp_f32 v102, v102
    v_exp_f32 v103, v103
    v_exp_f32 v104, v104
    v_exp_f32 v105, v105
    v_exp_f32 v106, v106
    v_exp_f32 v107, v107
    v_exp_f32 v108, v108
    v_smfmac_f32_32x32x32_bf16 v[16:31], a[102:105], v[96:103], v54
    v_exp_f32 v109, v109
    v_exp_f32 v110, v110
    v_exp_f32 v111, v111
    v_exp_f32 v112, v112
    v_exp_f32 v113, v113
    v_smfmac_f32_32x32x32_bf16 v[16:31], a[106:109], v[104:111], v54
    v_exp_f32 v114, v114
    v_exp_f32 v115, v115
    v_exp_f32 v116, v116
    v_mfma_f32_32x32x16_bf16 v[64:79], a[110:113], a[64:67], v[64:79]
    v_exp_f32 v117, v117
    v_exp_f32 v118, v118
    v_exp_f32 v119, v119
    v_mfma_f32_32x32x16_bf16 v[80:95], a[110:113], a[68:71], v[80:95]
    v_exp_f32 v120, v120
    v_exp_f32 v121, v121
    v_exp_f32 v122, v122
    v_smfmac_f32_32x32x32_bf16 v[32:47], a[102:105], v[112:119], v54
    v_exp_f32 v123, v123
    v_exp_f32 v124, v124
    v_exp_f32 v125, v125
    v_exp_f32 v126, v126
    v_exp_f32 v127, v127
    v_exp_f32 v64, v64
    v_exp_f32 v65, v65
    v_smfmac_f32_32x32x32_bf16 v[32:47], a[106:109], v[120:127], v54
    buffer_load_dwordx2 a[92:93], v8, s[8:11], s44 offen offset:1024 sc1
    buffer_load_dwordx4 a[84:87], v0, s[8:11], s44 offen sc1
    buffer_load_dwordx4 a[94:97], v9, s[8:11], s44 offen offset:1280 sc1
    buffer_load_dwordx4 a[98:101], v9, s[8:11], s44 offen offset:1984 sc1
    buffer_load_dwordx4 a[88:91], v254, s[8:11], s44 offen sc1
    buffer_load_dwordx4 a[102:105], v255, s[8:11], s44 offen offset:1280 sc1
    buffer_load_dwordx4 a[106:109], v255, s[8:11], s44 offen offset:1984 sc1
    s_add_u32 s44, s44, 10752
    v_exp_f32 v66, v66
    v_exp_f32 v67, v67
    v_exp_f32 v68, v68
    v_mfma_f32_32x32x4bf16_1k v[96:127], a[118:119], a[82:83], v[160:191] cbsz:1 abid:0
    v_exp_f32 v69, v69
    v_exp_f32 v70, v70
    v_exp_f32 v71, v71
    v_exp_f32 v72, v72
    v_exp_f32 v73, v73
    v_exp_f32 v74, v74
    v_exp_f32 v75, v75
    v_exp_f32 v76, v76
    v_smfmac_f32_32x32x32_bf16 a[0:15], a[120:123], v[64:71], v54
    v_exp_f32 v77, v77
    v_exp_f32 v78, v78
    v_exp_f32 v79, v79
    v_exp_f32 v80, v80
    v_exp_f32 v81, v81
    v_smfmac_f32_32x32x32_bf16 a[0:15], a[124:127], v[72:79], v54
    v_exp_f32 v82, v82
    v_exp_f32 v83, v83
    v_exp_f32 v84, v84
    v_mfma_f32_32x32x16_bf16 v[96:111], a[110:113], a[72:75], v[96:111]
    v_exp_f32 v85, v85
    v_exp_f32 v86, v86
    v_exp_f32 v87, v87
    v_mfma_f32_32x32x16_bf16 v[112:127], a[110:113], a[76:79], v[112:127]
    v_exp_f32 v88, v88
    v_exp_f32 v89, v89
    v_exp_f32 v90, v90
    v_smfmac_f32_32x32x32_bf16 a[16:31], a[120:123], v[80:87], v54
    v_exp_f32 v91, v91
    v_exp_f32 v92, v92
    v_exp_f32 v93, v93
    v_exp_f32 v94, v94
    v_exp_f32 v95, v95
    v_exp_f32 v96, v96
    v_exp_f32 v97, v97
    v_smfmac_f32_32x32x32_bf16 a[16:31], a[124:127], v[88:95], v54
    v_exp_f32 v98, v98
    v_exp_f32 v99, v99
    v_exp_f32 v100, v100
    v_mfma_f32_32x32x4bf16_1k v[64:95], a[118:119], a[80:81], v[128:159] cbsz:1 abid:1
    v_exp_f32 v101, v101
    v_exp_f32 v102, v102
    v_exp_f32 v103, v103
    v_exp_f32 v104, v104
    v_exp_f32 v105, v105
    v_exp_f32 v106, v106
    v_exp_f32 v107, v107
    v_exp_f32 v108, v108
    v_smfmac_f32_32x32x32_bf16 v[16:31], a[120:123], v[96:103], v54
    v_exp_f32 v109, v109
    v_exp_f32 v110, v110
    v_exp_f32 v111, v111
    v_exp_f32 v112, v112
    v_exp_f32 v113, v113
    v_smfmac_f32_32x32x32_bf16 v[16:31], a[124:127], v[104:111], v54
    v_exp_f32 v114, v114
    v_exp_f32 v115, v115
    v_exp_f32 v116, v116
    v_mfma_f32_32x32x16_bf16 v[64:79], a[114:117], a[64:67], v[64:79]
    v_exp_f32 v117, v117
    v_exp_f32 v118, v118
    v_exp_f32 v119, v119
    v_mfma_f32_32x32x16_bf16 v[80:95], a[114:117], a[68:71], v[80:95]
    v_exp_f32 v120, v120
    v_exp_f32 v121, v121
    v_exp_f32 v122, v122
    v_smfmac_f32_32x32x32_bf16 v[32:47], a[120:123], v[112:119], v54
    v_exp_f32 v123, v123
    v_exp_f32 v124, v124
    v_exp_f32 v125, v125
    v_exp_f32 v126, v126
    v_exp_f32 v127, v127
    v_exp_f32 v64, v64
    v_exp_f32 v65, v65
    v_smfmac_f32_32x32x32_bf16 v[32:47], a[124:127], v[120:127], v54
    v_exp_f32 v66, v66
    v_exp_f32 v67, v67
    v_exp_f32 v68, v68
    v_mfma_f32_32x32x4bf16_1k v[96:127], a[118:119], a[82:83], v[160:191] cbsz:1 abid:1
    v_exp_f32 v69, v69
    v_exp_f32 v70, v70
    v_exp_f32 v71, v71
    v_exp_f32 v72, v72
    v_exp_f32 v73, v73
    v_exp_f32 v74, v74
    v_exp_f32 v75, v75
    v_exp_f32 v76, v76
    v_smfmac_f32_32x32x32_bf16 a[0:15], a[128:131], v[64:71], v54
    v_exp_f32 v77, v77
    v_exp_f32 v78, v78
    v_exp_f32 v79, v79
    v_exp_f32 v80, v80
    v_exp_f32 v81, v81
    v_smfmac_f32_32x32x32_bf16 a[0:15], a[132:135], v[72:79], v54
    v_exp_f32 v82, v82
    v_exp_f32 v83, v83
    v_exp_f32 v84, v84
    v_mfma_f32_32x32x16_bf16 v[96:111], a[114:117], a[72:75], v[96:111]
    v_exp_f32 v85, v85
    v_exp_f32 v86, v86
    v_exp_f32 v87, v87
    v_mfma_f32_32x32x16_bf16 v[112:127], a[114:117], a[76:79], v[112:127]
    v_exp_f32 v88, v88
    v_exp_f32 v89, v89
    v_exp_f32 v90, v90
    v_smfmac_f32_32x32x32_bf16 a[16:31], a[128:131], v[80:87], v54
    v_exp_f32 v91, v91
    v_exp_f32 v92, v92
    v_exp_f32 v93, v93
    v_exp_f32 v94, v94
    v_exp_f32 v95, v95
    v_exp_f32 v96, v96
    v_exp_f32 v97, v97
    v_smfmac_f32_32x32x32_bf16 a[16:31], a[132:135], v[88:95], v54
    s_waitcnt vmcnt(0)
    v_exp_f32 v98, v98
    v_exp_f32 v99, v99
    v_exp_f32 v100, v100
    v_mfma_f32_32x32x4bf16_1k v[64:95], a[92:93], a[80:81], v[128:159] cbsz:1 abid:0
    v_exp_f32 v101, v101
    v_exp_f32 v102, v102
    v_exp_f32 v103, v103
    v_exp_f32 v104, v104
    v_exp_f32 v105, v105
    v_exp_f32 v106, v106
    v_exp_f32 v107, v107
    v_exp_f32 v108, v108
    v_smfmac_f32_32x32x32_bf16 v[16:31], a[128:131], v[96:103], v54
    s_sub_u32 s48, s48, 1
    s_cmp_lg_u32 s48, 0
    v_exp_f32 v109, v109
    v_exp_f32 v110, v110
    v_exp_f32 v111, v111
    v_exp_f32 v112, v112
    v_exp_f32 v113, v113
    v_smfmac_f32_32x32x32_bf16 v[16:31], a[132:135], v[104:111], v54
    v_exp_f32 v114, v114
    v_exp_f32 v115, v115
    v_exp_f32 v116, v116
    v_mfma_f32_32x32x16_bf16 v[64:79], a[84:87], a[64:67], v[64:79]
    v_exp_f32 v117, v117
    v_exp_f32 v118, v118
    v_exp_f32 v119, v119
    v_mfma_f32_32x32x16_bf16 v[80:95], a[84:87], a[68:71], v[80:95]
    v_exp_f32 v120, v120
    v_exp_f32 v121, v121
    v_exp_f32 v122, v122
    v_smfmac_f32_32x32x32_bf16 v[32:47], a[128:131], v[112:119], v54
    v_exp_f32 v123, v123
    v_exp_f32 v124, v124
    v_exp_f32 v125, v125
    v_exp_f32 v126, v126
    v_exp_f32 v127, v127
    s_cbranch_scc1 attloop_82
    s_nop 0
    v_smfmac_f32_32x32x32_bf16 v[32:47], a[132:135], v[120:127], v54
    s_nop 15
    s_nop 3
    ds_write_b128 v202, a[0:3] offset:0
    ds_write_b128 v202, a[4:7] offset:1024
    ds_write_b128 v202, a[8:11] offset:2048
    ds_write_b32 v202, a12 offset:3072
    ds_write_b128 v202, a[16:19] offset:4096
    ds_write_b128 v202, a[20:23] offset:5120
    ds_write_b128 v202, a[24:27] offset:6144
    ds_write_b32 v202, a28 offset:7168
    s_waitcnt lgkmcnt(0)
    s_barrier
    ds_read_b128 v[64:67], v203 offset:0
    ds_read_b128 v[68:71], v203 offset:1024
    ds_read_b128 v[72:75], v203 offset:2048
    ds_read_b32 v76, v203 offset:3072
    ds_read_b128 v[80:83], v203 offset:4096
    ds_read_b128 v[84:87], v203 offset:5120
    ds_read_b128 v[88:91], v203 offset:6144
    ds_read_b32 v92, v203 offset:7168
    s_branch attmerge_26
L_bot:
    s_endpgm
.section .rodata,"a"
.p2align 6
.amdhsa_kernel adaLN_cond__softmax_full_mha__glu_gated_geglu__prompt_kernel
  .amdhsa_next_free_vgpr 512
  .amdhsa_next_free_sgpr 102
  .amdhsa_accum_offset 256
  .amdhsa_group_segment_fixed_size 0
  .amdhsa_kernarg_size 96
  .amdhsa_user_sgpr_count 2
  .amdhsa_user_sgpr_kernarg_segment_ptr 1
  .amdhsa_system_sgpr_workgroup_id_x 1
  .amdhsa_float_denorm_mode_32 3
.end_amdhsa_kernel
```
